```python
import torch

def _softmax(x, axis=-1):
    return torch.softmax(x, dim=axis)
def _gelu(x):
    return torch.nn.functional.gelu(x, approximate="tanh")
def _silu(x):
    return torch.nn.functional.silu(x)
def _sigmoid(x):
    return torch.sigmoid(x)
def _layernorm(x, axis=-1, eps=1e-5):
    m = x.mean(dim=axis, keepdim=True)
    v = x.var(dim=axis, keepdim=True, unbiased=False)
    return (x - m) / torch.sqrt(v + eps)
def _scatter_add(tgt, idx, src, axis=0):
    return tgt.clone().index_add_(axis, idx, src)
def _segment_sum(src, seg, n):
    out = torch.zeros((n,) + src.shape[1:], dtype=src.dtype)
    return out.index_add_(0, seg, src)
def _pad(x, pw):
    flat = tuple(v for pair in reversed(pw) for v in pair)
    return torch.nn.functional.pad(x, flat)

kernel_name = 'gated_mix__ssm_conv_s5__linear_kernel_hedgehog__prompt'

def setup_inputs():

    _w = (lambda a: (lambda t: t.to(torch.bfloat16) if t.is_floating_point() else t)(torch.as_tensor(a)))
    def _A_setup():
        B, S, D = 1, 2048, 640
        P = D
        Lambda_re = -0.5 * (lambda _x: torch.exp(torch.as_tensor(_x)))((lambda *s: torch.randn(*s, dtype=torch.bfloat16) * 0.4)(P))
        Lambda_im = (lambda *s: torch.randn(*s, dtype=torch.bfloat16) * 0.4)(P) * 1.0
        B_re = (lambda *s: torch.randn(*s, dtype=torch.bfloat16) * 0.4)(P, D) * (D ** -0.5)
        B_im = (lambda *s: torch.randn(*s, dtype=torch.bfloat16) * 0.4)(P, D) * (D ** -0.5)
        C_re = (lambda *s: torch.randn(*s, dtype=torch.bfloat16) * 0.4)(D, P) * (P ** -0.5)
        C_im = (lambda *s: torch.randn(*s, dtype=torch.bfloat16) * 0.4)(D, P) * (P ** -0.5)
        log_dt = (lambda *s: torch.randn(*s, dtype=torch.bfloat16) * 0.4)(P) * 0.3 - 2.0
        Dskip = (lambda *s: torch.randn(*s, dtype=torch.bfloat16) * 0.05)(D)
        return {
            "x": _w((lambda *s: torch.randn(*s, dtype=torch.bfloat16) * 0.05)(B, S, D)),
            "Lambda_re": _w(Lambda_re),
            "Lambda_im": _w(Lambda_im),
            "B_re": _w(B_re),
            "B_im": _w(B_im),
            "C_re": _w(C_re),
            "C_im": _w(C_im),
            "log_dt": _w(log_dt),
            "Dskip": _w(Dskip),
        }
    _A_in = _A_setup()

    def _B_setup():
        B, S, D, H = 1, 2048, 640, 32
        Dh = D // H
        return {
            "x": _w((lambda *s: torch.randn(*s, dtype=torch.bfloat16) * 0.05)(B, S, D)),
            "wqkv": _w((lambda *s: torch.randn(*s, dtype=torch.bfloat16) * 0.8)(D, 3 * D)),
            "w_phi": _w((lambda *s: torch.randn(*s, dtype=torch.bfloat16) * 0.8)(H, Dh, Dh) * (Dh ** -0.5)),
            "wo": _w((lambda *s: torch.randn(*s, dtype=torch.bfloat16) * 0.05)(D, D)),
        }
    _B_in = _B_setup()

    return {
        "A_x": _A_in["x"],
        "A_Lambda_re": _A_in["Lambda_re"],
        "A_Lambda_im": _A_in["Lambda_im"],
        "A_B_re": _A_in["B_re"],
        "A_B_im": _A_in["B_im"],
        "A_C_re": _A_in["C_re"],
        "A_C_im": _A_in["C_im"],
        "A_log_dt": _A_in["log_dt"],
        "A_Dskip": _A_in["Dskip"],
        "B_x": _B_in["x"],
        "B_wqkv": _B_in["wqkv"],
        "B_w_phi": _B_in["w_phi"],
        "B_wo": _B_in["wo"],
        "gate_w": _w((lambda *s: torch.randn(*s, dtype=torch.bfloat16) * 0.05)(640) * 16.0),
    }

def reference(A_x, A_Lambda_re, A_Lambda_im, A_B_re, A_B_im, A_C_re, A_C_im, A_log_dt, A_Dskip, B_x, B_wqkv, B_w_phi, B_wo, gate_w):
    def _A_ref(x, Lambda_re, Lambda_im, B_re, B_im, C_re, C_im, log_dt, Dskip):
        Bsz, L, H = x.shape
        Lam = Lambda_re + 1j * Lambda_im
        Bmat = B_re + 1j * B_im
        Cmat = C_re + 1j * C_im
        dt = torch.exp(log_dt)
        Lam_bar = torch.exp(dt * Lam)
        B_bar = ((Lam_bar - 1.0) / Lam)[:, None] * Bmat
        Bu = torch.einsum("bld,pd->blp", x + 0j, B_bar)
        h = torch.zeros_like(Bu[:, 0, :])
        hs = []
        for t in range(L):
            h = Lam_bar[None, :] * h + Bu[:, t, :]
            hs.append(h)
        hseq = torch.stack(hs, 1)
        y = 2.0 * torch.einsum("blp,dp->bld", hseq, Cmat).real + x * Dskip[None, None, :]
        return y

    def _B_ref(x, wqkv, w_phi, wo):
        B, S, D = x.shape
        H = 32; Dh = D // H
        qkv = (lambda x, *d: x.permute(*d))((x @ wqkv).reshape(B, S, 3, H, Dh), 2, 0, 3, 1, 4)
        q, k, v = qkv[0], qkv[1], qkv[2]
        pq = torch.einsum("bhsd,hdf->bhsf", q, w_phi)
        pk = torch.einsum("bhsd,hdf->bhsf", k, w_phi)
        phi_q = torch.concatenate([_softmax(pq, axis=-1), _softmax(-pq, axis=-1)], axis=-1)
        phi_k = torch.concatenate([_softmax(pk, axis=-1), _softmax(-pk, axis=-1)], axis=-1)
        kv = torch.einsum("bhsf,bhsd->bhfd", phi_k, v)
        z  = torch.einsum("bhsf->bhf", phi_k)
        num = torch.einsum("bhqf,bhfd->bhqd", phi_q, kv)
        den = torch.einsum("bhqf,bhf->bhq", phi_q, z)[..., None] + 1e-6
        o = num / den
        return (lambda x, *d: x.permute(*d))(o, 0, 2, 1, 3).reshape(B, S, D) @ wo

    x = A_x
    g = _sigmoid((x * gate_w).sum(-1, keepdims=True))
    a = _A_ref(x, A_Lambda_re, A_Lambda_im, A_B_re, A_B_im, A_C_re, A_C_im, A_log_dt, A_Dskip)
    b = _B_ref(x, B_wqkv, B_w_phi, B_wo)
    return g * a + (1 - g) * b
```

```asm
; @launch grid=(256,1,1) block=(512,1,1) lds=163840
.amdgcn_target "amdgcn-amd-amdhsa--gfx950"
.text
.globl gated_mix__ssm_conv_s5__linear_kernel_hedgehog__prompt_kernel
.p2align 8
.type gated_mix__ssm_conv_s5__linear_kernel_hedgehog__prompt_kernel,@function
gated_mix__ssm_conv_s5__linear_kernel_hedgehog__prompt_kernel:
s_cmp_ge_u32 s2, 256
s_cbranch_scc1 L_end
s_load_dwordx16 s[4:19], s[0:1], 0
s_load_dwordx16 s[20:35], s[0:1], 64
s_load_dwordx2 s[36:37], s[0:1], 128
s_getpc_b64 s[38:39]
L_pfbase:
v_lshlrev_b32 v20, 7, v0
v_min_u32 v20, L_end-L_pfbase, v20
global_load_dword v250, v20, s[38:39]
v_and_b32 v1, 63, v0
v_lshrrev_b32 v20, 6, v0
s_nop 0
v_readfirstlane_b32 s58, v20
s_and_b32 s64, s2, 7
s_lshr_b32 s65, s2, 3
s_and_b32 s56, s64, 1
s_lshl_b32 s56, s56, 3
s_and_b32 s66, s65, 7
s_add_u32 s56, s56, s66
s_lshr_b32 s57, s64, 1
s_lshl_b32 s57, s57, 2
s_lshr_b32 s66, s65, 3
s_add_u32 s57, s57, s66
s_and_b32 s59, s58, 3
v_lshrrev_b32 v2, 5, v1
s_cmp_ge_u32 s58, 4
s_cbranch_scc1 L_roleY
v_lshrrev_b32 v20, 3, v1
v_and_b32 v21, 7, v1
v_lshrrev_b32 v22, 1, v20
v_xor_b32 v22, v22, v21
v_xor_b32 v23, 4, v22
v_bfe_u32 v24, v20, 2, 1
v_lshlrev_b32 v24, 4, v24
v_and_b32 v25, 1, v20
v_lshl_add_u32 v24, v25, 3, v24
v_bfe_u32 v25, v20, 1, 1
v_add_u32 v24, v24, v25
s_lshl_b32 s64, s56, 7
s_lshr_b32 s65, s58, 1
s_lshl_b32 s65, s65, 5
s_add_u32 s64, s64, s65
s_and_b32 s65, s58, 1
s_lshl_b32 s65, s65, 2
s_add_u32 s64, s64, s65
v_add_u32 v24, s64, v24
v_mul_u32_u24 v24, 1280, v24
v_lshl_add_u32 v144, v22, 4, v24
v_lshl_add_u32 v145, v23, 4, v24
v_add_u32 v145, 2560, v145
s_lshl_b32 s60, s58, 11
s_mul_i32 s64, s57, 40
s_and_b32 s65, s59, 1
s_lshl_b32 s65, s65, 4
s_add_u32 s65, s65, s64
v_add_u32 v24, s65, v20
v_mul_u32_u24 v24, 1280, v24
v_lshl_add_u32 v146, v22, 4, v24
v_lshl_add_u32 v147, v23, 4, v24
v_add_u32 v147, 10240, v147
s_add_u32 s64, s64, 32
v_add_u32 v24, s64, v20
v_mul_u32_u24 v24, 1280, v24
s_cmp_ge_u32 s59, 2
s_cselect_b32 s65, 0, -1
v_and_b32 v24, s65, v24
s_and_b32 s65, s59, 1
s_lshl_b32 s65, s65, 2
v_xor_b32 v22, s65, v22
v_lshl_add_u32 v148, v22, 4, v24
s_cmp_eq_u32 s59, 2
s_cselect_b32 s65, 1, 8
s_cmp_eq_u32 s59, 3
s_cselect_b32 s65, 0, s65
v_mov_b32 v25, 2146435072
v_cmp_gt_u32 vcc, s65, v20
s_nop 1
v_cndmask_b32 v148, v25, v148, vcc
s_lshl_b32 s61, s59, 11
s_add_u32 s61, s61, 49152
v_lshrrev_b32 v24, 4, v1
v_bfe_u32 v25, v1, 2, 2
v_xor_b32 v25, v25, v24
v_and_b32 v26, 3, v1
v_lshl_add_u32 v27, v25, 2, v26
v_lshlrev_b32 v27, 2, v27
v_mov_b32 v28, 0x23024310
v_mov_b32 v29, 0x44124310
v_cmp_lt_u32 vcc, 31, v27
s_nop 1
v_cndmask_b32 v28, v28, v29, vcc
v_and_b32 v27, 31, v27
v_lshrrev_b32 v28, v27, v28
v_and_b32 v28, 7, v28
v_lshlrev_b32 v28, 4, v28
v_lshrrev_b32 v29, 1, v25
v_mul_u32_u24 v29, 1280, v29
v_and_b32 v27, 1, v25
v_cmp_lt_u32 vcc, 0, v26
s_nop 1
v_cndmask_b32 v27, 0, v27, vcc
v_mov_b32 v30, 2560
v_cmp_eq_u32 vcc, 1, v27
s_nop 1
v_cndmask_b32 v29, v29, v30, vcc
v_add_u32 v28, v28, v29
v_mul_u32_u24 v24, 3840, v24
v_add_u32 v28, v28, v24
s_mul_i32 s64, s57, 80
s_xor_b32 s65, s57, 1
s_mul_i32 s65, s65, 80
v_mov_b32 v27, s64
v_mov_b32 v30, s65
v_cmp_eq_u32 vcc, 0, v29
s_nop 1
v_cndmask_b32 v27, v27, v30, vcc
v_add_u32 v149, v27, v28
v_lshl_add_u32 v27, v25, 2, v26
v_mov_b32 v30, 2146435072
v_cmp_eq_u32 vcc, 15, v27
s_nop 1
v_cndmask_b32 v149, v149, v30, vcc
s_lshl_b32 s62, s59, 10
s_add_u32 s62, s62, 86016
s_mul_i32 s3, s59, 15360
s_waitcnt lgkmcnt(0)
s_mov_b32 s40, s4
s_and_b32 s41, s5, 0xffff
s_mov_b32 s42, 2621440
s_mov_b32 s43, 0x20000
s_mov_b32 s48, s24
s_and_b32 s49, s25, 0xffff
s_mov_b32 s50, 2457600
s_mov_b32 s51, 0x20000
s_mov_b32 s52, s36
s_and_b32 s53, s37, 0xffff
s_mov_b32 s54, 268435456
s_mov_b32 s55, 0x20000
s_cmp_lt_u32 s59, 2
s_cselect_b32 s44, s10, s12
s_cselect_b32 s65, s11, s13
s_and_b32 s45, s65, 0xffff
s_mov_b32 s46, 819200
s_mov_b32 s47, 0x20000
s_cmp_eq_u32 s59, 0
s_cselect_b32 s64, s10, s12
s_cselect_b32 s65, s11, s13
s_cmp_ge_u32 s59, 2
s_cselect_b32 s68, s30, s64
s_cselect_b32 s65, s31, s65
s_movk_i32 s66, 1280
s_cselect_b32 s70, s66, 819200
s_and_b32 s69, s65, 0xffff
s_mov_b32 s71, 0x20000
s_add_u32 m0, s60, 0
s_movk_i32 s23, 0
buffer_load_dwordx4 v144, s[40:43], s23 offen lds
s_add_u32 m0, s60, 1024
s_movk_i32 s23, 0
buffer_load_dwordx4 v145, s[40:43], s23 offen lds
s_add_u32 m0, s61, 0
s_movk_i32 s23, 0
buffer_load_dwordx4 v146, s[44:47], s23 offen lds
s_add_u32 m0, s61, 1024
s_movk_i32 s23, 0
buffer_load_dwordx4 v147, s[44:47], s23 offen lds
s_lshr_b32 s23, s61, 1
s_add_u32 m0, s23, 32768
s_movk_i32 s23, 0
buffer_load_dwordx4 v148, s[68:71], s23 offen lds
s_add_u32 m0, s62, 0
s_add_u32 s23, s3, 0
buffer_load_dwordx4 v149, s[48:51], s23 offen lds
s_barrier
s_add_u32 m0, s60, 16384
s_movk_i32 s23, 128
buffer_load_dwordx4 v144, s[40:43], s23 offen lds
s_add_u32 m0, s60, 17408
s_movk_i32 s23, 128
buffer_load_dwordx4 v145, s[40:43], s23 offen lds
s_add_u32 m0, s61, 12288
s_movk_i32 s23, 128
buffer_load_dwordx4 v146, s[44:47], s23 offen lds
s_add_u32 m0, s61, 13312
s_movk_i32 s23, 128
buffer_load_dwordx4 v147, s[44:47], s23 offen lds
s_lshr_b32 s23, s61, 1
s_add_u32 m0, s23, 45056
s_movk_i32 s23, 128
buffer_load_dwordx4 v148, s[68:71], s23 offen lds
s_add_u32 m0, s62, 16384
s_add_u32 s23, s3, 245760
buffer_load_dwordx4 v149, s[48:51], s23 offen lds
s_or_b32 s64, s2, s58
s_cmp_lg_u32 s64, 0
s_cbranch_scc1 L_nonce_done
s_memrealtime s[66:67]
s_waitcnt lgkmcnt(0)
s_or_b32 s66, s66, 1
v_mov_b32 v20, s66
v_mov_b32 v21, 0
global_store_dword v21, v20, s[34:35] sc1
L_nonce_done:
v_and_b32 v24, 31, v1
v_bfe_u32 v26, v24, 1, 3
v_lshlrev_b32 v27, 7, v24
s_lshl_b32 s64, s59, 12
v_or_b32 v28, 0, v2
v_xor_b32 v28, v28, v26
v_lshl_add_u32 v28, v28, 4, v27
v_add_u32 v150, s64, v28
v_add_u32 v154, 49152, v28
v_or_b32 v28, 2, v2
v_xor_b32 v28, v28, v26
v_lshl_add_u32 v28, v28, 4, v27
v_add_u32 v151, s64, v28
v_add_u32 v155, 49152, v28
v_or_b32 v28, 4, v2
v_xor_b32 v28, v28, v26
v_lshl_add_u32 v28, v28, 4, v27
v_add_u32 v152, s64, v28
v_add_u32 v156, 49152, v28
v_or_b32 v28, 6, v2
v_xor_b32 v28, v28, v26
v_lshl_add_u32 v28, v28, 4, v27
v_add_u32 v153, s64, v28
v_add_u32 v157, 49152, v28
s_waitcnt vmcnt(6)
s_barrier
ds_read_b128 v[112:115], v150 offset:0
ds_read_b128 v[116:119], v154 offset:0
ds_read_b128 v[120:123], v154 offset:4096
ds_read_b128 v[124:127], v154 offset:8192
s_waitcnt lgkmcnt(0)
v_mfma_f32_32x32x16_bf16 v[32:47], v[112:115], v[116:119], 0
ds_read_b128 v[128:131], v151 offset:0
ds_read_b128 v[132:135], v155 offset:0
s_add_u32 m0, s60, 32768
s_movk_i32 s23, 256
buffer_load_dwordx4 v144, s[40:43], s23 offen lds
v_lshrrev_b32 v20, 3, v1
v_and_b32 v21, 7, v1
v_mov_b32 v23, 2146435072
v_mfma_f32_32x32x16_bf16 v[48:63], v[112:115], v[120:123], 0
ds_read_b128 v[136:139], v155 offset:4096
ds_read_b128 v[140:143], v155 offset:8192
s_add_u32 m0, s60, 33792
s_movk_i32 s23, 256
buffer_load_dwordx4 v145, s[40:43], s23 offen lds
s_lshl_b32 s64, s2, 3
v_add_u32 v21, s64, v21
v_mul_u32_u24 v21, 1280, v21
v_mfma_f32_32x32x16_bf16 v[64:79], v[112:115], v[124:127], 0
v_lshl_add_u32 v21, v20, 7, v21
v_add_u32 v21, 256, v21
s_cmp_eq_u32 s59, 0
s_cselect_b32 s65, 0, 2146435072
s_waitcnt lgkmcnt(0)
v_mfma_f32_32x32x16_bf16 v[32:47], v[128:131], v[132:135], v[32:47]
ds_read_b128 v[112:115], v152 offset:0
ds_read_b128 v[116:119], v156 offset:0
s_add_u32 m0, s61, 24576
s_movk_i32 s23, 256
buffer_load_dwordx4 v146, s[44:47], s23 offen lds
v_or_b32 v21, s65, v21
buffer_load_dword v251, v21, s[40:43], 0 offen
v_mov_b32 v23, 2146435072
v_mfma_f32_32x32x16_bf16 v[48:63], v[128:131], v[136:139], v[48:63]
ds_read_b128 v[120:123], v156 offset:4096
ds_read_b128 v[124:127], v156 offset:8192
s_add_u32 m0, s61, 25600
s_movk_i32 s23, 256
buffer_load_dwordx4 v147, s[44:47], s23 offen lds
v_and_b32 v20, 7, v1
v_add_u32 v20, 32, v20
v_cmp_gt_u32 vcc, 32, v1
v_mfma_f32_32x32x16_bf16 v[64:79], v[128:131], v[140:143], v[64:79]
s_nop 0
v_cndmask_b32 v3, v20, v1, vcc
s_mul_i32 s64, s57, 80
v_lshlrev_b32 v20, 1, v3
s_waitcnt lgkmcnt(0)
v_mfma_f32_32x32x16_bf16 v[32:47], v[112:115], v[116:119], v[32:47]
ds_read_b128 v[128:131], v153 offset:0
ds_read_b128 v[132:135], v157 offset:0
s_lshr_b32 s23, s61, 1
s_add_u32 m0, s23, 57344
s_movk_i32 s23, 256
buffer_load_dwordx4 v148, s[68:71], s23 offen lds
v_add_u32 v20, s64, v20
global_load_ushort v176, v20, s[6:7]
global_load_ushort v177, v20, s[8:9]
v_mfma_f32_32x32x16_bf16 v[48:63], v[112:115], v[120:123], v[48:63]
ds_read_b128 v[136:139], v157 offset:4096
ds_read_b128 v[140:143], v157 offset:8192
s_add_u32 m0, s62, 32768
s_add_u32 s23, s3, 491520
buffer_load_dwordx4 v149, s[48:51], s23 offen lds
global_load_ushort v178, v20, s[18:19]
s_mov_b32 s76, 0x3fb8aa3b
s_mov_b32 s77, 0x3fb8aa3b
v_mfma_f32_32x32x16_bf16 v[64:79], v[112:115], v[124:127], v[64:79]
s_mov_b32 s78, 0xbfb8aa3b
s_mov_b32 s79, 0xbfb8aa3b
s_waitcnt lgkmcnt(0)
s_waitcnt vmcnt(10)
s_barrier
v_mfma_f32_32x32x16_bf16 v[32:47], v[128:131], v[132:135], v[32:47]
ds_read_b128 v[112:115], v150 offset:16384
ds_read_b128 v[116:119], v154 offset:12288
s_add_u32 m0, s60, 0
s_movk_i32 s23, 384
buffer_load_dwordx4 v144, s[40:43], s23 offen lds
v_mfma_f32_32x32x16_bf16 v[48:63], v[128:131], v[136:139], v[48:63]
ds_read_b128 v[120:123], v154 offset:16384
ds_read_b128 v[124:127], v154 offset:20480
s_add_u32 m0, s60, 1024
s_movk_i32 s23, 384
buffer_load_dwordx4 v145, s[40:43], s23 offen lds
v_mfma_f32_32x32x16_bf16 v[64:79], v[128:131], v[140:143], v[64:79]
s_waitcnt lgkmcnt(0)
v_mfma_f32_32x32x16_bf16 v[32:47], v[112:115], v[116:119], v[32:47]
ds_read_b128 v[128:131], v151 offset:16384
ds_read_b128 v[132:135], v155 offset:12288
s_add_u32 m0, s61, 0
s_movk_i32 s23, 384
buffer_load_dwordx4 v146, s[44:47], s23 offen lds
v_mfma_f32_32x32x16_bf16 v[48:63], v[112:115], v[120:123], v[48:63]
ds_read_b128 v[136:139], v155 offset:16384
ds_read_b128 v[140:143], v155 offset:20480
s_add_u32 m0, s61, 1024
s_movk_i32 s23, 384
buffer_load_dwordx4 v147, s[44:47], s23 offen lds
v_mfma_f32_32x32x16_bf16 v[64:79], v[112:115], v[124:127], v[64:79]
s_waitcnt lgkmcnt(0)
v_mfma_f32_32x32x16_bf16 v[32:47], v[128:131], v[132:135], v[32:47]
ds_read_b128 v[112:115], v152 offset:16384
ds_read_b128 v[116:119], v156 offset:12288
s_lshr_b32 s23, s61, 1
s_add_u32 m0, s23, 32768
s_movk_i32 s23, 384
buffer_load_dwordx4 v148, s[68:71], s23 offen lds
v_mfma_f32_32x32x16_bf16 v[48:63], v[128:131], v[136:139], v[48:63]
ds_read_b128 v[120:123], v156 offset:16384
ds_read_b128 v[124:127], v156 offset:20480
s_add_u32 m0, s62, 0
s_add_u32 s23, s3, 737280
buffer_load_dwordx4 v149, s[48:51], s23 offen lds
v_mfma_f32_32x32x16_bf16 v[64:79], v[128:131], v[140:143], v[64:79]
s_waitcnt lgkmcnt(0)
v_mfma_f32_32x32x16_bf16 v[32:47], v[112:115], v[116:119], v[32:47]
ds_read_b128 v[128:131], v153 offset:16384
ds_read_b128 v[132:135], v157 offset:12288
v_mfma_f32_32x32x16_bf16 v[48:63], v[112:115], v[120:123], v[48:63]
ds_read_b128 v[136:139], v157 offset:16384
ds_read_b128 v[140:143], v157 offset:20480
v_mfma_f32_32x32x16_bf16 v[64:79], v[112:115], v[124:127], v[64:79]
s_waitcnt lgkmcnt(0)
s_waitcnt vmcnt(6)
s_barrier
v_mfma_f32_32x32x16_bf16 v[32:47], v[128:131], v[132:135], v[32:47]
ds_read_b128 v[112:115], v150 offset:32768
ds_read_b128 v[116:119], v154 offset:24576
s_add_u32 m0, s60, 16384
s_movk_i32 s23, 512
buffer_load_dwordx4 v144, s[40:43], s23 offen lds
v_mfma_f32_32x32x16_bf16 v[48:63], v[128:131], v[136:139], v[48:63]
ds_read_b128 v[120:123], v154 offset:28672
ds_read_b128 v[124:127], v154 offset:32768
s_add_u32 m0, s60, 17408
s_movk_i32 s23, 512
buffer_load_dwordx4 v145, s[40:43], s23 offen lds
v_mfma_f32_32x32x16_bf16 v[64:79], v[128:131], v[140:143], v[64:79]
s_waitcnt lgkmcnt(0)
v_mfma_f32_32x32x16_bf16 v[32:47], v[112:115], v[116:119], v[32:47]
ds_read_b128 v[128:131], v151 offset:32768
ds_read_b128 v[132:135], v155 offset:24576
s_add_u32 m0, s61, 12288
s_movk_i32 s23, 512
buffer_load_dwordx4 v146, s[44:47], s23 offen lds
v_mov_b32 v23, 2146435072
v_mul_u32_u24 v21, 1639, v0
v_lshrrev_b32 v21, 16, v21
v_mul_u32_u24 v20, 40, v21
v_sub_u32 v20, v0, v20
v_mfma_f32_32x32x16_bf16 v[48:63], v[112:115], v[120:123], v[48:63]
ds_read_b128 v[136:139], v155 offset:28672
ds_read_b128 v[140:143], v155 offset:32768
s_add_u32 m0, s61, 13312
s_movk_i32 s23, 512
buffer_load_dwordx4 v147, s[44:47], s23 offen lds
v_min_u32 v21, 9, v21
s_mul_i32 s64, s56, 40
v_add_u32 v22, s64, v20
v_min_u32 v22, 639, v22
v_mul_u32_u24 v22, 1280, v22
v_mfma_f32_32x32x16_bf16 v[64:79], v[112:115], v[124:127], v[64:79]
s_mul_i32 s64, s57, 80
v_lshl_add_u32 v22, v21, 3, v22
v_add_u32 v22, s64, v22
s_waitcnt lgkmcnt(0)
v_mfma_f32_32x32x16_bf16 v[32:47], v[128:131], v[132:135], v[32:47]
ds_read_b128 v[112:115], v152 offset:32768
ds_read_b128 v[116:119], v156 offset:24576
s_lshr_b32 s23, s61, 1
s_add_u32 m0, s23, 45056
s_movk_i32 s23, 512
buffer_load_dwordx4 v148, s[68:71], s23 offen lds
global_load_dwordx2 v[182:183], v22, s[14:15]
global_load_dwordx2 v[184:185], v22, s[16:17]
s_mul_i32 s64, s57, 10
v_add_u32 v26, s64, v21
v_lshrrev_b32 v27, 2, v26
v_mfma_f32_32x32x16_bf16 v[48:63], v[128:131], v[136:139], v[48:63]
ds_read_b128 v[120:123], v156 offset:28672
ds_read_b128 v[124:127], v156 offset:32768
s_add_u32 m0, s62, 16384
s_add_u32 s23, s3, 983040
buffer_load_dwordx4 v149, s[48:51], s23 offen lds
v_and_b32 v26, 3, v26
s_lshr_b32 s64, s56, 1
s_mul_i32 s64, s64, 60
v_add_u32 v27, s64, v27
v_mul_u32_u24 v27, 5, v27
v_mfma_f32_32x32x16_bf16 v[64:79], v[128:131], v[140:143], v[64:79]
s_and_b32 s64, s56, 1
s_mul_i32 s64, s64, 40
v_add_u32 v28, s64, v20
s_waitcnt lgkmcnt(0)
v_mfma_f32_32x32x16_bf16 v[32:47], v[112:115], v[116:119], v[32:47]
ds_read_b128 v[128:131], v153 offset:32768
ds_read_b128 v[132:135], v157 offset:24576
v_lshrrev_b32 v29, 4, v28
v_add_u32 v27, v27, v29
v_and_b32 v28, 15, v28
v_lshlrev_b32 v27, 6, v27
v_mfma_f32_32x32x16_bf16 v[48:63], v[112:115], v[120:123], v[48:63]
ds_read_b128 v[136:139], v157 offset:28672
ds_read_b128 v[140:143], v157 offset:32768
v_lshl_add_u32 v27, v26, 4, v27
v_add_u32 v27, v27, v28
v_lshlrev_b32 v27, 4, v27
v_add_u32 v181, 8388608, v27
v_mfma_f32_32x32x16_bf16 v[64:79], v[112:115], v[124:127], v[64:79]
v_cmp_gt_u32 vcc, 400, v0
s_nop 1
v_cndmask_b32 v181, v23, v181, vcc
v_lshlrev_b32 v186, 5, v21
v_add_u32 v186, 148480, v186
s_waitcnt lgkmcnt(0)
s_waitcnt vmcnt(8)
s_barrier
v_mfma_f32_32x32x16_bf16 v[32:47], v[128:131], v[132:135], v[32:47]
ds_read_b128 v[112:115], v150 offset:0
ds_read_b128 v[116:119], v154 offset:0
s_add_u32 m0, s60, 32768
s_movk_i32 s23, 640
buffer_load_dwordx4 v144, s[40:43], s23 offen lds
v_mfma_f32_32x32x16_bf16 v[48:63], v[128:131], v[136:139], v[48:63]
ds_read_b128 v[120:123], v154 offset:4096
ds_read_b128 v[124:127], v154 offset:8192
s_add_u32 m0, s60, 33792
s_movk_i32 s23, 640
buffer_load_dwordx4 v145, s[40:43], s23 offen lds
v_mfma_f32_32x32x16_bf16 v[64:79], v[128:131], v[140:143], v[64:79]
s_waitcnt lgkmcnt(0)
v_mfma_f32_32x32x16_bf16 v[32:47], v[112:115], v[116:119], v[32:47]
ds_read_b128 v[128:131], v151 offset:0
ds_read_b128 v[132:135], v155 offset:0
s_add_u32 m0, s61, 24576
s_movk_i32 s23, 640
buffer_load_dwordx4 v146, s[44:47], s23 offen lds
v_mfma_f32_32x32x16_bf16 v[48:63], v[112:115], v[120:123], v[48:63]
ds_read_b128 v[136:139], v155 offset:4096
ds_read_b128 v[140:143], v155 offset:8192
s_add_u32 m0, s61, 25600
s_movk_i32 s23, 640
buffer_load_dwordx4 v147, s[44:47], s23 offen lds
v_mfma_f32_32x32x16_bf16 v[64:79], v[112:115], v[124:127], v[64:79]
s_waitcnt lgkmcnt(0)
v_mfma_f32_32x32x16_bf16 v[32:47], v[128:131], v[132:135], v[32:47]
ds_read_b128 v[112:115], v152 offset:0
ds_read_b128 v[116:119], v156 offset:0
s_lshr_b32 s23, s61, 1
s_add_u32 m0, s23, 57344
s_movk_i32 s23, 640
buffer_load_dwordx4 v148, s[68:71], s23 offen lds
v_mfma_f32_32x32x16_bf16 v[48:63], v[128:131], v[136:139], v[48:63]
ds_read_b128 v[120:123], v156 offset:4096
ds_read_b128 v[124:127], v156 offset:8192
s_add_u32 m0, s62, 32768
s_add_u32 s23, s3, 1228800
buffer_load_dwordx4 v149, s[48:51], s23 offen lds
v_mfma_f32_32x32x16_bf16 v[64:79], v[128:131], v[140:143], v[64:79]
s_waitcnt lgkmcnt(0)
v_mfma_f32_32x32x16_bf16 v[32:47], v[112:115], v[116:119], v[32:47]
ds_read_b128 v[128:131], v153 offset:0
ds_read_b128 v[132:135], v157 offset:0
v_mfma_f32_32x32x16_bf16 v[48:63], v[112:115], v[120:123], v[48:63]
ds_read_b128 v[136:139], v157 offset:4096
ds_read_b128 v[140:143], v157 offset:8192
v_mfma_f32_32x32x16_bf16 v[64:79], v[112:115], v[124:127], v[64:79]
s_waitcnt lgkmcnt(0)
s_waitcnt vmcnt(6)
s_barrier
v_mfma_f32_32x32x16_bf16 v[32:47], v[128:131], v[132:135], v[32:47]
ds_read_b128 v[112:115], v150 offset:16384
ds_read_b128 v[116:119], v154 offset:12288
s_add_u32 m0, s60, 0
s_movk_i32 s23, 768
buffer_load_dwordx4 v144, s[40:43], s23 offen lds
v_mov_b32 v200, 0
global_load_dword v196, v200, s[34:35] sc1
v_lshlrev_b32 v176, 16, v176
v_lshlrev_b32 v177, 16, v177
v_mfma_f32_32x32x16_bf16 v[48:63], v[128:131], v[136:139], v[48:63]
ds_read_b128 v[120:123], v154 offset:16384
ds_read_b128 v[124:127], v154 offset:20480
s_add_u32 m0, s60, 1024
s_movk_i32 s23, 768
buffer_load_dwordx4 v145, s[40:43], s23 offen lds
v_lshlrev_b32 v178, 16, v178
v_mul_f32 v178, s76, v178
v_exp_f32 v178, v178
s_nop 0
v_cvt_pk_bf16_f32 v178, v178, v178
v_mfma_f32_32x32x16_bf16 v[64:79], v[128:131], v[140:143], v[64:79]
v_lshlrev_b32 v178, 16, v178
v_mul_f32 v200, v178, v176
v_mul_f32 v201, v178, v177
s_waitcnt lgkmcnt(0)
v_mfma_f32_32x32x16_bf16 v[32:47], v[112:115], v[116:119], v[32:47]
ds_read_b128 v[128:131], v151 offset:16384
ds_read_b128 v[132:135], v155 offset:12288
s_add_u32 m0, s61, 0
s_movk_i32 s23, 768
buffer_load_dwordx4 v146, s[44:47], s23 offen lds
v_mul_f32 v200, s76, v200
v_exp_f32 v200, v200
v_mul_f32 v201, 0.15915494, v201
v_fract_f32 v201, v201
v_mfma_f32_32x32x16_bf16 v[48:63], v[112:115], v[120:123], v[48:63]
ds_read_b128 v[136:139], v155 offset:16384
ds_read_b128 v[140:143], v155 offset:20480
s_add_u32 m0, s61, 1024
s_movk_i32 s23, 768
buffer_load_dwordx4 v147, s[44:47], s23 offen lds
v_cos_f32 v202, v201
v_sin_f32 v203, v201
v_mul_f32 v204, v200, v202
v_mul_f32 v205, v200, v203
v_mfma_f32_32x32x16_bf16 v[64:79], v[112:115], v[124:127], v[64:79]
v_mul_f32 v216, v205, v205
v_mul_f32 v207, v204, v205
v_fma_f32 v206, v204, v204, -v216
s_waitcnt lgkmcnt(0)
v_mfma_f32_32x32x16_bf16 v[32:47], v[128:131], v[132:135], v[32:47]
ds_read_b128 v[112:115], v152 offset:16384
ds_read_b128 v[116:119], v156 offset:12288
s_lshr_b32 s23, s61, 1
s_add_u32 m0, s23, 32768
s_movk_i32 s23, 768
buffer_load_dwordx4 v148, s[68:71], s23 offen lds
v_add_f32 v207, v207, v207
v_mul_f32 v216, v207, v207
v_mul_f32 v209, v206, v207
v_fma_f32 v208, v206, v206, -v216
v_mfma_f32_32x32x16_bf16 v[48:63], v[128:131], v[136:139], v[48:63]
ds_read_b128 v[120:123], v156 offset:16384
ds_read_b128 v[124:127], v156 offset:20480
s_add_u32 m0, s62, 0
s_add_u32 s23, s3, 1474560
buffer_load_dwordx4 v149, s[48:51], s23 offen lds
v_add_f32 v209, v209, v209
v_mul_f32 v216, v209, v209
v_mul_f32 v211, v208, v209
v_fma_f32 v210, v208, v208, -v216
v_mfma_f32_32x32x16_bf16 v[64:79], v[128:131], v[140:143], v[64:79]
v_add_f32 v211, v211, v211
v_mul_f32 v216, v211, v211
v_mul_f32 v213, v210, v211
s_waitcnt lgkmcnt(0)
v_mfma_f32_32x32x16_bf16 v[32:47], v[112:115], v[116:119], v[32:47]
ds_read_b128 v[128:131], v153 offset:16384
ds_read_b128 v[132:135], v157 offset:12288
v_fma_f32 v212, v210, v210, -v216
v_add_f32 v213, v213, v213
v_mul_f32 v216, v213, v213
v_mul_f32 v97, v212, v213
v_mfma_f32_32x32x16_bf16 v[48:63], v[112:115], v[120:123], v[48:63]
ds_read_b128 v[136:139], v157 offset:16384
ds_read_b128 v[140:143], v157 offset:20480
v_fma_f32 v96, v212, v212, -v216
v_add_f32 v97, v97, v97
v_mul_f32 v216, v97, v97
v_mul_f32 v215, v96, v97
v_mfma_f32_32x32x16_bf16 v[64:79], v[112:115], v[124:127], v[64:79]
v_fma_f32 v214, v96, v96, -v216
v_add_f32 v215, v215, v215
v_mul_f32 v216, v215, v215
s_waitcnt lgkmcnt(0)
s_waitcnt vmcnt(6)
s_barrier
v_mfma_f32_32x32x16_bf16 v[32:47], v[128:131], v[132:135], v[32:47]
ds_read_b128 v[112:115], v150 offset:32768
ds_read_b128 v[116:119], v154 offset:24576
s_add_u32 m0, s60, 16384
s_movk_i32 s23, 896
buffer_load_dwordx4 v144, s[40:43], s23 offen lds
v_mul_f32 v99, v214, v215
v_fma_f32 v98, v214, v214, -v216
v_add_f32 v99, v99, v99
v_mov_b32 v100, v204
v_mfma_f32_32x32x16_bf16 v[48:63], v[128:131], v[136:139], v[48:63]
ds_read_b128 v[120:123], v154 offset:28672
ds_read_b128 v[124:127], v154 offset:32768
s_add_u32 m0, s60, 17408
s_movk_i32 s23, 896
buffer_load_dwordx4 v145, s[40:43], s23 offen lds
v_mov_b32 v106, v204
s_nop 1
v_permlane32_swap_b32 v100, v106
v_mov_b32 v101, v205
v_mov_b32 v107, v205
v_mfma_f32_32x32x16_bf16 v[64:79], v[128:131], v[140:143], v[64:79]
s_nop 0
v_permlane32_swap_b32 v101, v107
v_mov_b32 v102, v210
v_mov_b32 v108, v210
s_waitcnt lgkmcnt(0)
v_mfma_f32_32x32x16_bf16 v[32:47], v[112:115], v[116:119], v[32:47]
ds_read_b128 v[128:131], v151 offset:32768
ds_read_b128 v[132:135], v155 offset:24576
s_add_u32 m0, s61, 12288
s_movk_i32 s23, 896
buffer_load_dwordx4 v146, s[44:47], s23 offen lds
v_permlane32_swap_b32 v102, v108
v_mov_b32 v103, v211
v_mov_b32 v109, v211
s_nop 1
v_permlane32_swap_b32 v103, v109
v_mfma_f32_32x32x16_bf16 v[48:63], v[112:115], v[120:123], v[48:63]
ds_read_b128 v[136:139], v155 offset:28672
ds_read_b128 v[140:143], v155 offset:32768
s_add_u32 m0, s61, 13312
s_movk_i32 s23, 896
buffer_load_dwordx4 v147, s[44:47], s23 offen lds
v_mov_b32 v104, v212
v_mov_b32 v110, v212
s_nop 1
v_permlane32_swap_b32 v104, v110
v_mov_b32 v105, v213
v_mfma_f32_32x32x16_bf16 v[64:79], v[112:115], v[124:127], v[64:79]
v_mov_b32 v111, v213
s_nop 1
v_permlane32_swap_b32 v105, v111
v_add_f32 v200, -1.0, v204
s_waitcnt lgkmcnt(0)
v_mfma_f32_32x32x16_bf16 v[32:47], v[128:131], v[132:135], v[32:47]
ds_read_b128 v[112:115], v152 offset:32768
ds_read_b128 v[116:119], v156 offset:24576
s_lshr_b32 s23, s61, 1
s_add_u32 m0, s23, 45056
s_movk_i32 s23, 896
buffer_load_dwordx4 v148, s[68:71], s23 offen lds
v_mul_f32 v201, v176, v176
v_fma_f32 v201, v177, v177, v201
v_rcp_f32 v201, v201
s_nop 0
v_add_f32 v201, v201, v201
v_mfma_f32_32x32x16_bf16 v[48:63], v[128:131], v[136:139], v[48:63]
ds_read_b128 v[120:123], v156 offset:28672
ds_read_b128 v[124:127], v156 offset:32768
s_add_u32 m0, s62, 16384
s_add_u32 s23, s3, 1720320
buffer_load_dwordx4 v149, s[48:51], s23 offen lds
v_mul_f32 v202, v200, v176
v_fma_f32 v202, v205, v177, v202
v_mul_f32 v202, v202, v201
v_mul_f32 v203, v205, v176
v_mfma_f32_32x32x16_bf16 v[64:79], v[128:131], v[140:143], v[64:79]
v_fma_f32 v203, -v200, v177, v203
v_mul_f32 v203, v203, v201
v_lshlrev_b32 v200, 3, v3
s_waitcnt lgkmcnt(0)
v_mfma_f32_32x32x16_bf16 v[32:47], v[112:115], v[116:119], v[32:47]
ds_read_b128 v[128:131], v153 offset:32768
ds_read_b128 v[132:135], v157 offset:24576
v_add_u32 v200, 148480, v200
ds_write_b64 v200, v[202:203]
v_mfma_f32_32x32x16_bf16 v[48:63], v[112:115], v[120:123], v[48:63]
ds_read_b128 v[136:139], v157 offset:28672
ds_read_b128 v[140:143], v157 offset:32768
v_mov_b32 v202, 0
v_mov_b32 v203, 0
v_mfma_f32_32x32x16_bf16 v[64:79], v[112:115], v[124:127], v[64:79]
s_waitcnt lgkmcnt(0)
s_waitcnt vmcnt(6)
s_barrier
v_mfma_f32_32x32x16_bf16 v[32:47], v[128:131], v[132:135], v[32:47]
ds_read_b128 v[112:115], v150 offset:0
ds_read_b128 v[116:119], v154 offset:0
s_add_u32 m0, s60, 32768
s_movk_i32 s23, 1024
buffer_load_dwordx4 v144, s[40:43], s23 offen lds
ds_read_b128 v[200:203], v186
v_mfma_f32_32x32x16_bf16 v[48:63], v[128:131], v[136:139], v[48:63]
ds_read_b128 v[120:123], v154 offset:4096
ds_read_b128 v[124:127], v154 offset:8192
s_add_u32 m0, s60, 33792
s_movk_i32 s23, 1024
buffer_load_dwordx4 v145, s[40:43], s23 offen lds
ds_read_b128 v[204:207], v186 offset:16
v_mfma_f32_32x32x16_bf16 v[64:79], v[128:131], v[140:143], v[64:79]
s_waitcnt lgkmcnt(0)
v_mfma_f32_32x32x16_bf16 v[32:47], v[112:115], v[116:119], v[32:47]
ds_read_b128 v[128:131], v151 offset:0
ds_read_b128 v[132:135], v155 offset:0
s_add_u32 m0, s61, 24576
s_movk_i32 s23, 1024
buffer_load_dwordx4 v146, s[44:47], s23 offen lds
v_mfma_f32_32x32x16_bf16 v[48:63], v[112:115], v[120:123], v[48:63]
ds_read_b128 v[136:139], v155 offset:4096
ds_read_b128 v[140:143], v155 offset:8192
s_add_u32 m0, s61, 25600
s_movk_i32 s23, 1024
buffer_load_dwordx4 v147, s[44:47], s23 offen lds
v_mfma_f32_32x32x16_bf16 v[64:79], v[112:115], v[124:127], v[64:79]
s_waitcnt lgkmcnt(0)
v_mfma_f32_32x32x16_bf16 v[32:47], v[128:131], v[132:135], v[32:47]
ds_read_b128 v[112:115], v152 offset:0
ds_read_b128 v[116:119], v156 offset:0
s_lshr_b32 s23, s61, 1
s_add_u32 m0, s23, 57344
s_movk_i32 s23, 1024
buffer_load_dwordx4 v148, s[68:71], s23 offen lds
v_readfirstlane_b32 s63, v196
v_mfma_f32_32x32x16_bf16 v[48:63], v[128:131], v[136:139], v[48:63]
ds_read_b128 v[120:123], v156 offset:4096
ds_read_b128 v[124:127], v156 offset:8192
s_add_u32 m0, s62, 32768
s_add_u32 s23, s3, 1966080
buffer_load_dwordx4 v149, s[48:51], s23 offen lds
v_mfma_f32_32x32x16_bf16 v[64:79], v[128:131], v[140:143], v[64:79]
s_waitcnt lgkmcnt(0)
v_mfma_f32_32x32x16_bf16 v[32:47], v[112:115], v[116:119], v[32:47]
ds_read_b128 v[128:131], v153 offset:0
ds_read_b128 v[132:135], v157 offset:0
v_lshlrev_b32 v208, 16, v182
v_lshlrev_b32 v209, 16, v184
v_mul_f32 v210, v208, v200
v_fma_f32 v210, -v209, v201, v210
v_mul_f32 v211, v208, v201
v_mfma_f32_32x32x16_bf16 v[48:63], v[112:115], v[120:123], v[48:63]
ds_read_b128 v[136:139], v157 offset:4096
ds_read_b128 v[140:143], v157 offset:8192
v_fma_f32 v211, v209, v200, v211
v_cvt_pk_bf16_f32 v212, v210, -v211
v_and_b32 v208, 0xffff0000, v182
v_and_b32 v209, 0xffff0000, v184
v_mul_f32 v210, v208, v202
v_mfma_f32_32x32x16_bf16 v[64:79], v[112:115], v[124:127], v[64:79]
v_fma_f32 v210, -v209, v203, v210
v_mul_f32 v211, v208, v203
v_fma_f32 v211, v209, v202, v211
v_cvt_pk_bf16_f32 v213, v210, -v211
v_lshlrev_b32 v208, 16, v183
s_waitcnt lgkmcnt(0)
s_waitcnt vmcnt(6)
s_barrier
v_mfma_f32_32x32x16_bf16 v[32:47], v[128:131], v[132:135], v[32:47]
ds_read_b128 v[112:115], v150 offset:16384
ds_read_b128 v[116:119], v154 offset:12288
s_add_u32 m0, s60, 0
s_movk_i32 s23, 1152
buffer_load_dwordx4 v144, s[40:43], s23 offen lds
v_lshlrev_b32 v209, 16, v185
v_mul_f32 v210, v208, v204
v_fma_f32 v210, -v209, v205, v210
v_mul_f32 v211, v208, v205
v_fma_f32 v211, v209, v204, v211
v_mfma_f32_32x32x16_bf16 v[48:63], v[128:131], v[136:139], v[48:63]
ds_read_b128 v[120:123], v154 offset:16384
ds_read_b128 v[124:127], v154 offset:20480
s_add_u32 m0, s60, 1024
s_movk_i32 s23, 1152
buffer_load_dwordx4 v145, s[40:43], s23 offen lds
v_cvt_pk_bf16_f32 v214, v210, -v211
v_and_b32 v208, 0xffff0000, v183
v_and_b32 v209, 0xffff0000, v185
v_mul_f32 v210, v208, v206
v_fma_f32 v210, -v209, v207, v210
v_mfma_f32_32x32x16_bf16 v[64:79], v[128:131], v[140:143], v[64:79]
v_mul_f32 v211, v208, v207
v_fma_f32 v211, v209, v206, v211
v_cvt_pk_bf16_f32 v215, v210, -v211
buffer_store_dwordx4 v[212:215], v181, s[52:55], 0 offen sc1
s_waitcnt lgkmcnt(0)
v_mfma_f32_32x32x16_bf16 v[32:47], v[112:115], v[116:119], v[32:47]
ds_read_b128 v[128:131], v151 offset:16384
ds_read_b128 v[132:135], v155 offset:12288
s_add_u32 m0, s61, 0
s_movk_i32 s23, 1152
buffer_load_dwordx4 v146, s[44:47], s23 offen lds
v_mfma_f32_32x32x16_bf16 v[48:63], v[112:115], v[120:123], v[48:63]
ds_read_b128 v[136:139], v155 offset:16384
ds_read_b128 v[140:143], v155 offset:20480
s_add_u32 m0, s61, 1024
s_movk_i32 s23, 1152
buffer_load_dwordx4 v147, s[44:47], s23 offen lds
v_mfma_f32_32x32x16_bf16 v[64:79], v[112:115], v[124:127], v[64:79]
s_waitcnt lgkmcnt(0)
v_mfma_f32_32x32x16_bf16 v[32:47], v[128:131], v[132:135], v[32:47]
ds_read_b128 v[112:115], v152 offset:16384
ds_read_b128 v[116:119], v156 offset:12288
s_lshr_b32 s23, s61, 1
s_add_u32 m0, s23, 32768
s_movk_i32 s23, 1152
buffer_load_dwordx4 v148, s[68:71], s23 offen lds
v_mfma_f32_32x32x16_bf16 v[48:63], v[128:131], v[136:139], v[48:63]
ds_read_b128 v[120:123], v156 offset:16384
ds_read_b128 v[124:127], v156 offset:20480
s_add_u32 m0, s62, 0
s_add_u32 s23, s3, 2211840
buffer_load_dwordx4 v149, s[48:51], s23 offen lds
v_mfma_f32_32x32x16_bf16 v[64:79], v[128:131], v[140:143], v[64:79]
s_waitcnt lgkmcnt(0)
v_mfma_f32_32x32x16_bf16 v[32:47], v[112:115], v[116:119], v[32:47]
ds_read_b128 v[128:131], v153 offset:16384
ds_read_b128 v[132:135], v157 offset:12288
v_mfma_f32_32x32x16_bf16 v[48:63], v[112:115], v[120:123], v[48:63]
ds_read_b128 v[136:139], v157 offset:16384
ds_read_b128 v[140:143], v157 offset:20480
v_mfma_f32_32x32x16_bf16 v[64:79], v[112:115], v[124:127], v[64:79]
s_waitcnt lgkmcnt(0)
s_waitcnt vmcnt(7)
s_barrier
v_mfma_f32_32x32x16_bf16 v[32:47], v[128:131], v[132:135], v[32:47]
ds_read_b128 v[112:115], v150 offset:32768
ds_read_b128 v[116:119], v154 offset:24576
v_mfma_f32_32x32x16_bf16 v[48:63], v[128:131], v[136:139], v[48:63]
ds_read_b128 v[120:123], v154 offset:28672
ds_read_b128 v[124:127], v154 offset:32768
v_mfma_f32_32x32x16_bf16 v[64:79], v[128:131], v[140:143], v[64:79]
s_waitcnt lgkmcnt(0)
v_mfma_f32_32x32x16_bf16 v[32:47], v[112:115], v[116:119], v[32:47]
ds_read_b128 v[128:131], v151 offset:32768
ds_read_b128 v[132:135], v155 offset:24576
v_mfma_f32_32x32x16_bf16 v[48:63], v[112:115], v[120:123], v[48:63]
ds_read_b128 v[136:139], v155 offset:28672
ds_read_b128 v[140:143], v155 offset:32768
v_mfma_f32_32x32x16_bf16 v[64:79], v[112:115], v[124:127], v[64:79]
s_waitcnt lgkmcnt(0)
v_mfma_f32_32x32x16_bf16 v[32:47], v[128:131], v[132:135], v[32:47]
ds_read_b128 v[112:115], v152 offset:32768
ds_read_b128 v[116:119], v156 offset:24576
v_mfma_f32_32x32x16_bf16 v[48:63], v[128:131], v[136:139], v[48:63]
ds_read_b128 v[120:123], v156 offset:28672
ds_read_b128 v[124:127], v156 offset:32768
v_mfma_f32_32x32x16_bf16 v[64:79], v[128:131], v[140:143], v[64:79]
s_waitcnt lgkmcnt(0)
v_mfma_f32_32x32x16_bf16 v[32:47], v[112:115], v[116:119], v[32:47]
ds_read_b128 v[128:131], v153 offset:32768
ds_read_b128 v[132:135], v157 offset:24576
v_mfma_f32_32x32x16_bf16 v[48:63], v[112:115], v[120:123], v[48:63]
ds_read_b128 v[136:139], v157 offset:28672
ds_read_b128 v[140:143], v157 offset:32768
v_mfma_f32_32x32x16_bf16 v[64:79], v[112:115], v[124:127], v[64:79]
s_waitcnt lgkmcnt(0)
s_waitcnt vmcnt(0)
s_barrier
s_cmp_lg_u32 s63, 0
s_cbranch_scc1 L_nonce_ok_X
s_mov_b32 s22, 0
L_nonce_X:
v_mov_b32 v20, 0
global_load_dword v21, v20, s[34:35] sc1
s_waitcnt vmcnt(0)
v_readfirstlane_b32 s63, v21
s_add_u32 s22, s22, 1
s_cmp_ge_u32 s22, 0x100000
s_cbranch_scc1 L_nonce_ok_X
s_cmp_eq_u32 s63, 0
s_cbranch_scc1 L_nonce_X
L_nonce_ok_X:
s_cmp_lg_u32 s58, 0
s_cbranch_scc1 L_f0done
s_lshl_b32 s64, s56, 4
s_add_u32 s64, s64, s57
s_lshl_b32 s64, s64, 6
s_add_u32 s64, s64, 14745600
v_lshlrev_b32 v21, 2, v1
v_mov_b32 v20, 2146435072
v_cmp_gt_u32 vcc, 16, v1
s_nop 1
v_cndmask_b32 v20, v20, v21, vcc
v_mov_b32 v21, s63
buffer_store_dword v21, v20, s[52:55], s64 offen sc1
L_f0done:
v_mfma_f32_32x32x16_bf16 v[32:47], v[128:131], v[132:135], v[32:47]
ds_read_b128 v[112:115], v150 offset:0
ds_read_b128 v[116:119], v154 offset:0
v_mfma_f32_32x32x16_bf16 v[48:63], v[128:131], v[136:139], v[48:63]
ds_read_b128 v[120:123], v154 offset:4096
ds_read_b128 v[124:127], v154 offset:8192
v_mfma_f32_32x32x16_bf16 v[64:79], v[128:131], v[140:143], v[64:79]
s_waitcnt lgkmcnt(0)
v_mfma_f32_32x32x16_bf16 v[32:47], v[112:115], v[116:119], v[32:47]
ds_read_b128 v[128:131], v151 offset:0
ds_read_b128 v[132:135], v155 offset:0
v_mfma_f32_32x32x16_bf16 v[48:63], v[112:115], v[120:123], v[48:63]
ds_read_b128 v[136:139], v155 offset:4096
ds_read_b128 v[140:143], v155 offset:8192
v_mfma_f32_32x32x16_bf16 v[64:79], v[112:115], v[124:127], v[64:79]
s_waitcnt lgkmcnt(0)
v_mfma_f32_32x32x16_bf16 v[32:47], v[128:131], v[132:135], v[32:47]
ds_read_b128 v[112:115], v152 offset:0
ds_read_b128 v[116:119], v156 offset:0
v_mfma_f32_32x32x16_bf16 v[48:63], v[128:131], v[136:139], v[48:63]
ds_read_b128 v[120:123], v156 offset:4096
ds_read_b128 v[124:127], v156 offset:8192
v_mfma_f32_32x32x16_bf16 v[64:79], v[128:131], v[140:143], v[64:79]
s_waitcnt lgkmcnt(0)
v_mfma_f32_32x32x16_bf16 v[32:47], v[112:115], v[116:119], v[32:47]
ds_read_b128 v[128:131], v153 offset:0
ds_read_b128 v[132:135], v157 offset:0
v_mfma_f32_32x32x16_bf16 v[48:63], v[112:115], v[120:123], v[48:63]
ds_read_b128 v[136:139], v157 offset:4096
ds_read_b128 v[140:143], v157 offset:8192
v_mfma_f32_32x32x16_bf16 v[64:79], v[112:115], v[124:127], v[64:79]
s_waitcnt lgkmcnt(0)
v_mfma_f32_32x32x16_bf16 v[32:47], v[128:131], v[132:135], v[32:47]
v_mfma_f32_32x32x16_bf16 v[48:63], v[128:131], v[136:139], v[48:63]
v_mfma_f32_32x32x16_bf16 v[64:79], v[128:131], v[140:143], v[64:79]
s_nop 11
v_mov_b32_dpp v80, v64 row_shl:8 row_mask:0xf bank_mask:0xf
v_mov_b32_dpp v81, v65 row_shl:8 row_mask:0xf bank_mask:0xf
v_mov_b32_dpp v82, v66 row_shl:8 row_mask:0xf bank_mask:0xf
v_mov_b32_dpp v83, v67 row_shl:8 row_mask:0xf bank_mask:0xf
v_mov_b32_dpp v84, v68 row_shl:8 row_mask:0xf bank_mask:0xf
v_mov_b32_dpp v85, v69 row_shl:8 row_mask:0xf bank_mask:0xf
v_mov_b32_dpp v86, v70 row_shl:8 row_mask:0xf bank_mask:0xf
v_mov_b32_dpp v87, v71 row_shl:8 row_mask:0xf bank_mask:0xf
v_mov_b32_dpp v88, v72 row_shl:8 row_mask:0xf bank_mask:0xf
v_mov_b32_dpp v89, v73 row_shl:8 row_mask:0xf bank_mask:0xf
v_mov_b32_dpp v90, v74 row_shl:8 row_mask:0xf bank_mask:0xf
v_mov_b32_dpp v91, v75 row_shl:8 row_mask:0xf bank_mask:0xf
v_mov_b32_dpp v92, v76 row_shl:8 row_mask:0xf bank_mask:0xf
v_mov_b32_dpp v93, v77 row_shl:8 row_mask:0xf bank_mask:0xf
v_mov_b32_dpp v94, v78 row_shl:8 row_mask:0xf bank_mask:0xf
v_mov_b32_dpp v95, v79 row_shl:8 row_mask:0xf bank_mask:0xf
v_pk_fma_f32 v[20:21], v[100:101], v[32:33], v[34:35] op_sel_hi:[0,1,1]
v_pk_fma_f32 v[22:23], v[100:101], v[48:49], v[50:51] op_sel_hi:[0,1,1]
v_pk_fma_f32 v[20:21], v[100:101], v[48:49], v[20:21] op_sel:[1,0,0] op_sel_hi:[1,1,1] neg_lo:[1,0,0] neg_hi:[1,0,0]
v_pk_fma_f32 v[22:23], v[100:101], v[32:33], v[22:23] op_sel:[1,0,0] op_sel_hi:[1,1,1]
v_pk_fma_f32 v[24:25], v[100:101], v[20:21], v[36:37] op_sel_hi:[0,1,1]
v_pk_fma_f32 v[26:27], v[100:101], v[22:23], v[52:53] op_sel_hi:[0,1,1]
v_pk_fma_f32 v[24:25], v[100:101], v[22:23], v[24:25] op_sel:[1,0,0] op_sel_hi:[1,1,1] neg_lo:[1,0,0] neg_hi:[1,0,0]
v_pk_fma_f32 v[26:27], v[100:101], v[20:21], v[26:27] op_sel:[1,0,0] op_sel_hi:[1,1,1]
v_pk_fma_f32 v[20:21], v[100:101], v[24:25], v[38:39] op_sel_hi:[0,1,1]
v_pk_fma_f32 v[22:23], v[100:101], v[26:27], v[54:55] op_sel_hi:[0,1,1]
v_pk_fma_f32 v[20:21], v[100:101], v[26:27], v[20:21] op_sel:[1,0,0] op_sel_hi:[1,1,1] neg_lo:[1,0,0] neg_hi:[1,0,0]
v_pk_fma_f32 v[22:23], v[100:101], v[24:25], v[22:23] op_sel:[1,0,0] op_sel_hi:[1,1,1]
v_pk_fma_f32 v[24:25], v[100:101], v[20:21], v[40:41] op_sel_hi:[0,1,1]
v_pk_fma_f32 v[26:27], v[100:101], v[22:23], v[56:57] op_sel_hi:[0,1,1]
v_pk_fma_f32 v[24:25], v[100:101], v[22:23], v[24:25] op_sel:[1,0,0] op_sel_hi:[1,1,1] neg_lo:[1,0,0] neg_hi:[1,0,0]
v_pk_fma_f32 v[26:27], v[100:101], v[20:21], v[26:27] op_sel:[1,0,0] op_sel_hi:[1,1,1]
v_pk_fma_f32 v[20:21], v[100:101], v[24:25], v[42:43] op_sel_hi:[0,1,1]
v_pk_fma_f32 v[22:23], v[100:101], v[26:27], v[58:59] op_sel_hi:[0,1,1]
v_pk_fma_f32 v[20:21], v[100:101], v[26:27], v[20:21] op_sel:[1,0,0] op_sel_hi:[1,1,1] neg_lo:[1,0,0] neg_hi:[1,0,0]
v_pk_fma_f32 v[22:23], v[100:101], v[24:25], v[22:23] op_sel:[1,0,0] op_sel_hi:[1,1,1]
v_pk_fma_f32 v[24:25], v[100:101], v[20:21], v[44:45] op_sel_hi:[0,1,1]
v_pk_fma_f32 v[26:27], v[100:101], v[22:23], v[60:61] op_sel_hi:[0,1,1]
v_pk_fma_f32 v[24:25], v[100:101], v[22:23], v[24:25] op_sel:[1,0,0] op_sel_hi:[1,1,1] neg_lo:[1,0,0] neg_hi:[1,0,0]
v_pk_fma_f32 v[26:27], v[100:101], v[20:21], v[26:27] op_sel:[1,0,0] op_sel_hi:[1,1,1]
v_pk_fma_f32 v[20:21], v[100:101], v[24:25], v[46:47] op_sel_hi:[0,1,1]
v_pk_fma_f32 v[22:23], v[100:101], v[26:27], v[62:63] op_sel_hi:[0,1,1]
v_pk_fma_f32 v[20:21], v[100:101], v[26:27], v[20:21] op_sel:[1,0,0] op_sel_hi:[1,1,1] neg_lo:[1,0,0] neg_hi:[1,0,0]
v_pk_fma_f32 v[22:23], v[100:101], v[24:25], v[22:23] op_sel:[1,0,0] op_sel_hi:[1,1,1]
v_fma_f32 v24, v102, v20, v21
v_fma_f32 v25, v102, v22, v23
v_fma_f32 v24, -v103, v22, v24
v_fma_f32 v25, v103, v20, v25
v_mov_b32 v4, v20
v_mov_b32 v5, v22
v_mov_b32 v6, v24
v_mov_b32 v26, v24
s_nop 1
v_permlane32_swap_b32 v6, v26
v_mov_b32 v7, v25
v_mov_b32 v27, v25
s_nop 1
v_permlane32_swap_b32 v7, v27
v_fma_f32 v30, v104, v6, v26
v_fma_f32 v31, v104, v7, v27
v_fma_f32 v30, -v105, v7, v30
v_fma_f32 v31, v105, v6, v31
v_mov_b32 v12, v30
v_mov_b32 v13, v31
v_pk_fma_f32 v[20:21], v[106:107], v[64:65], v[66:67] op_sel_hi:[0,1,1]
v_pk_fma_f32 v[22:23], v[106:107], v[80:81], v[82:83] op_sel_hi:[0,1,1]
v_pk_fma_f32 v[20:21], v[106:107], v[80:81], v[20:21] op_sel:[1,0,0] op_sel_hi:[1,1,1] neg_lo:[1,0,0] neg_hi:[1,0,0]
v_pk_fma_f32 v[22:23], v[106:107], v[64:65], v[22:23] op_sel:[1,0,0] op_sel_hi:[1,1,1]
v_pk_fma_f32 v[24:25], v[106:107], v[20:21], v[68:69] op_sel_hi:[0,1,1]
v_pk_fma_f32 v[26:27], v[106:107], v[22:23], v[84:85] op_sel_hi:[0,1,1]
v_pk_fma_f32 v[24:25], v[106:107], v[22:23], v[24:25] op_sel:[1,0,0] op_sel_hi:[1,1,1] neg_lo:[1,0,0] neg_hi:[1,0,0]
v_pk_fma_f32 v[26:27], v[106:107], v[20:21], v[26:27] op_sel:[1,0,0] op_sel_hi:[1,1,1]
v_pk_fma_f32 v[20:21], v[106:107], v[24:25], v[70:71] op_sel_hi:[0,1,1]
v_pk_fma_f32 v[22:23], v[106:107], v[26:27], v[86:87] op_sel_hi:[0,1,1]
v_pk_fma_f32 v[20:21], v[106:107], v[26:27], v[20:21] op_sel:[1,0,0] op_sel_hi:[1,1,1] neg_lo:[1,0,0] neg_hi:[1,0,0]
v_pk_fma_f32 v[22:23], v[106:107], v[24:25], v[22:23] op_sel:[1,0,0] op_sel_hi:[1,1,1]
v_pk_fma_f32 v[24:25], v[106:107], v[20:21], v[72:73] op_sel_hi:[0,1,1]
v_pk_fma_f32 v[26:27], v[106:107], v[22:23], v[88:89] op_sel_hi:[0,1,1]
v_pk_fma_f32 v[24:25], v[106:107], v[22:23], v[24:25] op_sel:[1,0,0] op_sel_hi:[1,1,1] neg_lo:[1,0,0] neg_hi:[1,0,0]
v_pk_fma_f32 v[26:27], v[106:107], v[20:21], v[26:27] op_sel:[1,0,0] op_sel_hi:[1,1,1]
v_pk_fma_f32 v[20:21], v[106:107], v[24:25], v[74:75] op_sel_hi:[0,1,1]
v_pk_fma_f32 v[22:23], v[106:107], v[26:27], v[90:91] op_sel_hi:[0,1,1]
v_pk_fma_f32 v[20:21], v[106:107], v[26:27], v[20:21] op_sel:[1,0,0] op_sel_hi:[1,1,1] neg_lo:[1,0,0] neg_hi:[1,0,0]
v_pk_fma_f32 v[22:23], v[106:107], v[24:25], v[22:23] op_sel:[1,0,0] op_sel_hi:[1,1,1]
v_pk_fma_f32 v[24:25], v[106:107], v[20:21], v[76:77] op_sel_hi:[0,1,1]
v_pk_fma_f32 v[26:27], v[106:107], v[22:23], v[92:93] op_sel_hi:[0,1,1]
v_pk_fma_f32 v[24:25], v[106:107], v[22:23], v[24:25] op_sel:[1,0,0] op_sel_hi:[1,1,1] neg_lo:[1,0,0] neg_hi:[1,0,0]
v_pk_fma_f32 v[26:27], v[106:107], v[20:21], v[26:27] op_sel:[1,0,0] op_sel_hi:[1,1,1]
v_pk_fma_f32 v[20:21], v[106:107], v[24:25], v[78:79] op_sel_hi:[0,1,1]
v_pk_fma_f32 v[22:23], v[106:107], v[26:27], v[94:95] op_sel_hi:[0,1,1]
v_pk_fma_f32 v[20:21], v[106:107], v[26:27], v[20:21] op_sel:[1,0,0] op_sel_hi:[1,1,1] neg_lo:[1,0,0] neg_hi:[1,0,0]
v_pk_fma_f32 v[22:23], v[106:107], v[24:25], v[22:23] op_sel:[1,0,0] op_sel_hi:[1,1,1]
v_fma_f32 v24, v108, v20, v21
v_fma_f32 v25, v108, v22, v23
v_fma_f32 v24, -v109, v22, v24
v_fma_f32 v25, v109, v20, v25
v_mov_b32 v8, v20
v_mov_b32 v9, v22
v_mov_b32 v10, v24
v_mov_b32 v26, v24
s_nop 1
v_permlane32_swap_b32 v10, v26
v_mov_b32 v11, v25
v_mov_b32 v27, v25
s_nop 1
v_permlane32_swap_b32 v11, v27
v_fma_f32 v30, v110, v10, v26
v_fma_f32 v31, v110, v11, v27
v_fma_f32 v30, -v111, v11, v30
v_fma_f32 v31, v111, v10, v31
v_cmp_eq_u32 vcc, 1, v2
s_nop 1
v_cndmask_b32 v30, v12, v30, vcc
v_cndmask_b32 v31, v13, v31, vcc
v_lshlrev_b32 v24, 3, v3
s_mul_i32 s64, s59, 320
v_add_u32 v24, s64, v24
v_add_u32 v24, 148800, v24
v_cmp_gt_u32 vcc, 40, v1
s_and_saveexec_b64 s[22:23], vcc
ds_write_b64 v24, v[30:31]
s_mov_b64 exec, s[22:23]
s_waitcnt lgkmcnt(0)
v_mov_b32 v20, 153516
v_mov_b32 v21, 1
v_cmp_eq_u32 vcc, 0, v1
s_and_saveexec_b64 s[22:23], vcc
ds_add_rtn_u32 v22, v20, v21
s_mov_b64 exec, s[22:23]
s_waitcnt lgkmcnt(0)
v_readfirstlane_b32 s66, v22
s_cmp_lg_u32 s59, 0
s_cbranch_scc1 L_notx0
v_mov_b32 v20, 153516
s_mov_b32 s22, 0
L_lw_73:
ds_read_b32 v21, v20
s_waitcnt lgkmcnt(0)
v_readfirstlane_b32 s64, v21
s_add_u32 s22, s22, 1
s_cmp_ge_u32 s64, 4
s_cbranch_scc1 L_lwok_73
s_cmp_lt_u32 s22, 4194304
s_cbranch_scc1 L_lw_73
L_lwok_73:
v_lshlrev_b32 v20, 3, v3
v_add_u32 v20, 148800, v20
ds_read_b64 v[24:25], v20 offset:0
ds_read_b64 v[26:27], v20 offset:320
ds_read_b64 v[28:29], v20 offset:640
ds_read_b64 v[30:31], v20 offset:960
s_mul_i32 s64, s57, 40
v_add_u32 v16, s64, v3
v_lshlrev_b32 v16, 4, v16
v_add_u32 v16, 11534336, v16
s_waitcnt lgkmcnt(0)
v_fma_f32 v14, v96, v24, v26
v_fma_f32 v15, v96, v25, v27
v_fma_f32 v14, -v97, v25, v14
v_fma_f32 v15, v97, v24, v15
v_fma_f32 v12, v96, v14, v28
v_fma_f32 v13, v96, v15, v29
v_fma_f32 v12, -v97, v15, v12
v_fma_f32 v13, v97, v14, v13
v_fma_f32 v14, v96, v12, v30
v_fma_f32 v15, v96, v13, v31
v_fma_f32 v14, -v97, v13, v14
v_fma_f32 v15, v97, v12, v15
v_mov_b32 v20, v14
v_mov_b32 v21, s63
v_mov_b32 v22, v15
v_mov_b32 v23, s63
s_mul_i32 s64, s56, 10240
v_add_u32 v12, s64, v16
v_mov_b32 v13, 2146435072
v_cmp_gt_u32 vcc, 40, v1
s_nop 1
v_cndmask_b32 v12, v13, v12, vcc
buffer_store_dwordx4 v[20:23], v12, s[52:55], 0 offen sc1
s_cmp_le_u32 s56, 0
s_cbranch_scc1 L_gl_X
s_mov_b32 s64, 0
buffer_load_dwordx4 v[112:115], v16, s[52:55], s64 offen sc1
s_cmp_le_u32 s56, 1
s_cbranch_scc1 L_gl_X
s_mov_b32 s64, 10240
buffer_load_dwordx4 v[116:119], v16, s[52:55], s64 offen sc1
s_cmp_le_u32 s56, 2
s_cbranch_scc1 L_gl_X
s_mov_b32 s64, 20480
buffer_load_dwordx4 v[120:123], v16, s[52:55], s64 offen sc1
s_cmp_le_u32 s56, 3
s_cbranch_scc1 L_gl_X
s_mov_b32 s64, 30720
buffer_load_dwordx4 v[124:127], v16, s[52:55], s64 offen sc1
s_cmp_le_u32 s56, 4
s_cbranch_scc1 L_gl_X
s_mov_b32 s64, 40960
buffer_load_dwordx4 v[128:131], v16, s[52:55], s64 offen sc1
s_cmp_le_u32 s56, 5
s_cbranch_scc1 L_gl_X
s_mov_b32 s64, 51200
buffer_load_dwordx4 v[132:135], v16, s[52:55], s64 offen sc1
s_cmp_le_u32 s56, 6
s_cbranch_scc1 L_gl_X
s_mov_b32 s64, 61440
buffer_load_dwordx4 v[136:139], v16, s[52:55], s64 offen sc1
s_cmp_le_u32 s56, 7
s_cbranch_scc1 L_gl_X
s_mov_b32 s64, 71680
buffer_load_dwordx4 v[140:143], v16, s[52:55], s64 offen sc1
s_cmp_le_u32 s56, 8
s_cbranch_scc1 L_gl_X
s_mov_b32 s64, 81920
buffer_load_dwordx4 v[144:147], v16, s[52:55], s64 offen sc1
s_cmp_le_u32 s56, 9
s_cbranch_scc1 L_gl_X
s_mov_b32 s64, 92160
buffer_load_dwordx4 v[148:151], v16, s[52:55], s64 offen sc1
s_cmp_le_u32 s56, 10
s_cbranch_scc1 L_gl_X
s_mov_b32 s64, 102400
buffer_load_dwordx4 v[152:155], v16, s[52:55], s64 offen sc1
s_cmp_le_u32 s56, 11
s_cbranch_scc1 L_gl_X
s_mov_b32 s64, 112640
buffer_load_dwordx4 v[156:159], v16, s[52:55], s64 offen sc1
s_cmp_le_u32 s56, 12
s_cbranch_scc1 L_gl_X
s_mov_b32 s64, 122880
buffer_load_dwordx4 v[160:163], v16, s[52:55], s64 offen sc1
s_cmp_le_u32 s56, 13
s_cbranch_scc1 L_gl_X
s_mov_b32 s64, 133120
buffer_load_dwordx4 v[164:167], v16, s[52:55], s64 offen sc1
s_cmp_le_u32 s56, 14
s_cbranch_scc1 L_gl_X
s_mov_b32 s64, 143360
buffer_load_dwordx4 v[168:171], v16, s[52:55], s64 offen sc1
L_gl_X:
s_mov_b32 s22, 0
s_lshl_b32 s65, 1, s56
s_sub_u32 s65, s65, 1
L_gchk:
s_waitcnt vmcnt(0)
s_bitcmp1_b32 s65, 0
s_cbranch_scc0 L_gs0
v_cmp_eq_u32 vcc, s63, v113
v_cmp_eq_u32 s[80:81], s63, v115
s_and_b64 vcc, vcc, s[80:81]
s_cmp_eq_u64 vcc, -1
s_cbranch_scc0 L_gr0
s_bitset0_b32 s65, 0
s_branch L_gs0
L_gr0:
s_mov_b32 s64, 0
buffer_load_dwordx4 v[112:115], v16, s[52:55], s64 offen sc1
L_gs0:
s_bitcmp1_b32 s65, 1
s_cbranch_scc0 L_gs1
v_cmp_eq_u32 vcc, s63, v117
v_cmp_eq_u32 s[80:81], s63, v119
s_and_b64 vcc, vcc, s[80:81]
s_cmp_eq_u64 vcc, -1
s_cbranch_scc0 L_gr1
s_bitset0_b32 s65, 1
s_branch L_gs1
L_gr1:
s_mov_b32 s64, 10240
buffer_load_dwordx4 v[116:119], v16, s[52:55], s64 offen sc1
L_gs1:
s_bitcmp1_b32 s65, 2
s_cbranch_scc0 L_gs2
v_cmp_eq_u32 vcc, s63, v121
v_cmp_eq_u32 s[80:81], s63, v123
s_and_b64 vcc, vcc, s[80:81]
s_cmp_eq_u64 vcc, -1
s_cbranch_scc0 L_gr2
s_bitset0_b32 s65, 2
s_branch L_gs2
L_gr2:
s_mov_b32 s64, 20480
buffer_load_dwordx4 v[120:123], v16, s[52:55], s64 offen sc1
L_gs2:
s_bitcmp1_b32 s65, 3
s_cbranch_scc0 L_gs3
v_cmp_eq_u32 vcc, s63, v125
v_cmp_eq_u32 s[80:81], s63, v127
s_and_b64 vcc, vcc, s[80:81]
s_cmp_eq_u64 vcc, -1
s_cbranch_scc0 L_gr3
s_bitset0_b32 s65, 3
s_branch L_gs3
L_gr3:
s_mov_b32 s64, 30720
buffer_load_dwordx4 v[124:127], v16, s[52:55], s64 offen sc1
L_gs3:
s_bitcmp1_b32 s65, 4
s_cbranch_scc0 L_gs4
v_cmp_eq_u32 vcc, s63, v129
v_cmp_eq_u32 s[80:81], s63, v131
s_and_b64 vcc, vcc, s[80:81]
s_cmp_eq_u64 vcc, -1
s_cbranch_scc0 L_gr4
s_bitset0_b32 s65, 4
s_branch L_gs4
L_gr4:
s_mov_b32 s64, 40960
buffer_load_dwordx4 v[128:131], v16, s[52:55], s64 offen sc1
L_gs4:
s_bitcmp1_b32 s65, 5
s_cbranch_scc0 L_gs5
v_cmp_eq_u32 vcc, s63, v133
v_cmp_eq_u32 s[80:81], s63, v135
s_and_b64 vcc, vcc, s[80:81]
s_cmp_eq_u64 vcc, -1
s_cbranch_scc0 L_gr5
s_bitset0_b32 s65, 5
s_branch L_gs5
L_gr5:
s_mov_b32 s64, 51200
buffer_load_dwordx4 v[132:135], v16, s[52:55], s64 offen sc1
L_gs5:
s_bitcmp1_b32 s65, 6
s_cbranch_scc0 L_gs6
v_cmp_eq_u32 vcc, s63, v137
v_cmp_eq_u32 s[80:81], s63, v139
s_and_b64 vcc, vcc, s[80:81]
s_cmp_eq_u64 vcc, -1
s_cbranch_scc0 L_gr6
s_bitset0_b32 s65, 6
s_branch L_gs6
L_gr6:
s_mov_b32 s64, 61440
buffer_load_dwordx4 v[136:139], v16, s[52:55], s64 offen sc1
L_gs6:
s_bitcmp1_b32 s65, 7
s_cbranch_scc0 L_gs7
v_cmp_eq_u32 vcc, s63, v141
v_cmp_eq_u32 s[80:81], s63, v143
s_and_b64 vcc, vcc, s[80:81]
s_cmp_eq_u64 vcc, -1
s_cbranch_scc0 L_gr7
s_bitset0_b32 s65, 7
s_branch L_gs7
L_gr7:
s_mov_b32 s64, 71680
buffer_load_dwordx4 v[140:143], v16, s[52:55], s64 offen sc1
L_gs7:
s_bitcmp1_b32 s65, 8
s_cbranch_scc0 L_gs8
v_cmp_eq_u32 vcc, s63, v145
v_cmp_eq_u32 s[80:81], s63, v147
s_and_b64 vcc, vcc, s[80:81]
s_cmp_eq_u64 vcc, -1
s_cbranch_scc0 L_gr8
s_bitset0_b32 s65, 8
s_branch L_gs8
L_gr8:
s_mov_b32 s64, 81920
buffer_load_dwordx4 v[144:147], v16, s[52:55], s64 offen sc1
L_gs8:
s_bitcmp1_b32 s65, 9
s_cbranch_scc0 L_gs9
v_cmp_eq_u32 vcc, s63, v149
v_cmp_eq_u32 s[80:81], s63, v151
s_and_b64 vcc, vcc, s[80:81]
s_cmp_eq_u64 vcc, -1
s_cbranch_scc0 L_gr9
s_bitset0_b32 s65, 9
s_branch L_gs9
L_gr9:
s_mov_b32 s64, 92160
buffer_load_dwordx4 v[148:151], v16, s[52:55], s64 offen sc1
L_gs9:
s_bitcmp1_b32 s65, 10
s_cbranch_scc0 L_gs10
v_cmp_eq_u32 vcc, s63, v153
v_cmp_eq_u32 s[80:81], s63, v155
s_and_b64 vcc, vcc, s[80:81]
s_cmp_eq_u64 vcc, -1
s_cbranch_scc0 L_gr10
s_bitset0_b32 s65, 10
s_branch L_gs10
L_gr10:
s_mov_b32 s64, 102400
buffer_load_dwordx4 v[152:155], v16, s[52:55], s64 offen sc1
L_gs10:
s_bitcmp1_b32 s65, 11
s_cbranch_scc0 L_gs11
v_cmp_eq_u32 vcc, s63, v157
v_cmp_eq_u32 s[80:81], s63, v159
s_and_b64 vcc, vcc, s[80:81]
s_cmp_eq_u64 vcc, -1
s_cbranch_scc0 L_gr11
s_bitset0_b32 s65, 11
s_branch L_gs11
L_gr11:
s_mov_b32 s64, 112640
buffer_load_dwordx4 v[156:159], v16, s[52:55], s64 offen sc1
L_gs11:
s_bitcmp1_b32 s65, 12
s_cbranch_scc0 L_gs12
v_cmp_eq_u32 vcc, s63, v161
v_cmp_eq_u32 s[80:81], s63, v163
s_and_b64 vcc, vcc, s[80:81]
s_cmp_eq_u64 vcc, -1
s_cbranch_scc0 L_gr12
s_bitset0_b32 s65, 12
s_branch L_gs12
L_gr12:
s_mov_b32 s64, 122880
buffer_load_dwordx4 v[160:163], v16, s[52:55], s64 offen sc1
L_gs12:
s_bitcmp1_b32 s65, 13
s_cbranch_scc0 L_gs13
v_cmp_eq_u32 vcc, s63, v165
v_cmp_eq_u32 s[80:81], s63, v167
s_and_b64 vcc, vcc, s[80:81]
s_cmp_eq_u64 vcc, -1
s_cbranch_scc0 L_gr13
s_bitset0_b32 s65, 13
s_branch L_gs13
L_gr13:
s_mov_b32 s64, 133120
buffer_load_dwordx4 v[164:167], v16, s[52:55], s64 offen sc1
L_gs13:
s_bitcmp1_b32 s65, 14
s_cbranch_scc0 L_gs14
v_cmp_eq_u32 vcc, s63, v169
v_cmp_eq_u32 s[80:81], s63, v171
s_and_b64 vcc, vcc, s[80:81]
s_cmp_eq_u64 vcc, -1
s_cbranch_scc0 L_gr14
s_bitset0_b32 s65, 14
s_branch L_gs14
L_gr14:
s_mov_b32 s64, 143360
buffer_load_dwordx4 v[168:171], v16, s[52:55], s64 offen sc1
L_gs14:
s_cmp_eq_u32 s65, 0
s_cbranch_scc1 L_gok
s_add_u32 s22, s22, 1
s_cmp_lt_u32 s22, 0x40000
s_cbranch_scc1 L_gchk
L_gok:
v_mov_b32 v12, 0
v_mov_b32 v13, 0
s_cmp_le_u32 s56, 0
s_cbranch_scc1 L_gh
v_fma_f32 v112, v98, v12, v112
v_fma_f32 v114, v98, v13, v114
v_fma_f32 v112, -v99, v13, v112
v_fma_f32 v114, v99, v12, v114
v_mov_b32 v12, v112
v_mov_b32 v13, v114
s_cmp_le_u32 s56, 1
s_cbranch_scc1 L_gh
v_fma_f32 v116, v98, v12, v116
v_fma_f32 v118, v98, v13, v118
v_fma_f32 v116, -v99, v13, v116
v_fma_f32 v118, v99, v12, v118
v_mov_b32 v12, v116
v_mov_b32 v13, v118
s_cmp_le_u32 s56, 2
s_cbranch_scc1 L_gh
v_fma_f32 v120, v98, v12, v120
v_fma_f32 v122, v98, v13, v122
v_fma_f32 v120, -v99, v13, v120
v_fma_f32 v122, v99, v12, v122
v_mov_b32 v12, v120
v_mov_b32 v13, v122
s_cmp_le_u32 s56, 3
s_cbranch_scc1 L_gh
v_fma_f32 v124, v98, v12, v124
v_fma_f32 v126, v98, v13, v126
v_fma_f32 v124, -v99, v13, v124
v_fma_f32 v126, v99, v12, v126
v_mov_b32 v12, v124
v_mov_b32 v13, v126
s_cmp_le_u32 s56, 4
s_cbranch_scc1 L_gh
v_fma_f32 v128, v98, v12, v128
v_fma_f32 v130, v98, v13, v130
v_fma_f32 v128, -v99, v13, v128
v_fma_f32 v130, v99, v12, v130
v_mov_b32 v12, v128
v_mov_b32 v13, v130
s_cmp_le_u32 s56, 5
s_cbranch_scc1 L_gh
v_fma_f32 v132, v98, v12, v132
v_fma_f32 v134, v98, v13, v134
v_fma_f32 v132, -v99, v13, v132
v_fma_f32 v134, v99, v12, v134
v_mov_b32 v12, v132
v_mov_b32 v13, v134
s_cmp_le_u32 s56, 6
s_cbranch_scc1 L_gh
v_fma_f32 v136, v98, v12, v136
v_fma_f32 v138, v98, v13, v138
v_fma_f32 v136, -v99, v13, v136
v_fma_f32 v138, v99, v12, v138
v_mov_b32 v12, v136
v_mov_b32 v13, v138
s_cmp_le_u32 s56, 7
s_cbranch_scc1 L_gh
v_fma_f32 v140, v98, v12, v140
v_fma_f32 v142, v98, v13, v142
v_fma_f32 v140, -v99, v13, v140
v_fma_f32 v142, v99, v12, v142
v_mov_b32 v12, v140
v_mov_b32 v13, v142
s_cmp_le_u32 s56, 8
s_cbranch_scc1 L_gh
v_fma_f32 v144, v98, v12, v144
v_fma_f32 v146, v98, v13, v146
v_fma_f32 v144, -v99, v13, v144
v_fma_f32 v146, v99, v12, v146
v_mov_b32 v12, v144
v_mov_b32 v13, v146
s_cmp_le_u32 s56, 9
s_cbranch_scc1 L_gh
v_fma_f32 v148, v98, v12, v148
v_fma_f32 v150, v98, v13, v150
v_fma_f32 v148, -v99, v13, v148
v_fma_f32 v150, v99, v12, v150
v_mov_b32 v12, v148
v_mov_b32 v13, v150
s_cmp_le_u32 s56, 10
s_cbranch_scc1 L_gh
v_fma_f32 v152, v98, v12, v152
v_fma_f32 v154, v98, v13, v154
v_fma_f32 v152, -v99, v13, v152
v_fma_f32 v154, v99, v12, v154
v_mov_b32 v12, v152
v_mov_b32 v13, v154
s_cmp_le_u32 s56, 11
s_cbranch_scc1 L_gh
v_fma_f32 v156, v98, v12, v156
v_fma_f32 v158, v98, v13, v158
v_fma_f32 v156, -v99, v13, v156
v_fma_f32 v158, v99, v12, v158
v_mov_b32 v12, v156
v_mov_b32 v13, v158
s_cmp_le_u32 s56, 12
s_cbranch_scc1 L_gh
v_fma_f32 v160, v98, v12, v160
v_fma_f32 v162, v98, v13, v162
v_fma_f32 v160, -v99, v13, v160
v_fma_f32 v162, v99, v12, v162
v_mov_b32 v12, v160
v_mov_b32 v13, v162
s_cmp_le_u32 s56, 13
s_cbranch_scc1 L_gh
v_fma_f32 v164, v98, v12, v164
v_fma_f32 v166, v98, v13, v166
v_fma_f32 v164, -v99, v13, v164
v_fma_f32 v166, v99, v12, v166
v_mov_b32 v12, v164
v_mov_b32 v13, v166
s_cmp_le_u32 s56, 14
s_cbranch_scc1 L_gh
v_fma_f32 v168, v98, v12, v168
v_fma_f32 v170, v98, v13, v170
v_fma_f32 v168, -v99, v13, v168
v_fma_f32 v170, v99, v12, v170
v_mov_b32 v12, v168
v_mov_b32 v13, v170
L_gh:
v_lshlrev_b32 v20, 3, v3
v_add_u32 v20, 153632, v20
ds_write_b64 v20, v[12:13]
v_mov_b32 v20, 153508
v_mov_b32 v21, 1
s_waitcnt lgkmcnt(0)
ds_write_b32 v20, v21
s_branch L_x0done
L_notx0:
s_cmp_lg_u32 s59, 2
s_cbranch_scc1 L_notx2
s_lshr_b32 s64, s2, 6
s_lshr_b32 s65, s2, 2
s_and_b32 s65, s65, 1
s_lshl_b32 s65, s65, 2
s_add_u32 s64, s64, s65
s_lshl_b32 s67, s64, 11
s_add_u32 s67, s67, 14745600
v_and_b32 v17, 31, v1
v_lshlrev_b32 v17, 2, v17
s_mov_b32 s22, 0
L_spoll_f0X:
s_mov_b32 s64, 0
s_add_u32 s65, s67, 0
s_load_dword s40, s[36:37], s65 glc
s_add_u32 s65, s67, 64
s_load_dword s41, s[36:37], s65 glc
s_add_u32 s65, s67, 128
s_load_dword s42, s[36:37], s65 glc
s_add_u32 s65, s67, 192
s_load_dword s43, s[36:37], s65 glc
s_add_u32 s65, s67, 256
s_load_dword s44, s[36:37], s65 glc
s_add_u32 s65, s67, 320
s_load_dword s45, s[36:37], s65 glc
s_add_u32 s65, s67, 384
s_load_dword s46, s[36:37], s65 glc
s_add_u32 s65, s67, 448
s_load_dword s47, s[36:37], s65 glc
s_add_u32 s65, s67, 512
s_load_dword s68, s[36:37], s65 glc
s_add_u32 s65, s67, 576
s_load_dword s69, s[36:37], s65 glc
s_add_u32 s65, s67, 640
s_load_dword s70, s[36:37], s65 glc
s_add_u32 s65, s67, 704
s_load_dword s71, s[36:37], s65 glc
s_add_u32 s65, s67, 768
s_load_dword s72, s[36:37], s65 glc
s_add_u32 s65, s67, 832
s_load_dword s73, s[36:37], s65 glc
s_add_u32 s65, s67, 896
s_load_dword s74, s[36:37], s65 glc
s_add_u32 s65, s67, 960
s_load_dword s75, s[36:37], s65 glc
s_waitcnt lgkmcnt(0)
s_xor_b32 s40, s40, s63
s_or_b32 s64, s64, s40
s_xor_b32 s41, s41, s63
s_or_b32 s64, s64, s41
s_xor_b32 s42, s42, s63
s_or_b32 s64, s64, s42
s_xor_b32 s43, s43, s63
s_or_b32 s64, s64, s43
s_xor_b32 s44, s44, s63
s_or_b32 s64, s64, s44
s_xor_b32 s45, s45, s63
s_or_b32 s64, s64, s45
s_xor_b32 s46, s46, s63
s_or_b32 s64, s64, s46
s_xor_b32 s47, s47, s63
s_or_b32 s64, s64, s47
s_xor_b32 s68, s68, s63
s_or_b32 s64, s64, s68
s_xor_b32 s69, s69, s63
s_or_b32 s64, s64, s69
s_xor_b32 s70, s70, s63
s_or_b32 s64, s64, s70
s_xor_b32 s71, s71, s63
s_or_b32 s64, s64, s71
s_xor_b32 s72, s72, s63
s_or_b32 s64, s64, s72
s_xor_b32 s73, s73, s63
s_or_b32 s64, s64, s73
s_xor_b32 s74, s74, s63
s_or_b32 s64, s64, s74
s_xor_b32 s75, s75, s63
s_or_b32 s64, s64, s75
s_add_u32 s65, s67, 1024
s_load_dword s40, s[36:37], s65 glc
s_add_u32 s65, s67, 1088
s_load_dword s41, s[36:37], s65 glc
s_add_u32 s65, s67, 1152
s_load_dword s42, s[36:37], s65 glc
s_add_u32 s65, s67, 1216
s_load_dword s43, s[36:37], s65 glc
s_add_u32 s65, s67, 1280
s_load_dword s44, s[36:37], s65 glc
s_add_u32 s65, s67, 1344
s_load_dword s45, s[36:37], s65 glc
s_add_u32 s65, s67, 1408
s_load_dword s46, s[36:37], s65 glc
s_add_u32 s65, s67, 1472
s_load_dword s47, s[36:37], s65 glc
s_add_u32 s65, s67, 1536
s_load_dword s68, s[36:37], s65 glc
s_add_u32 s65, s67, 1600
s_load_dword s69, s[36:37], s65 glc
s_add_u32 s65, s67, 1664
s_load_dword s70, s[36:37], s65 glc
s_add_u32 s65, s67, 1728
s_load_dword s71, s[36:37], s65 glc
s_add_u32 s65, s67, 1792
s_load_dword s72, s[36:37], s65 glc
s_add_u32 s65, s67, 1856
s_load_dword s73, s[36:37], s65 glc
s_add_u32 s65, s67, 1920
s_load_dword s74, s[36:37], s65 glc
s_add_u32 s65, s67, 1984
s_load_dword s75, s[36:37], s65 glc
s_waitcnt lgkmcnt(0)
s_xor_b32 s40, s40, s63
s_or_b32 s64, s64, s40
s_xor_b32 s41, s41, s63
s_or_b32 s64, s64, s41
s_xor_b32 s42, s42, s63
s_or_b32 s64, s64, s42
s_xor_b32 s43, s43, s63
s_or_b32 s64, s64, s43
s_xor_b32 s44, s44, s63
s_or_b32 s64, s64, s44
s_xor_b32 s45, s45, s63
s_or_b32 s64, s64, s45
s_xor_b32 s46, s46, s63
s_or_b32 s64, s64, s46
s_xor_b32 s47, s47, s63
s_or_b32 s64, s64, s47
s_xor_b32 s68, s68, s63
s_or_b32 s64, s64, s68
s_xor_b32 s69, s69, s63
s_or_b32 s64, s64, s69
s_xor_b32 s70, s70, s63
s_or_b32 s64, s64, s70
s_xor_b32 s71, s71, s63
s_or_b32 s64, s64, s71
s_xor_b32 s72, s72, s63
s_or_b32 s64, s64, s72
s_xor_b32 s73, s73, s63
s_or_b32 s64, s64, s73
s_xor_b32 s74, s74, s63
s_or_b32 s64, s64, s74
s_xor_b32 s75, s75, s63
s_or_b32 s64, s64, s75
s_add_u32 s22, s22, 1
s_cmp_eq_u32 s64, 0
s_cbranch_scc1 L_spollok_f0X
s_cmp_lt_u32 s22, 262144
s_cbranch_scc1 L_spoll_f0X
L_spollok_f0X:
v_mov_b32 v20, 153564
v_mov_b32 v21, 1
s_waitcnt lgkmcnt(0)
ds_write_b32 v20, v21
L_notx2:
v_mov_b32 v20, 153508
s_mov_b32 s22, 0
L_lw_74:
ds_read_b32 v21, v20
s_waitcnt lgkmcnt(0)
v_readfirstlane_b32 s64, v21
s_add_u32 s22, s22, 1
s_cmp_ge_u32 s64, 1
s_cbranch_scc1 L_lwok_74
s_cmp_lt_u32 s22, 4194304
s_cbranch_scc1 L_lw_74
L_lwok_74:
v_lshlrev_b32 v20, 3, v3
v_add_u32 v22, 148800, v20
v_add_u32 v20, 153632, v20
ds_read_b64 v[12:13], v20
ds_read_b64 v[24:25], v22 offset:0
ds_read_b64 v[26:27], v22 offset:320
ds_read_b64 v[28:29], v22 offset:640
s_waitcnt lgkmcnt(0)
L_x0done:
s_cmp_le_u32 s59, 0
s_cbranch_scc1 L_it
v_fma_f32 v24, v96, v12, v24
v_fma_f32 v25, v96, v13, v25
v_fma_f32 v24, -v97, v13, v24
v_fma_f32 v25, v97, v12, v25
v_mov_b32 v12, v24
v_mov_b32 v13, v25
s_cmp_le_u32 s59, 1
s_cbranch_scc1 L_it
v_fma_f32 v26, v96, v12, v26
v_fma_f32 v27, v96, v13, v27
v_fma_f32 v26, -v97, v13, v26
v_fma_f32 v27, v97, v12, v27
v_mov_b32 v12, v26
v_mov_b32 v13, v27
s_cmp_le_u32 s59, 2
s_cbranch_scc1 L_it
v_fma_f32 v28, v96, v12, v28
v_fma_f32 v29, v96, v13, v29
v_fma_f32 v28, -v97, v13, v28
v_fma_f32 v29, v97, v12, v29
v_mov_b32 v12, v28
v_mov_b32 v13, v29
L_it:
v_mov_b32 v14, v12
v_mov_b32 v12, v12
s_nop 1
v_permlane32_swap_b32 v14, v12
v_mov_b32 v15, v13
v_mov_b32 v13, v13
s_nop 1
v_permlane32_swap_b32 v15, v13
s_cmp_lg_u32 s57, 0
s_cbranch_scc1 L_nologit
s_lshl_b32 s65, s59, 7
v_lshlrev_b32 v20, 6, v2
v_add_u32 v20, s65, v20
v_add_u32 v20, 157168, v20
v_and_b32 v21, 31, v1
v_cmp_eq_u32 vcc, 16, v21
s_and_saveexec_b64 s[22:23], vcc
ds_write_b32 v20, v64 offset:0
ds_write_b32 v20, v65 offset:32
ds_write_b32 v20, v66 offset:4
ds_write_b32 v20, v67 offset:36
ds_write_b32 v20, v68 offset:8
ds_write_b32 v20, v69 offset:40
ds_write_b32 v20, v70 offset:12
ds_write_b32 v20, v71 offset:44
ds_write_b32 v20, v72 offset:16
ds_write_b32 v20, v73 offset:48
ds_write_b32 v20, v74 offset:20
ds_write_b32 v20, v75 offset:52
ds_write_b32 v20, v76 offset:24
ds_write_b32 v20, v77 offset:56
ds_write_b32 v20, v78 offset:28
ds_write_b32 v20, v79 offset:60
s_mov_b64 exec, s[22:23]
L_nologit:
v_mov_b32 v20, 153520
s_mov_b32 s22, 0
L_lw_75:
ds_read_b32 v21, v20
s_waitcnt lgkmcnt(0)
v_readfirstlane_b32 s64, v21
s_add_u32 s22, s22, 1
s_cmp_ge_u32 s64, 4
s_cbranch_scc1 L_lwok_75
s_cmp_lt_u32 s22, 4194304
s_cbranch_scc1 L_lw_75
L_lwok_75:
v_and_b32 v16, 31, v1
v_fma_f32 v6, v104, v14, v6
v_fma_f32 v7, v104, v15, v7
v_fma_f32 v6, -v105, v15, v6
v_fma_f32 v7, v105, v14, v7
v_cmp_eq_u32 vcc, 1, v2
s_nop 1
v_cndmask_b32 v20, v14, v6, vcc
v_cndmask_b32 v22, v15, v7, vcc
v_fma_f32 v4, v102, v20, v4
v_fma_f32 v5, v102, v22, v5
v_fma_f32 v4, -v103, v22, v4
v_fma_f32 v5, v103, v20, v5
v_mov_b32 v21, v4
v_mov_b32 v23, v5
v_pk_fma_f32 v[32:33], v[100:101], v[20:21], v[32:33] op_sel_hi:[0,1,1]
v_pk_fma_f32 v[48:49], v[100:101], v[22:23], v[48:49] op_sel_hi:[0,1,1]
v_pk_fma_f32 v[32:33], v[100:101], v[22:23], v[32:33] op_sel:[1,0,0] op_sel_hi:[1,1,1] neg_lo:[1,0,0] neg_hi:[1,0,0]
v_pk_fma_f32 v[48:49], v[100:101], v[20:21], v[48:49] op_sel:[1,0,0] op_sel_hi:[1,1,1]
v_pk_fma_f32 v[34:35], v[100:101], v[32:33], v[34:35] op_sel_hi:[0,1,1]
v_pk_fma_f32 v[50:51], v[100:101], v[48:49], v[50:51] op_sel_hi:[0,1,1]
v_pk_fma_f32 v[34:35], v[100:101], v[48:49], v[34:35] op_sel:[1,0,0] op_sel_hi:[1,1,1] neg_lo:[1,0,0] neg_hi:[1,0,0]
v_pk_fma_f32 v[50:51], v[100:101], v[32:33], v[50:51] op_sel:[1,0,0] op_sel_hi:[1,1,1]
v_pk_fma_f32 v[36:37], v[100:101], v[34:35], v[36:37] op_sel_hi:[0,1,1]
v_pk_fma_f32 v[52:53], v[100:101], v[50:51], v[52:53] op_sel_hi:[0,1,1]
v_pk_fma_f32 v[36:37], v[100:101], v[50:51], v[36:37] op_sel:[1,0,0] op_sel_hi:[1,1,1] neg_lo:[1,0,0] neg_hi:[1,0,0]
v_pk_fma_f32 v[52:53], v[100:101], v[34:35], v[52:53] op_sel:[1,0,0] op_sel_hi:[1,1,1]
v_pk_fma_f32 v[38:39], v[100:101], v[36:37], v[38:39] op_sel_hi:[0,1,1]
v_pk_fma_f32 v[54:55], v[100:101], v[52:53], v[54:55] op_sel_hi:[0,1,1]
v_pk_fma_f32 v[38:39], v[100:101], v[52:53], v[38:39] op_sel:[1,0,0] op_sel_hi:[1,1,1] neg_lo:[1,0,0] neg_hi:[1,0,0]
v_pk_fma_f32 v[54:55], v[100:101], v[36:37], v[54:55] op_sel:[1,0,0] op_sel_hi:[1,1,1]
v_pk_fma_f32 v[40:41], v[100:101], v[38:39], v[40:41] op_sel_hi:[0,1,1]
v_pk_fma_f32 v[56:57], v[100:101], v[54:55], v[56:57] op_sel_hi:[0,1,1]
v_pk_fma_f32 v[40:41], v[100:101], v[54:55], v[40:41] op_sel:[1,0,0] op_sel_hi:[1,1,1] neg_lo:[1,0,0] neg_hi:[1,0,0]
v_pk_fma_f32 v[56:57], v[100:101], v[38:39], v[56:57] op_sel:[1,0,0] op_sel_hi:[1,1,1]
v_pk_fma_f32 v[42:43], v[100:101], v[40:41], v[42:43] op_sel_hi:[0,1,1]
v_pk_fma_f32 v[58:59], v[100:101], v[56:57], v[58:59] op_sel_hi:[0,1,1]
v_pk_fma_f32 v[42:43], v[100:101], v[56:57], v[42:43] op_sel:[1,0,0] op_sel_hi:[1,1,1] neg_lo:[1,0,0] neg_hi:[1,0,0]
v_pk_fma_f32 v[58:59], v[100:101], v[40:41], v[58:59] op_sel:[1,0,0] op_sel_hi:[1,1,1]
v_pk_fma_f32 v[44:45], v[100:101], v[42:43], v[44:45] op_sel_hi:[0,1,1]
v_pk_fma_f32 v[60:61], v[100:101], v[58:59], v[60:61] op_sel_hi:[0,1,1]
v_pk_fma_f32 v[44:45], v[100:101], v[58:59], v[44:45] op_sel:[1,0,0] op_sel_hi:[1,1,1] neg_lo:[1,0,0] neg_hi:[1,0,0]
v_pk_fma_f32 v[60:61], v[100:101], v[42:43], v[60:61] op_sel:[1,0,0] op_sel_hi:[1,1,1]
v_pk_fma_f32 v[46:47], v[100:101], v[44:45], v[46:47] op_sel_hi:[0,1,1]
v_pk_fma_f32 v[62:63], v[100:101], v[60:61], v[62:63] op_sel_hi:[0,1,1]
v_pk_fma_f32 v[46:47], v[100:101], v[60:61], v[46:47] op_sel:[1,0,0] op_sel_hi:[1,1,1] neg_lo:[1,0,0] neg_hi:[1,0,0]
v_pk_fma_f32 v[62:63], v[100:101], v[44:45], v[62:63] op_sel:[1,0,0] op_sel_hi:[1,1,1]
s_mul_i32 s64, s59, 7680
v_mul_u32_u24 v24, 3840, v2
v_lshl_add_u32 v24, v16, 2, v24
v_add_u32 v24, s64, v24
v_add_u32 v24, 15360, v24
v_cvt_pk_bf16_f32 v26, v32, v48
ds_write_b32 v24, v26 offset:0
v_cvt_pk_bf16_f32 v27, v33, v49
ds_write_b32 v24, v27 offset:1920
v_cvt_pk_bf16_f32 v28, v34, v50
ds_write_b32 v24, v28 offset:240
v_cvt_pk_bf16_f32 v29, v35, v51
ds_write_b32 v24, v29 offset:2160
v_cvt_pk_bf16_f32 v26, v36, v52
ds_write_b32 v24, v26 offset:480
v_cvt_pk_bf16_f32 v27, v37, v53
ds_write_b32 v24, v27 offset:2400
v_cvt_pk_bf16_f32 v28, v38, v54
ds_write_b32 v24, v28 offset:720
v_cvt_pk_bf16_f32 v29, v39, v55
ds_write_b32 v24, v29 offset:2640
v_cvt_pk_bf16_f32 v26, v40, v56
ds_write_b32 v24, v26 offset:960
v_cvt_pk_bf16_f32 v27, v41, v57
ds_write_b32 v24, v27 offset:2880
v_cvt_pk_bf16_f32 v28, v42, v58
ds_write_b32 v24, v28 offset:1200
v_cvt_pk_bf16_f32 v29, v43, v59
ds_write_b32 v24, v29 offset:3120
v_cvt_pk_bf16_f32 v26, v44, v60
ds_write_b32 v24, v26 offset:1440
v_cvt_pk_bf16_f32 v27, v45, v61
ds_write_b32 v24, v27 offset:3360
v_cvt_pk_bf16_f32 v28, v46, v62
ds_write_b32 v24, v28 offset:1680
v_cvt_pk_bf16_f32 v29, v47, v63
ds_write_b32 v24, v29 offset:3600
v_and_b32 v16, 7, v1
v_add_u32 v16, 32, v16
v_fma_f32 v10, v110, v12, v10
v_fma_f32 v11, v110, v13, v11
v_fma_f32 v10, -v111, v13, v10
v_fma_f32 v11, v111, v12, v11
v_cmp_eq_u32 vcc, 1, v2
s_nop 1
v_cndmask_b32 v20, v12, v10, vcc
v_cndmask_b32 v22, v13, v11, vcc
v_fma_f32 v8, v108, v20, v8
v_fma_f32 v9, v108, v22, v9
v_fma_f32 v8, -v109, v22, v8
v_fma_f32 v9, v109, v20, v9
v_mov_b32 v21, v8
v_mov_b32 v23, v9
v_pk_fma_f32 v[64:65], v[106:107], v[20:21], v[64:65] op_sel_hi:[0,1,1]
v_pk_fma_f32 v[80:81], v[106:107], v[22:23], v[80:81] op_sel_hi:[0,1,1]
v_pk_fma_f32 v[64:65], v[106:107], v[22:23], v[64:65] op_sel:[1,0,0] op_sel_hi:[1,1,1] neg_lo:[1,0,0] neg_hi:[1,0,0]
v_pk_fma_f32 v[80:81], v[106:107], v[20:21], v[80:81] op_sel:[1,0,0] op_sel_hi:[1,1,1]
v_pk_fma_f32 v[66:67], v[106:107], v[64:65], v[66:67] op_sel_hi:[0,1,1]
v_pk_fma_f32 v[82:83], v[106:107], v[80:81], v[82:83] op_sel_hi:[0,1,1]
v_pk_fma_f32 v[66:67], v[106:107], v[80:81], v[66:67] op_sel:[1,0,0] op_sel_hi:[1,1,1] neg_lo:[1,0,0] neg_hi:[1,0,0]
v_pk_fma_f32 v[82:83], v[106:107], v[64:65], v[82:83] op_sel:[1,0,0] op_sel_hi:[1,1,1]
v_pk_fma_f32 v[68:69], v[106:107], v[66:67], v[68:69] op_sel_hi:[0,1,1]
v_pk_fma_f32 v[84:85], v[106:107], v[82:83], v[84:85] op_sel_hi:[0,1,1]
v_pk_fma_f32 v[68:69], v[106:107], v[82:83], v[68:69] op_sel:[1,0,0] op_sel_hi:[1,1,1] neg_lo:[1,0,0] neg_hi:[1,0,0]
v_pk_fma_f32 v[84:85], v[106:107], v[66:67], v[84:85] op_sel:[1,0,0] op_sel_hi:[1,1,1]
v_pk_fma_f32 v[70:71], v[106:107], v[68:69], v[70:71] op_sel_hi:[0,1,1]
v_pk_fma_f32 v[86:87], v[106:107], v[84:85], v[86:87] op_sel_hi:[0,1,1]
v_pk_fma_f32 v[70:71], v[106:107], v[84:85], v[70:71] op_sel:[1,0,0] op_sel_hi:[1,1,1] neg_lo:[1,0,0] neg_hi:[1,0,0]
v_pk_fma_f32 v[86:87], v[106:107], v[68:69], v[86:87] op_sel:[1,0,0] op_sel_hi:[1,1,1]
v_pk_fma_f32 v[72:73], v[106:107], v[70:71], v[72:73] op_sel_hi:[0,1,1]
v_pk_fma_f32 v[88:89], v[106:107], v[86:87], v[88:89] op_sel_hi:[0,1,1]
v_pk_fma_f32 v[72:73], v[106:107], v[86:87], v[72:73] op_sel:[1,0,0] op_sel_hi:[1,1,1] neg_lo:[1,0,0] neg_hi:[1,0,0]
v_pk_fma_f32 v[88:89], v[106:107], v[70:71], v[88:89] op_sel:[1,0,0] op_sel_hi:[1,1,1]
v_pk_fma_f32 v[74:75], v[106:107], v[72:73], v[74:75] op_sel_hi:[0,1,1]
v_pk_fma_f32 v[90:91], v[106:107], v[88:89], v[90:91] op_sel_hi:[0,1,1]
v_pk_fma_f32 v[74:75], v[106:107], v[88:89], v[74:75] op_sel:[1,0,0] op_sel_hi:[1,1,1] neg_lo:[1,0,0] neg_hi:[1,0,0]
v_pk_fma_f32 v[90:91], v[106:107], v[72:73], v[90:91] op_sel:[1,0,0] op_sel_hi:[1,1,1]
v_pk_fma_f32 v[76:77], v[106:107], v[74:75], v[76:77] op_sel_hi:[0,1,1]
v_pk_fma_f32 v[92:93], v[106:107], v[90:91], v[92:93] op_sel_hi:[0,1,1]
v_pk_fma_f32 v[76:77], v[106:107], v[90:91], v[76:77] op_sel:[1,0,0] op_sel_hi:[1,1,1] neg_lo:[1,0,0] neg_hi:[1,0,0]
v_pk_fma_f32 v[92:93], v[106:107], v[74:75], v[92:93] op_sel:[1,0,0] op_sel_hi:[1,1,1]
v_pk_fma_f32 v[78:79], v[106:107], v[76:77], v[78:79] op_sel_hi:[0,1,1]
v_pk_fma_f32 v[94:95], v[106:107], v[92:93], v[94:95] op_sel_hi:[0,1,1]
v_pk_fma_f32 v[78:79], v[106:107], v[92:93], v[78:79] op_sel:[1,0,0] op_sel_hi:[1,1,1] neg_lo:[1,0,0] neg_hi:[1,0,0]
v_pk_fma_f32 v[94:95], v[106:107], v[76:77], v[94:95] op_sel:[1,0,0] op_sel_hi:[1,1,1]
s_mul_i32 s64, s59, 7680
v_mul_u32_u24 v24, 3840, v2
v_lshl_add_u32 v24, v16, 2, v24
v_add_u32 v24, s64, v24
v_add_u32 v24, 15360, v24
v_and_b32 v25, 31, v1
v_cmp_gt_u32 vcc, 8, v25
s_and_saveexec_b64 s[22:23], vcc
v_cvt_pk_bf16_f32 v26, v64, v80
ds_write_b32 v24, v26 offset:0
v_cvt_pk_bf16_f32 v27, v65, v81
ds_write_b32 v24, v27 offset:1920
v_cvt_pk_bf16_f32 v28, v66, v82
ds_write_b32 v24, v28 offset:240
v_cvt_pk_bf16_f32 v29, v67, v83
ds_write_b32 v24, v29 offset:2160
v_cvt_pk_bf16_f32 v26, v68, v84
ds_write_b32 v24, v26 offset:480
v_cvt_pk_bf16_f32 v27, v69, v85
ds_write_b32 v24, v27 offset:2400
v_cvt_pk_bf16_f32 v28, v70, v86
ds_write_b32 v24, v28 offset:720
v_cvt_pk_bf16_f32 v29, v71, v87
ds_write_b32 v24, v29 offset:2640
v_cvt_pk_bf16_f32 v26, v72, v88
ds_write_b32 v24, v26 offset:960
v_cvt_pk_bf16_f32 v27, v73, v89
ds_write_b32 v24, v27 offset:2880
v_cvt_pk_bf16_f32 v28, v74, v90
ds_write_b32 v24, v28 offset:1200
v_cvt_pk_bf16_f32 v29, v75, v91
ds_write_b32 v24, v29 offset:3120
v_cvt_pk_bf16_f32 v26, v76, v92
ds_write_b32 v24, v26 offset:1440
v_cvt_pk_bf16_f32 v27, v77, v93
ds_write_b32 v24, v27 offset:3360
v_cvt_pk_bf16_f32 v28, v78, v94
ds_write_b32 v24, v28 offset:1680
v_cvt_pk_bf16_f32 v29, v79, v95
ds_write_b32 v24, v29 offset:3600
s_mov_b64 exec, s[22:23]
s_cmp_lg_u32 s57, 0
s_cbranch_scc1 L_nologit2
s_lshl_b32 s65, s59, 7
v_and_b32 v21, 31, v1
v_lshlrev_b32 v21, 2, v21
v_add_u32 v20, s65, v21
v_add_u32 v22, 157168, v20
ds_read_b32 v23, v22
s_lshl_b32 s64, s56, 9
s_add_u32 s64, s64, 14680064
v_mov_b32 v21, 2146435072
v_cmp_gt_u32 vcc, 32, v1
s_nop 1
v_cndmask_b32 v20, v21, v20, vcc
s_waitcnt lgkmcnt(0)
buffer_store_dword v23, v20, s[52:55], s64 offen sc1
L_nologit2:
v_lshrrev_b32 v20, 4, v1
v_and_b32 v21, 15, v1
v_lshrrev_b32 v22, 1, v20
v_and_b32 v23, 1, v20
v_mul_u32_u24 v23, 5, v23
s_mul_i32 s64, s57, 10
s_lshl_b32 s65, s59, 1
v_add_u32 v22, s65, v22
v_lshl_add_u32 v24, v22, 4, v21
v_mul_u32_u24 v24, 240, v24
v_lshl_add_u32 v24, v23, 4, v24
v_add_u32 v24, 15360, v24
s_waitcnt lgkmcnt(0)
ds_read_b128 v[32:35], v24 offset:0
ds_read_b128 v[36:39], v24 offset:16
ds_read_b128 v[40:43], v24 offset:32
ds_read_b128 v[44:47], v24 offset:48
ds_read_b128 v[48:51], v24 offset:64
s_lshl_b32 s65, s56, 3
v_add_u32 v22, s65, v22
v_mul_u32_u24 v22, 61440, v22
v_add_u32 v25, s64, v23
v_lshl_add_u32 v22, v25, 8, v22
v_lshl_add_u32 v22, v21, 4, v22
s_waitcnt lgkmcnt(0)
buffer_store_dwordx4 v[32:35], v22, s[52:55], 0 offen offset:0 sc1
buffer_store_dwordx4 v[36:39], v22, s[52:55], 0 offen offset:256 sc1
buffer_store_dwordx4 v[40:43], v22, s[52:55], 0 offen offset:512 sc1
buffer_store_dwordx4 v[44:47], v22, s[52:55], 0 offen offset:768 sc1
buffer_store_dwordx4 v[48:51], v22, s[52:55], 0 offen offset:1024 sc1
s_waitcnt vmcnt(0)
s_waitcnt lgkmcnt(0)
v_mov_b32 v20, 153532
v_mov_b32 v21, 1
v_cmp_eq_u32 vcc, 0, v1
s_and_saveexec_b64 s[22:23], vcc
ds_add_rtn_u32 v22, v20, v21
s_mov_b64 exec, s[22:23]
s_waitcnt lgkmcnt(0)
v_readfirstlane_b32 s66, v22
s_cmp_lg_u32 s66, 3
s_cbranch_scc1 L_sig_a
s_lshl_b32 s66, s56, 4
s_add_u32 s66, s66, s57
s_lshl_b32 s66, s66, 6
s_add_u32 s66, s66, 14876672
v_lshlrev_b32 v21, 2, v1
v_mov_b32 v20, 2146435072
v_cmp_gt_u32 vcc, 16, v1
s_nop 1
v_cndmask_b32 v20, v20, v21, vcc
v_mov_b32 v21, s63
buffer_store_dword v21, v20, s[52:55], s66 offen sc1
L_sig_a:
v_mov_b32 v20, 153564
s_mov_b32 s22, 0
L_lw_76:
ds_read_b32 v21, v20
s_waitcnt lgkmcnt(0)
v_readfirstlane_b32 s64, v21
s_add_u32 s22, s22, 1
s_cmp_ge_u32 s64, 1
s_cbranch_scc1 L_lwok_76
s_cmp_lt_u32 s22, 4194304
s_cbranch_scc1 L_lw_76
L_lwok_76:
s_and_b32 s64, s2, 7
s_lshr_b32 s65, s2, 3
s_and_b32 s8, s64, 3
s_lshl_b32 s8, s8, 3
s_and_b32 s66, s65, 7
s_add_u32 s8, s8, s66
s_lshr_b32 s9, s64, 2
s_lshl_b32 s9, s9, 2
s_lshr_b32 s66, s65, 3
s_add_u32 s9, s9, s66
s_lshl_b32 s6, s58, 3
s_cmp_eq_u32 s58, 6
s_cselect_b32 s6, 47, s6
s_cmp_eq_u32 s58, 7
s_cselect_b32 s6, 54, s6
s_mov_b32 s7, 8
s_cmp_ge_u32 s58, 5
s_cselect_b32 s7, 7, s7
s_cmp_eq_u32 s58, 7
s_cselect_b32 s7, 6, s7
s_mul_i32 s10, s9, 60
s_add_u32 s10, s10, s6
s_mul_i32 s10, s10, 5120
s_add_u32 s10, s10, 8388608
v_lshlrev_b32 v18, 4, v1
s_cmp_gt_u32 s7, 6
s_cselect_b32 s64, 0, 2146435072
v_add_u32 v17, s64, v18
s_cmp_gt_u32 s7, 7
s_cselect_b32 s64, 0, 2146435072
v_add_u32 v19, s64, v18
v_lshlrev_b32 v3, 4, v1
s_cmp_gt_u32 s7, 6
s_cselect_b32 s64, 0, 2146435072
v_add_u32 v4, s64, v3
s_cmp_gt_u32 s7, 7
s_cselect_b32 s64, 0, 2146435072
v_add_u32 v5, s64, v3
v_and_b32 v6, 15, v1
s_lshl_b32 s64, s8, 6
v_add_u32 v6, s64, v6
s_add_u32 s39, s10, 35840
buffer_load_dwordx4 v[236:239], v5, s[52:55], s39 offen
s_add_u32 s39, s10, 36864
buffer_load_dwordx4 v[240:243], v5, s[52:55], s39 offen
s_add_u32 s39, s10, 37888
buffer_load_dwordx4 v[244:247], v5, s[52:55], s39 offen
s_add_u32 s39, s10, 38912
buffer_load_dwordx4 v[248:251], v5, s[52:55], s39 offen
s_add_u32 s39, s10, 39936
buffer_load_dwordx4 v[252:255], v5, s[52:55], s39 offen
s_add_u32 s39, s10, 30720
buffer_load_dwordx4 v[216:219], v4, s[52:55], s39 offen
s_add_u32 s39, s10, 31744
buffer_load_dwordx4 v[220:223], v4, s[52:55], s39 offen
s_add_u32 s39, s10, 32768
buffer_load_dwordx4 v[224:227], v4, s[52:55], s39 offen
s_add_u32 s39, s10, 33792
buffer_load_dwordx4 v[228:231], v4, s[52:55], s39 offen
s_add_u32 s39, s10, 34816
buffer_load_dwordx4 v[232:235], v4, s[52:55], s39 offen
s_add_u32 s39, s10, 25600
buffer_load_dwordx4 v[196:199], v3, s[52:55], s39 offen
s_add_u32 s39, s10, 26624
buffer_load_dwordx4 v[200:203], v3, s[52:55], s39 offen
s_add_u32 s39, s10, 27648
buffer_load_dwordx4 v[204:207], v3, s[52:55], s39 offen
s_add_u32 s39, s10, 28672
buffer_load_dwordx4 v[208:211], v3, s[52:55], s39 offen
s_add_u32 s39, s10, 29696
buffer_load_dwordx4 v[212:215], v3, s[52:55], s39 offen
s_add_u32 s39, s10, 20480
buffer_load_dwordx4 v[176:179], v3, s[52:55], s39 offen
s_add_u32 s39, s10, 21504
buffer_load_dwordx4 v[180:183], v3, s[52:55], s39 offen
s_add_u32 s39, s10, 22528
buffer_load_dwordx4 v[184:187], v3, s[52:55], s39 offen
s_add_u32 s39, s10, 23552
buffer_load_dwordx4 v[188:191], v3, s[52:55], s39 offen
s_add_u32 s39, s10, 24576
buffer_load_dwordx4 v[192:195], v3, s[52:55], s39 offen
v_mov_b32 v20, 153524
s_mov_b32 s22, 0
L_lw_77:
ds_read_b32 v21, v20
s_waitcnt lgkmcnt(0)
v_readfirstlane_b32 s64, v21
s_add_u32 s22, s22, 1
s_cmp_ge_u32 s64, 1
s_cbranch_scc1 L_lwok_77
s_cmp_lt_u32 s22, 4194304
s_cbranch_scc1 L_lw_77
L_lwok_77:
v_lshlrev_b32 v3, 4, v1
s_cmp_gt_u32 s7, 6
s_cselect_b32 s64, 0, 2146435072
v_add_u32 v4, s64, v3
s_cmp_gt_u32 s7, 7
s_cselect_b32 s64, 0, 2146435072
v_add_u32 v5, s64, v3
v_and_b32 v6, 15, v1
s_lshl_b32 s64, s8, 6
v_add_u32 v6, s64, v6
s_add_u32 s39, s10, 15360
buffer_load_dwordx4 v[156:159], v3, s[52:55], s39 offen
s_add_u32 s39, s10, 16384
buffer_load_dwordx4 v[160:163], v3, s[52:55], s39 offen
s_add_u32 s39, s10, 17408
buffer_load_dwordx4 v[164:167], v3, s[52:55], s39 offen
s_add_u32 s39, s10, 18432
buffer_load_dwordx4 v[168:171], v3, s[52:55], s39 offen
s_add_u32 s39, s10, 19456
buffer_load_dwordx4 v[172:175], v3, s[52:55], s39 offen
s_add_u32 s39, s10, 10240
buffer_load_dwordx4 v[136:139], v3, s[52:55], s39 offen
s_add_u32 s39, s10, 11264
buffer_load_dwordx4 v[140:143], v3, s[52:55], s39 offen
s_add_u32 s39, s10, 12288
buffer_load_dwordx4 v[144:147], v3, s[52:55], s39 offen
s_add_u32 s39, s10, 13312
buffer_load_dwordx4 v[148:151], v3, s[52:55], s39 offen
s_add_u32 s39, s10, 14336
buffer_load_dwordx4 v[152:155], v3, s[52:55], s39 offen
s_add_u32 s39, s10, 5120
buffer_load_dwordx4 v[116:119], v3, s[52:55], s39 offen
s_add_u32 s39, s10, 6144
buffer_load_dwordx4 v[120:123], v3, s[52:55], s39 offen
s_add_u32 s39, s10, 7168
buffer_load_dwordx4 v[124:127], v3, s[52:55], s39 offen
s_add_u32 s39, s10, 8192
buffer_load_dwordx4 v[128:131], v3, s[52:55], s39 offen
s_add_u32 s39, s10, 9216
buffer_load_dwordx4 v[132:135], v3, s[52:55], s39 offen
s_add_u32 s39, s10, 0
buffer_load_dwordx4 v[96:99], v3, s[52:55], s39 offen
s_add_u32 s39, s10, 1024
buffer_load_dwordx4 v[100:103], v3, s[52:55], s39 offen
s_add_u32 s39, s10, 2048
buffer_load_dwordx4 v[104:107], v3, s[52:55], s39 offen
s_add_u32 s39, s10, 3072
buffer_load_dwordx4 v[108:111], v3, s[52:55], s39 offen
s_add_u32 s39, s10, 4096
buffer_load_dwordx4 v[112:115], v3, s[52:55], s39 offen
s_cmp_lg_u32 s59, 1
s_cbranch_scc1 L_notx1
s_lshr_b32 s66, s8, 1
s_lshl_b32 s66, s66, 10
s_add_u32 s66, s66, 14876672
v_and_b32 v16, 15, v1
v_lshlrev_b32 v16, 2, v16
s_mov_b32 s22, 0
L_spoll_f2a:
s_mov_b32 s64, 0
s_add_u32 s65, s66, 0
s_load_dword s40, s[36:37], s65 glc
s_add_u32 s65, s66, 64
s_load_dword s41, s[36:37], s65 glc
s_add_u32 s65, s66, 128
s_load_dword s42, s[36:37], s65 glc
s_add_u32 s65, s66, 192
s_load_dword s43, s[36:37], s65 glc
s_add_u32 s65, s66, 256
s_load_dword s44, s[36:37], s65 glc
s_add_u32 s65, s66, 320
s_load_dword s45, s[36:37], s65 glc
s_add_u32 s65, s66, 384
s_load_dword s46, s[36:37], s65 glc
s_add_u32 s65, s66, 448
s_load_dword s47, s[36:37], s65 glc
s_add_u32 s65, s66, 512
s_load_dword s68, s[36:37], s65 glc
s_add_u32 s65, s66, 576
s_load_dword s69, s[36:37], s65 glc
s_add_u32 s65, s66, 640
s_load_dword s70, s[36:37], s65 glc
s_add_u32 s65, s66, 704
s_load_dword s71, s[36:37], s65 glc
s_add_u32 s65, s66, 768
s_load_dword s72, s[36:37], s65 glc
s_add_u32 s65, s66, 832
s_load_dword s73, s[36:37], s65 glc
s_add_u32 s65, s66, 896
s_load_dword s74, s[36:37], s65 glc
s_add_u32 s65, s66, 960
s_load_dword s75, s[36:37], s65 glc
s_waitcnt lgkmcnt(0)
s_xor_b32 s40, s40, s63
s_or_b32 s64, s64, s40
s_xor_b32 s41, s41, s63
s_or_b32 s64, s64, s41
s_xor_b32 s42, s42, s63
s_or_b32 s64, s64, s42
s_xor_b32 s43, s43, s63
s_or_b32 s64, s64, s43
s_xor_b32 s44, s44, s63
s_or_b32 s64, s64, s44
s_xor_b32 s45, s45, s63
s_or_b32 s64, s64, s45
s_xor_b32 s46, s46, s63
s_or_b32 s64, s64, s46
s_xor_b32 s47, s47, s63
s_or_b32 s64, s64, s47
s_xor_b32 s68, s68, s63
s_or_b32 s64, s64, s68
s_xor_b32 s69, s69, s63
s_or_b32 s64, s64, s69
s_xor_b32 s70, s70, s63
s_or_b32 s64, s64, s70
s_xor_b32 s71, s71, s63
s_or_b32 s64, s64, s71
s_xor_b32 s72, s72, s63
s_or_b32 s64, s64, s72
s_xor_b32 s73, s73, s63
s_or_b32 s64, s64, s73
s_xor_b32 s74, s74, s63
s_or_b32 s64, s64, s74
s_xor_b32 s75, s75, s63
s_or_b32 s64, s64, s75
s_add_u32 s22, s22, 1
s_cmp_eq_u32 s64, 0
s_cbranch_scc1 L_spollok_f2a
s_cmp_lt_u32 s22, 262144
s_cbranch_scc1 L_spoll_f2a
L_spollok_f2a:
v_mov_b32 v20, 153544
v_mov_b32 v21, 1
s_waitcnt lgkmcnt(0)
ds_write_b32 v20, v21
L_notx1:
v_mov_b32 v20, 153544
s_mov_b32 s22, 0
L_lw_78:
ds_read_b32 v21, v20
s_waitcnt lgkmcnt(0)
v_readfirstlane_b32 s64, v21
s_add_u32 s22, s22, 1
s_cmp_ge_u32 s64, 1
s_cbranch_scc1 L_lwok_78
s_cmp_lt_u32 s22, 4194304
s_cbranch_scc1 L_lw_78
L_lwok_78:
v_mov_b32 v20, 153504
s_mov_b32 s22, 0
L_lw_79:
ds_read_b32 v21, v20
s_waitcnt lgkmcnt(0)
v_readfirstlane_b32 s64, v21
s_add_u32 s22, s22, 1
s_cmp_ge_u32 s64, 4
s_cbranch_scc1 L_lwok_79
s_cmp_lt_u32 s22, 4194304
s_cbranch_scc1 L_lw_79
L_lwok_79:
s_lshl_b32 s38, s8, 2
s_mul_i32 s38, s38, 60
s_add_u32 s38, s38, s6
s_lshl_b32 s38, s38, 10
v_lshlrev_b32 v20, 2, v6
s_add_u32 s39, s59, 1
s_and_b32 s39, s39, 3
s_mul_i32 s12, s39, 61440
s_add_u32 s12, s12, s38
s_lshl_b32 s39, s39, 6
s_add_u32 s39, s39, 14680064
buffer_load_dword v8, v20, s[52:55], s39 offen
s_add_u32 s39, s59, 2
s_and_b32 s39, s39, 3
s_mul_i32 s13, s39, 61440
s_add_u32 s13, s13, s38
s_lshl_b32 s39, s39, 6
s_add_u32 s39, s39, 14680064
buffer_load_dword v9, v20, s[52:55], s39 offen
s_add_u32 s39, s59, 3
s_and_b32 s39, s39, 3
s_mul_i32 s14, s39, 61440
s_add_u32 s14, s14, s38
s_lshl_b32 s39, s39, 6
s_add_u32 s39, s39, 14680064
buffer_load_dword v10, v20, s[52:55], s39 offen
s_add_u32 s39, s59, 4
s_and_b32 s39, s39, 3
s_mul_i32 s15, s39, 61440
s_add_u32 s15, s15, s38
s_lshl_b32 s39, s39, 6
s_add_u32 s39, s39, 14680064
buffer_load_dword v11, v20, s[52:55], s39 offen
s_add_u32 s64, s12, 0
buffer_load_dwordx4 v[72:75], v3, s[52:55], s64 offen
s_add_u32 s64, s12, 1024
buffer_load_dwordx4 v[76:79], v3, s[52:55], s64 offen
s_add_u32 s64, s12, 2048
buffer_load_dwordx4 v[80:83], v3, s[52:55], s64 offen
s_add_u32 s64, s12, 3072
buffer_load_dwordx4 v[84:87], v3, s[52:55], s64 offen
s_add_u32 s64, s12, 4096
buffer_load_dwordx4 v[88:91], v3, s[52:55], s64 offen
s_add_u32 s64, s12, 5120
buffer_load_dwordx4 v[92:95], v3, s[52:55], s64 offen
s_add_u32 s64, s12, 6144
buffer_load_dwordx4 v[12:15], v3, s[52:55], s64 offen
s_add_u32 s64, s12, 7168
buffer_load_dwordx4 v[16:19], v3, s[52:55], s64 offen
s_mov_b32 s67, 46080
s_cmp_eq_u32 s59, 1
s_cselect_b32 s67, 66560, s67
s_cmp_eq_u32 s59, 2
s_cselect_b32 s67, 102400, s67
s_cmp_eq_u32 s59, 3
s_cselect_b32 s67, 122880, s67
v_add_u32 v7, s67, v3
s_waitcnt vmcnt(8)
v_mul_f32 v8, 0xbfb8aa3b, v8
v_exp_f32 v8, v8
s_nop 0
v_add_f32 v8, 1.0, v8
v_rcp_f32 v8, v8
v_mul_f32 v9, 0xbfb8aa3b, v9
v_exp_f32 v9, v9
s_nop 0
v_add_f32 v9, 1.0, v9
v_rcp_f32 v9, v9
v_mul_f32 v10, 0xbfb8aa3b, v10
v_exp_f32 v10, v10
s_nop 0
v_add_f32 v10, 1.0, v10
v_rcp_f32 v10, v10
v_mul_f32 v11, 0xbfb8aa3b, v11
v_exp_f32 v11, v11
s_nop 0
v_add_f32 v11, 1.0, v11
v_rcp_f32 v11, v11
s_waitcnt vmcnt(7)
v_mfma_f32_16x16x32_bf16 v[32:35], v[96:99], v[72:75], 0
v_mfma_f32_16x16x32_bf16 v[36:39], v[100:103], v[72:75], 0
v_mfma_f32_16x16x32_bf16 v[40:43], v[104:107], v[72:75], 0
v_mfma_f32_16x16x32_bf16 v[44:47], v[108:111], v[72:75], 0
v_mfma_f32_16x16x32_bf16 v[48:51], v[112:115], v[72:75], 0
s_add_u32 s64, s13, 0
buffer_load_dwordx4 v[72:75], v3, s[52:55], s64 offen
s_waitcnt vmcnt(7)
v_mfma_f32_16x16x32_bf16 v[32:35], v[116:119], v[76:79], v[32:35]
v_mfma_f32_16x16x32_bf16 v[36:39], v[120:123], v[76:79], v[36:39]
v_mfma_f32_16x16x32_bf16 v[40:43], v[124:127], v[76:79], v[40:43]
v_mfma_f32_16x16x32_bf16 v[44:47], v[128:131], v[76:79], v[44:47]
v_mfma_f32_16x16x32_bf16 v[48:51], v[132:135], v[76:79], v[48:51]
s_add_u32 s64, s13, 1024
buffer_load_dwordx4 v[76:79], v3, s[52:55], s64 offen
s_waitcnt vmcnt(7)
v_mfma_f32_16x16x32_bf16 v[32:35], v[136:139], v[80:83], v[32:35]
v_mfma_f32_16x16x32_bf16 v[36:39], v[140:143], v[80:83], v[36:39]
v_mfma_f32_16x16x32_bf16 v[40:43], v[144:147], v[80:83], v[40:43]
v_mfma_f32_16x16x32_bf16 v[44:47], v[148:151], v[80:83], v[44:47]
v_mfma_f32_16x16x32_bf16 v[48:51], v[152:155], v[80:83], v[48:51]
s_add_u32 s64, s13, 2048
buffer_load_dwordx4 v[80:83], v3, s[52:55], s64 offen
s_waitcnt vmcnt(7)
v_mfma_f32_16x16x32_bf16 v[32:35], v[156:159], v[84:87], v[32:35]
v_mfma_f32_16x16x32_bf16 v[36:39], v[160:163], v[84:87], v[36:39]
v_mfma_f32_16x16x32_bf16 v[40:43], v[164:167], v[84:87], v[40:43]
v_mfma_f32_16x16x32_bf16 v[44:47], v[168:171], v[84:87], v[44:47]
v_mfma_f32_16x16x32_bf16 v[48:51], v[172:175], v[84:87], v[48:51]
s_add_u32 s64, s13, 3072
buffer_load_dwordx4 v[84:87], v3, s[52:55], s64 offen
s_waitcnt vmcnt(7)
v_mfma_f32_16x16x32_bf16 v[32:35], v[176:179], v[88:91], v[32:35]
v_mfma_f32_16x16x32_bf16 v[36:39], v[180:183], v[88:91], v[36:39]
v_mfma_f32_16x16x32_bf16 v[40:43], v[184:187], v[88:91], v[40:43]
v_mfma_f32_16x16x32_bf16 v[44:47], v[188:191], v[88:91], v[44:47]
v_mfma_f32_16x16x32_bf16 v[48:51], v[192:195], v[88:91], v[48:51]
s_add_u32 s64, s13, 4096
buffer_load_dwordx4 v[88:91], v3, s[52:55], s64 offen
s_waitcnt vmcnt(7)
v_mfma_f32_16x16x32_bf16 v[32:35], v[196:199], v[92:95], v[32:35]
v_mfma_f32_16x16x32_bf16 v[36:39], v[200:203], v[92:95], v[36:39]
v_mfma_f32_16x16x32_bf16 v[40:43], v[204:207], v[92:95], v[40:43]
v_mfma_f32_16x16x32_bf16 v[44:47], v[208:211], v[92:95], v[44:47]
v_mfma_f32_16x16x32_bf16 v[48:51], v[212:215], v[92:95], v[48:51]
s_add_u32 s64, s13, 5120
buffer_load_dwordx4 v[92:95], v3, s[52:55], s64 offen
s_waitcnt vmcnt(7)
v_mfma_f32_16x16x32_bf16 v[32:35], v[216:219], v[12:15], v[32:35]
v_mfma_f32_16x16x32_bf16 v[36:39], v[220:223], v[12:15], v[36:39]
v_mfma_f32_16x16x32_bf16 v[40:43], v[224:227], v[12:15], v[40:43]
v_mfma_f32_16x16x32_bf16 v[44:47], v[228:231], v[12:15], v[44:47]
v_mfma_f32_16x16x32_bf16 v[48:51], v[232:235], v[12:15], v[48:51]
s_add_u32 s64, s13, 6144
buffer_load_dwordx4 v[12:15], v3, s[52:55], s64 offen
s_waitcnt vmcnt(7)
v_mfma_f32_16x16x32_bf16 v[32:35], v[236:239], v[16:19], v[32:35]
v_mfma_f32_16x16x32_bf16 v[36:39], v[240:243], v[16:19], v[36:39]
v_mfma_f32_16x16x32_bf16 v[40:43], v[244:247], v[16:19], v[40:43]
v_mfma_f32_16x16x32_bf16 v[44:47], v[248:251], v[16:19], v[44:47]
v_mfma_f32_16x16x32_bf16 v[48:51], v[252:255], v[16:19], v[48:51]
s_add_u32 s64, s13, 7168
buffer_load_dwordx4 v[16:19], v3, s[52:55], s64 offen
s_nop 1
v_pk_mul_f32 v[32:33], v[32:33], v[8:9] op_sel_hi:[1,0]
v_pk_mul_f32 v[34:35], v[34:35], v[8:9] op_sel_hi:[1,0]
v_pk_mul_f32 v[36:37], v[36:37], v[8:9] op_sel_hi:[1,0]
v_pk_mul_f32 v[38:39], v[38:39], v[8:9] op_sel_hi:[1,0]
v_pk_mul_f32 v[40:41], v[40:41], v[8:9] op_sel_hi:[1,0]
v_pk_mul_f32 v[42:43], v[42:43], v[8:9] op_sel_hi:[1,0]
v_pk_mul_f32 v[44:45], v[44:45], v[8:9] op_sel_hi:[1,0]
v_pk_mul_f32 v[46:47], v[46:47], v[8:9] op_sel_hi:[1,0]
v_pk_mul_f32 v[48:49], v[48:49], v[8:9] op_sel_hi:[1,0]
v_pk_mul_f32 v[50:51], v[50:51], v[8:9] op_sel_hi:[1,0]
ds_write_b128 v7, v[32:35] offset:0
ds_write_b128 v7, v[36:39] offset:1024
ds_write_b128 v7, v[40:43] offset:2048
ds_write_b128 v7, v[44:47] offset:3072
ds_write_b128 v7, v[48:51] offset:4096
s_waitcnt vmcnt(7)
v_mfma_f32_16x16x32_bf16 v[52:55], v[96:99], v[72:75], 0
v_mfma_f32_16x16x32_bf16 v[56:59], v[100:103], v[72:75], 0
v_mfma_f32_16x16x32_bf16 v[60:63], v[104:107], v[72:75], 0
v_mfma_f32_16x16x32_bf16 v[64:67], v[108:111], v[72:75], 0
v_mfma_f32_16x16x32_bf16 v[68:71], v[112:115], v[72:75], 0
s_add_u32 s64, s14, 0
buffer_load_dwordx4 v[72:75], v3, s[52:55], s64 offen
s_waitcnt vmcnt(7)
v_mfma_f32_16x16x32_bf16 v[52:55], v[116:119], v[76:79], v[52:55]
v_mfma_f32_16x16x32_bf16 v[56:59], v[120:123], v[76:79], v[56:59]
v_mfma_f32_16x16x32_bf16 v[60:63], v[124:127], v[76:79], v[60:63]
v_mfma_f32_16x16x32_bf16 v[64:67], v[128:131], v[76:79], v[64:67]
v_mfma_f32_16x16x32_bf16 v[68:71], v[132:135], v[76:79], v[68:71]
s_add_u32 s64, s14, 1024
buffer_load_dwordx4 v[76:79], v3, s[52:55], s64 offen
s_waitcnt vmcnt(7)
v_mfma_f32_16x16x32_bf16 v[52:55], v[136:139], v[80:83], v[52:55]
v_mfma_f32_16x16x32_bf16 v[56:59], v[140:143], v[80:83], v[56:59]
v_mfma_f32_16x16x32_bf16 v[60:63], v[144:147], v[80:83], v[60:63]
v_mfma_f32_16x16x32_bf16 v[64:67], v[148:151], v[80:83], v[64:67]
v_mfma_f32_16x16x32_bf16 v[68:71], v[152:155], v[80:83], v[68:71]
s_add_u32 s64, s14, 2048
buffer_load_dwordx4 v[80:83], v3, s[52:55], s64 offen
s_waitcnt vmcnt(7)
v_mfma_f32_16x16x32_bf16 v[52:55], v[156:159], v[84:87], v[52:55]
v_mfma_f32_16x16x32_bf16 v[56:59], v[160:163], v[84:87], v[56:59]
v_mfma_f32_16x16x32_bf16 v[60:63], v[164:167], v[84:87], v[60:63]
v_mfma_f32_16x16x32_bf16 v[64:67], v[168:171], v[84:87], v[64:67]
v_mfma_f32_16x16x32_bf16 v[68:71], v[172:175], v[84:87], v[68:71]
s_add_u32 s64, s14, 3072
buffer_load_dwordx4 v[84:87], v3, s[52:55], s64 offen
s_waitcnt vmcnt(7)
v_mfma_f32_16x16x32_bf16 v[52:55], v[176:179], v[88:91], v[52:55]
v_mfma_f32_16x16x32_bf16 v[56:59], v[180:183], v[88:91], v[56:59]
v_mfma_f32_16x16x32_bf16 v[60:63], v[184:187], v[88:91], v[60:63]
v_mfma_f32_16x16x32_bf16 v[64:67], v[188:191], v[88:91], v[64:67]
v_mfma_f32_16x16x32_bf16 v[68:71], v[192:195], v[88:91], v[68:71]
s_add_u32 s64, s14, 4096
buffer_load_dwordx4 v[88:91], v3, s[52:55], s64 offen
s_waitcnt vmcnt(7)
v_mfma_f32_16x16x32_bf16 v[52:55], v[196:199], v[92:95], v[52:55]
v_mfma_f32_16x16x32_bf16 v[56:59], v[200:203], v[92:95], v[56:59]
v_mfma_f32_16x16x32_bf16 v[60:63], v[204:207], v[92:95], v[60:63]
v_mfma_f32_16x16x32_bf16 v[64:67], v[208:211], v[92:95], v[64:67]
v_mfma_f32_16x16x32_bf16 v[68:71], v[212:215], v[92:95], v[68:71]
s_add_u32 s64, s14, 5120
buffer_load_dwordx4 v[92:95], v3, s[52:55], s64 offen
s_waitcnt vmcnt(7)
v_mfma_f32_16x16x32_bf16 v[52:55], v[216:219], v[12:15], v[52:55]
v_mfma_f32_16x16x32_bf16 v[56:59], v[220:223], v[12:15], v[56:59]
v_mfma_f32_16x16x32_bf16 v[60:63], v[224:227], v[12:15], v[60:63]
v_mfma_f32_16x16x32_bf16 v[64:67], v[228:231], v[12:15], v[64:67]
v_mfma_f32_16x16x32_bf16 v[68:71], v[232:235], v[12:15], v[68:71]
s_add_u32 s64, s14, 6144
buffer_load_dwordx4 v[12:15], v3, s[52:55], s64 offen
s_waitcnt vmcnt(7)
v_mfma_f32_16x16x32_bf16 v[52:55], v[236:239], v[16:19], v[52:55]
v_mfma_f32_16x16x32_bf16 v[56:59], v[240:243], v[16:19], v[56:59]
v_mfma_f32_16x16x32_bf16 v[60:63], v[244:247], v[16:19], v[60:63]
v_mfma_f32_16x16x32_bf16 v[64:67], v[248:251], v[16:19], v[64:67]
v_mfma_f32_16x16x32_bf16 v[68:71], v[252:255], v[16:19], v[68:71]
s_add_u32 s64, s14, 7168
buffer_load_dwordx4 v[16:19], v3, s[52:55], s64 offen
s_nop 1
v_pk_mul_f32 v[52:53], v[52:53], v[8:9] op_sel:[0,1] op_sel_hi:[1,1]
v_pk_mul_f32 v[54:55], v[54:55], v[8:9] op_sel:[0,1] op_sel_hi:[1,1]
v_pk_mul_f32 v[56:57], v[56:57], v[8:9] op_sel:[0,1] op_sel_hi:[1,1]
v_pk_mul_f32 v[58:59], v[58:59], v[8:9] op_sel:[0,1] op_sel_hi:[1,1]
v_pk_mul_f32 v[60:61], v[60:61], v[8:9] op_sel:[0,1] op_sel_hi:[1,1]
v_pk_mul_f32 v[62:63], v[62:63], v[8:9] op_sel:[0,1] op_sel_hi:[1,1]
v_pk_mul_f32 v[64:65], v[64:65], v[8:9] op_sel:[0,1] op_sel_hi:[1,1]
v_pk_mul_f32 v[66:67], v[66:67], v[8:9] op_sel:[0,1] op_sel_hi:[1,1]
v_pk_mul_f32 v[68:69], v[68:69], v[8:9] op_sel:[0,1] op_sel_hi:[1,1]
v_pk_mul_f32 v[70:71], v[70:71], v[8:9] op_sel:[0,1] op_sel_hi:[1,1]
ds_write_b128 v7, v[52:55] offset:5120
ds_write_b128 v7, v[56:59] offset:6144
ds_write_b128 v7, v[60:63] offset:7168
ds_write_b128 v7, v[64:67] offset:8192
ds_write_b128 v7, v[68:71] offset:9216
s_waitcnt vmcnt(7)
v_mfma_f32_16x16x32_bf16 v[32:35], v[96:99], v[72:75], 0
v_mfma_f32_16x16x32_bf16 v[36:39], v[100:103], v[72:75], 0
v_mfma_f32_16x16x32_bf16 v[40:43], v[104:107], v[72:75], 0
v_mfma_f32_16x16x32_bf16 v[44:47], v[108:111], v[72:75], 0
v_mfma_f32_16x16x32_bf16 v[48:51], v[112:115], v[72:75], 0
s_add_u32 s64, s15, 0
buffer_load_dwordx4 v[72:75], v3, s[52:55], s64 offen
s_waitcnt vmcnt(7)
v_mfma_f32_16x16x32_bf16 v[32:35], v[116:119], v[76:79], v[32:35]
v_mfma_f32_16x16x32_bf16 v[36:39], v[120:123], v[76:79], v[36:39]
v_mfma_f32_16x16x32_bf16 v[40:43], v[124:127], v[76:79], v[40:43]
v_mfma_f32_16x16x32_bf16 v[44:47], v[128:131], v[76:79], v[44:47]
v_mfma_f32_16x16x32_bf16 v[48:51], v[132:135], v[76:79], v[48:51]
s_add_u32 s64, s15, 1024
buffer_load_dwordx4 v[76:79], v3, s[52:55], s64 offen
s_waitcnt vmcnt(7)
v_mfma_f32_16x16x32_bf16 v[32:35], v[136:139], v[80:83], v[32:35]
v_mfma_f32_16x16x32_bf16 v[36:39], v[140:143], v[80:83], v[36:39]
v_mfma_f32_16x16x32_bf16 v[40:43], v[144:147], v[80:83], v[40:43]
v_mfma_f32_16x16x32_bf16 v[44:47], v[148:151], v[80:83], v[44:47]
v_mfma_f32_16x16x32_bf16 v[48:51], v[152:155], v[80:83], v[48:51]
s_add_u32 s64, s15, 2048
buffer_load_dwordx4 v[80:83], v3, s[52:55], s64 offen
s_waitcnt vmcnt(7)
v_mfma_f32_16x16x32_bf16 v[32:35], v[156:159], v[84:87], v[32:35]
v_mfma_f32_16x16x32_bf16 v[36:39], v[160:163], v[84:87], v[36:39]
v_mfma_f32_16x16x32_bf16 v[40:43], v[164:167], v[84:87], v[40:43]
v_mfma_f32_16x16x32_bf16 v[44:47], v[168:171], v[84:87], v[44:47]
v_mfma_f32_16x16x32_bf16 v[48:51], v[172:175], v[84:87], v[48:51]
s_add_u32 s64, s15, 3072
buffer_load_dwordx4 v[84:87], v3, s[52:55], s64 offen
s_waitcnt vmcnt(7)
v_mfma_f32_16x16x32_bf16 v[32:35], v[176:179], v[88:91], v[32:35]
v_mfma_f32_16x16x32_bf16 v[36:39], v[180:183], v[88:91], v[36:39]
v_mfma_f32_16x16x32_bf16 v[40:43], v[184:187], v[88:91], v[40:43]
v_mfma_f32_16x16x32_bf16 v[44:47], v[188:191], v[88:91], v[44:47]
v_mfma_f32_16x16x32_bf16 v[48:51], v[192:195], v[88:91], v[48:51]
s_add_u32 s64, s15, 4096
buffer_load_dwordx4 v[88:91], v3, s[52:55], s64 offen
s_waitcnt vmcnt(7)
v_mfma_f32_16x16x32_bf16 v[32:35], v[196:199], v[92:95], v[32:35]
v_mfma_f32_16x16x32_bf16 v[36:39], v[200:203], v[92:95], v[36:39]
v_mfma_f32_16x16x32_bf16 v[40:43], v[204:207], v[92:95], v[40:43]
v_mfma_f32_16x16x32_bf16 v[44:47], v[208:211], v[92:95], v[44:47]
v_mfma_f32_16x16x32_bf16 v[48:51], v[212:215], v[92:95], v[48:51]
s_add_u32 s64, s15, 5120
buffer_load_dwordx4 v[92:95], v3, s[52:55], s64 offen
s_waitcnt vmcnt(7)
v_mfma_f32_16x16x32_bf16 v[32:35], v[216:219], v[12:15], v[32:35]
v_mfma_f32_16x16x32_bf16 v[36:39], v[220:223], v[12:15], v[36:39]
v_mfma_f32_16x16x32_bf16 v[40:43], v[224:227], v[12:15], v[40:43]
v_mfma_f32_16x16x32_bf16 v[44:47], v[228:231], v[12:15], v[44:47]
v_mfma_f32_16x16x32_bf16 v[48:51], v[232:235], v[12:15], v[48:51]
s_add_u32 s64, s15, 6144
buffer_load_dwordx4 v[12:15], v3, s[52:55], s64 offen
s_waitcnt vmcnt(7)
v_mfma_f32_16x16x32_bf16 v[32:35], v[236:239], v[16:19], v[32:35]
v_mfma_f32_16x16x32_bf16 v[36:39], v[240:243], v[16:19], v[36:39]
v_mfma_f32_16x16x32_bf16 v[40:43], v[244:247], v[16:19], v[40:43]
v_mfma_f32_16x16x32_bf16 v[44:47], v[248:251], v[16:19], v[44:47]
v_mfma_f32_16x16x32_bf16 v[48:51], v[252:255], v[16:19], v[48:51]
s_add_u32 s64, s15, 7168
buffer_load_dwordx4 v[16:19], v3, s[52:55], s64 offen
s_nop 1
v_pk_mul_f32 v[32:33], v[32:33], v[10:11] op_sel_hi:[1,0]
v_pk_mul_f32 v[34:35], v[34:35], v[10:11] op_sel_hi:[1,0]
v_pk_mul_f32 v[36:37], v[36:37], v[10:11] op_sel_hi:[1,0]
v_pk_mul_f32 v[38:39], v[38:39], v[10:11] op_sel_hi:[1,0]
v_pk_mul_f32 v[40:41], v[40:41], v[10:11] op_sel_hi:[1,0]
v_pk_mul_f32 v[42:43], v[42:43], v[10:11] op_sel_hi:[1,0]
v_pk_mul_f32 v[44:45], v[44:45], v[10:11] op_sel_hi:[1,0]
v_pk_mul_f32 v[46:47], v[46:47], v[10:11] op_sel_hi:[1,0]
v_pk_mul_f32 v[48:49], v[48:49], v[10:11] op_sel_hi:[1,0]
v_pk_mul_f32 v[50:51], v[50:51], v[10:11] op_sel_hi:[1,0]
ds_write_b128 v7, v[32:35] offset:10240
ds_write_b128 v7, v[36:39] offset:11264
ds_write_b128 v7, v[40:43] offset:12288
ds_write_b128 v7, v[44:47] offset:13312
ds_write_b128 v7, v[48:51] offset:14336
s_waitcnt vmcnt(7)
v_mfma_f32_16x16x32_bf16 v[52:55], v[96:99], v[72:75], 0
v_mfma_f32_16x16x32_bf16 v[56:59], v[100:103], v[72:75], 0
v_mfma_f32_16x16x32_bf16 v[60:63], v[104:107], v[72:75], 0
v_mfma_f32_16x16x32_bf16 v[64:67], v[108:111], v[72:75], 0
v_mfma_f32_16x16x32_bf16 v[68:71], v[112:115], v[72:75], 0
s_waitcnt vmcnt(6)
v_mfma_f32_16x16x32_bf16 v[52:55], v[116:119], v[76:79], v[52:55]
v_mfma_f32_16x16x32_bf16 v[56:59], v[120:123], v[76:79], v[56:59]
v_mfma_f32_16x16x32_bf16 v[60:63], v[124:127], v[76:79], v[60:63]
v_mfma_f32_16x16x32_bf16 v[64:67], v[128:131], v[76:79], v[64:67]
v_mfma_f32_16x16x32_bf16 v[68:71], v[132:135], v[76:79], v[68:71]
s_waitcnt vmcnt(5)
v_mfma_f32_16x16x32_bf16 v[52:55], v[136:139], v[80:83], v[52:55]
v_mfma_f32_16x16x32_bf16 v[56:59], v[140:143], v[80:83], v[56:59]
v_mfma_f32_16x16x32_bf16 v[60:63], v[144:147], v[80:83], v[60:63]
v_mfma_f32_16x16x32_bf16 v[64:67], v[148:151], v[80:83], v[64:67]
v_mfma_f32_16x16x32_bf16 v[68:71], v[152:155], v[80:83], v[68:71]
s_waitcnt vmcnt(4)
v_mfma_f32_16x16x32_bf16 v[52:55], v[156:159], v[84:87], v[52:55]
v_mfma_f32_16x16x32_bf16 v[56:59], v[160:163], v[84:87], v[56:59]
v_mfma_f32_16x16x32_bf16 v[60:63], v[164:167], v[84:87], v[60:63]
v_mfma_f32_16x16x32_bf16 v[64:67], v[168:171], v[84:87], v[64:67]
v_mfma_f32_16x16x32_bf16 v[68:71], v[172:175], v[84:87], v[68:71]
s_waitcnt vmcnt(3)
v_mfma_f32_16x16x32_bf16 v[52:55], v[176:179], v[88:91], v[52:55]
v_mfma_f32_16x16x32_bf16 v[56:59], v[180:183], v[88:91], v[56:59]
v_mfma_f32_16x16x32_bf16 v[60:63], v[184:187], v[88:91], v[60:63]
v_mfma_f32_16x16x32_bf16 v[64:67], v[188:191], v[88:91], v[64:67]
v_mfma_f32_16x16x32_bf16 v[68:71], v[192:195], v[88:91], v[68:71]
s_waitcnt vmcnt(2)
v_mfma_f32_16x16x32_bf16 v[52:55], v[196:199], v[92:95], v[52:55]
v_mfma_f32_16x16x32_bf16 v[56:59], v[200:203], v[92:95], v[56:59]
v_mfma_f32_16x16x32_bf16 v[60:63], v[204:207], v[92:95], v[60:63]
v_mfma_f32_16x16x32_bf16 v[64:67], v[208:211], v[92:95], v[64:67]
v_mfma_f32_16x16x32_bf16 v[68:71], v[212:215], v[92:95], v[68:71]
s_waitcnt vmcnt(1)
v_mfma_f32_16x16x32_bf16 v[52:55], v[216:219], v[12:15], v[52:55]
v_mfma_f32_16x16x32_bf16 v[56:59], v[220:223], v[12:15], v[56:59]
v_mfma_f32_16x16x32_bf16 v[60:63], v[224:227], v[12:15], v[60:63]
v_mfma_f32_16x16x32_bf16 v[64:67], v[228:231], v[12:15], v[64:67]
v_mfma_f32_16x16x32_bf16 v[68:71], v[232:235], v[12:15], v[68:71]
s_waitcnt vmcnt(0)
v_mfma_f32_16x16x32_bf16 v[52:55], v[236:239], v[16:19], v[52:55]
v_mfma_f32_16x16x32_bf16 v[56:59], v[240:243], v[16:19], v[56:59]
v_mfma_f32_16x16x32_bf16 v[60:63], v[244:247], v[16:19], v[60:63]
v_mfma_f32_16x16x32_bf16 v[64:67], v[248:251], v[16:19], v[64:67]
v_mfma_f32_16x16x32_bf16 v[68:71], v[252:255], v[16:19], v[68:71]
s_nop 3
v_pk_mul_f32 v[52:53], v[52:53], v[10:11] op_sel:[0,1] op_sel_hi:[1,1]
v_pk_mul_f32 v[54:55], v[54:55], v[10:11] op_sel:[0,1] op_sel_hi:[1,1]
v_pk_mul_f32 v[56:57], v[56:57], v[10:11] op_sel:[0,1] op_sel_hi:[1,1]
v_pk_mul_f32 v[58:59], v[58:59], v[10:11] op_sel:[0,1] op_sel_hi:[1,1]
v_pk_mul_f32 v[60:61], v[60:61], v[10:11] op_sel:[0,1] op_sel_hi:[1,1]
v_pk_mul_f32 v[62:63], v[62:63], v[10:11] op_sel:[0,1] op_sel_hi:[1,1]
v_pk_mul_f32 v[64:65], v[64:65], v[10:11] op_sel:[0,1] op_sel_hi:[1,1]
v_pk_mul_f32 v[66:67], v[66:67], v[10:11] op_sel:[0,1] op_sel_hi:[1,1]
v_pk_mul_f32 v[68:69], v[68:69], v[10:11] op_sel:[0,1] op_sel_hi:[1,1]
v_pk_mul_f32 v[70:71], v[70:71], v[10:11] op_sel:[0,1] op_sel_hi:[1,1]
s_waitcnt lgkmcnt(0)
v_mov_b32 v20, 153552
v_mov_b32 v21, 1
v_cmp_eq_u32 vcc, 0, v1
s_and_saveexec_b64 s[22:23], vcc
ds_add_rtn_u32 v22, v20, v21
s_mov_b64 exec, s[22:23]
s_waitcnt lgkmcnt(0)
v_readfirstlane_b32 s66, v22
v_mov_b32 v20, 153552
s_mov_b32 s22, 0
L_lw_80:
ds_read_b32 v21, v20
s_waitcnt lgkmcnt(0)
v_readfirstlane_b32 s64, v21
s_add_u32 s22, s22, 1
s_cmp_ge_u32 s64, 4
s_cbranch_scc1 L_lwok_80
s_cmp_lt_u32 s22, 4194304
s_cbranch_scc1 L_lw_80
L_lwok_80:
s_add_u32 s64, s59, 1
s_and_b32 s64, s64, 3
s_mov_b32 s65, 46080
s_cmp_eq_u32 s64, 1
s_cselect_b32 s65, 66560, s65
s_cmp_eq_u32 s64, 2
s_cselect_b32 s65, 102400, s65
s_cmp_eq_u32 s64, 3
s_cselect_b32 s65, 122880, s65
s_add_u32 s65, s65, 10240
v_add_u32 v12, s65, v3
ds_read_b128 v[96:99], v12 offset:0
ds_read_b128 v[100:103], v12 offset:1024
ds_read_b128 v[104:107], v12 offset:2048
ds_read_b128 v[108:111], v12 offset:3072
ds_read_b128 v[112:115], v12 offset:4096
s_add_u32 s64, s59, 2
s_and_b32 s64, s64, 3
s_mov_b32 s65, 46080
s_cmp_eq_u32 s64, 1
s_cselect_b32 s65, 66560, s65
s_cmp_eq_u32 s64, 2
s_cselect_b32 s65, 102400, s65
s_cmp_eq_u32 s64, 3
s_cselect_b32 s65, 122880, s65
s_add_u32 s65, s65, 5120
v_add_u32 v12, s65, v3
ds_read_b128 v[116:119], v12 offset:0
ds_read_b128 v[120:123], v12 offset:1024
ds_read_b128 v[124:127], v12 offset:2048
ds_read_b128 v[128:131], v12 offset:3072
ds_read_b128 v[132:135], v12 offset:4096
s_add_u32 s64, s59, 3
s_and_b32 s64, s64, 3
s_mov_b32 s65, 46080
s_cmp_eq_u32 s64, 1
s_cselect_b32 s65, 66560, s65
s_cmp_eq_u32 s64, 2
s_cselect_b32 s65, 102400, s65
s_cmp_eq_u32 s64, 3
s_cselect_b32 s65, 122880, s65
s_add_u32 s65, s65, 0
v_add_u32 v12, s65, v3
ds_read_b128 v[136:139], v12 offset:0
ds_read_b128 v[140:143], v12 offset:1024
ds_read_b128 v[144:147], v12 offset:2048
ds_read_b128 v[148:151], v12 offset:3072
ds_read_b128 v[152:155], v12 offset:4096
s_waitcnt lgkmcnt(0)
v_pk_add_f32 v[52:53], v[52:53], v[96:97]
v_pk_add_f32 v[54:55], v[54:55], v[98:99]
v_pk_add_f32 v[56:57], v[56:57], v[100:101]
v_pk_add_f32 v[58:59], v[58:59], v[102:103]
v_pk_add_f32 v[60:61], v[60:61], v[104:105]
v_pk_add_f32 v[62:63], v[62:63], v[106:107]
v_pk_add_f32 v[64:65], v[64:65], v[108:109]
v_pk_add_f32 v[66:67], v[66:67], v[110:111]
v_pk_add_f32 v[68:69], v[68:69], v[112:113]
v_pk_add_f32 v[70:71], v[70:71], v[114:115]
v_pk_add_f32 v[52:53], v[52:53], v[116:117]
v_pk_add_f32 v[54:55], v[54:55], v[118:119]
v_pk_add_f32 v[56:57], v[56:57], v[120:121]
v_pk_add_f32 v[58:59], v[58:59], v[122:123]
v_pk_add_f32 v[60:61], v[60:61], v[124:125]
v_pk_add_f32 v[62:63], v[62:63], v[126:127]
v_pk_add_f32 v[64:65], v[64:65], v[128:129]
v_pk_add_f32 v[66:67], v[66:67], v[130:131]
v_pk_add_f32 v[68:69], v[68:69], v[132:133]
v_pk_add_f32 v[70:71], v[70:71], v[134:135]
v_pk_add_f32 v[52:53], v[52:53], v[136:137]
v_pk_add_f32 v[54:55], v[54:55], v[138:139]
v_pk_add_f32 v[56:57], v[56:57], v[140:141]
v_pk_add_f32 v[58:59], v[58:59], v[142:143]
v_pk_add_f32 v[60:61], v[60:61], v[144:145]
v_pk_add_f32 v[62:63], v[62:63], v[146:147]
v_pk_add_f32 v[64:65], v[64:65], v[148:149]
v_pk_add_f32 v[66:67], v[66:67], v[150:151]
v_pk_add_f32 v[68:69], v[68:69], v[152:153]
v_pk_add_f32 v[70:71], v[70:71], v[154:155]
s_mov_b32 s65, 46080
s_cmp_eq_u32 s59, 1
s_cselect_b32 s65, 66560, s65
s_cmp_eq_u32 s59, 2
s_cselect_b32 s65, 102400, s65
s_cmp_eq_u32 s59, 3
s_cselect_b32 s65, 122880, s65
s_add_u32 s65, s65, 15360
v_add_u32 v12, s65, v3
ds_write_b128 v12, v[52:55] offset:0
ds_write_b128 v12, v[56:59] offset:1024
ds_write_b128 v12, v[60:63] offset:2048
ds_write_b128 v12, v[64:67] offset:3072
ds_write_b128 v12, v[68:71] offset:4096
s_waitcnt lgkmcnt(0)
v_mov_b32 v20, 153560
v_mov_b32 v21, 1
v_cmp_eq_u32 vcc, 0, v1
s_and_saveexec_b64 s[22:23], vcc
ds_add_rtn_u32 v22, v20, v21
s_mov_b64 exec, s[22:23]
s_waitcnt lgkmcnt(0)
v_readfirstlane_b32 s66, v22
s_branch L_fin
L_roleY:
v_lshrrev_b32 v20, 3, v1
v_and_b32 v21, 7, v1
v_lshrrev_b32 v22, 1, v20
v_xor_b32 v22, v22, v21
v_xor_b32 v23, 4, v22
v_bfe_u32 v24, v20, 2, 1
v_lshlrev_b32 v24, 4, v24
v_and_b32 v25, 1, v20
v_lshl_add_u32 v24, v25, 3, v24
v_bfe_u32 v25, v20, 1, 1
v_add_u32 v24, v24, v25
s_lshl_b32 s64, s56, 7
s_lshr_b32 s65, s58, 1
s_lshl_b32 s65, s65, 5
s_add_u32 s64, s64, s65
s_and_b32 s65, s58, 1
s_lshl_b32 s65, s65, 2
s_add_u32 s64, s64, s65
v_add_u32 v24, s64, v24
v_mul_u32_u24 v24, 1280, v24
v_lshl_add_u32 v136, v22, 4, v24
v_lshl_add_u32 v137, v23, 4, v24
v_add_u32 v137, 2560, v137
s_lshl_b32 s60, s58, 11
v_lshrrev_b32 v24, 4, v1
v_bfe_u32 v25, v1, 2, 2
v_xor_b32 v25, v25, v24
v_and_b32 v26, 3, v1
v_lshl_add_u32 v27, v25, 2, v26
v_lshlrev_b32 v27, 2, v27
v_mov_b32 v28, 0x23024310
v_mov_b32 v29, 0x44124310
v_cmp_lt_u32 vcc, 31, v27
s_nop 1
v_cndmask_b32 v28, v28, v29, vcc
v_and_b32 v27, 31, v27
v_lshrrev_b32 v28, v27, v28
v_and_b32 v28, 7, v28
v_lshlrev_b32 v28, 4, v28
v_lshrrev_b32 v29, 1, v25
v_mul_u32_u24 v29, 1280, v29
v_and_b32 v27, 1, v25
v_cmp_lt_u32 vcc, 0, v26
s_nop 1
v_cndmask_b32 v27, 0, v27, vcc
v_mov_b32 v30, 2560
v_cmp_eq_u32 vcc, 1, v27
s_nop 1
v_cndmask_b32 v29, v29, v30, vcc
v_add_u32 v28, v28, v29
v_mul_u32_u24 v24, 3840, v24
v_add_u32 v28, v28, v24
s_mul_i32 s64, s57, 80
s_xor_b32 s65, s57, 1
s_mul_i32 s65, s65, 80
v_mov_b32 v27, s64
v_mov_b32 v30, s65
v_cmp_eq_u32 vcc, 0, v29
s_nop 1
v_cndmask_b32 v27, v27, v30, vcc
v_add_u32 v138, v27, v28
v_lshl_add_u32 v27, v25, 2, v26
v_mov_b32 v30, 2146435072
v_cmp_eq_u32 vcc, 15, v27
s_nop 1
v_cndmask_b32 v138, v138, v30, vcc
s_mul_i32 s62, s59, 3072
s_add_u32 s62, s62, 90112
s_mul_i32 s3, s59, 46080
s_add_u32 s3, s3, 61440
s_waitcnt lgkmcnt(0)
s_mov_b32 s40, s4
s_and_b32 s41, s5, 0xffff
s_mov_b32 s42, 2621440
s_mov_b32 s43, 0x20000
s_mov_b32 s48, s24
s_and_b32 s49, s25, 0xffff
s_mov_b32 s50, 2457600
s_mov_b32 s51, 0x20000
s_mov_b32 s52, s36
s_and_b32 s53, s37, 0xffff
s_mov_b32 s54, 268435456
s_mov_b32 s55, 0x20000
s_add_u32 m0, s60, 0
s_movk_i32 s23, 0
buffer_load_dwordx4 v136, s[40:43], s23 offen lds
s_add_u32 m0, s60, 1024
s_movk_i32 s23, 0
buffer_load_dwordx4 v137, s[40:43], s23 offen lds
s_add_u32 m0, s62, 0
s_add_u32 s23, s3, 0
buffer_load_dwordx4 v138, s[48:51], s23 offen lds
s_add_u32 m0, s62, 1024
s_add_u32 s23, s3, 15360
buffer_load_dwordx4 v138, s[48:51], s23 offen lds
s_add_u32 m0, s62, 2048
s_add_u32 s23, s3, 30720
buffer_load_dwordx4 v138, s[48:51], s23 offen lds
s_barrier
s_add_u32 m0, s60, 16384
s_movk_i32 s23, 128
buffer_load_dwordx4 v136, s[40:43], s23 offen lds
s_add_u32 m0, s60, 17408
s_movk_i32 s23, 128
buffer_load_dwordx4 v137, s[40:43], s23 offen lds
s_add_u32 m0, s62, 16384
s_add_u32 s23, s3, 245760
buffer_load_dwordx4 v138, s[48:51], s23 offen lds
s_add_u32 m0, s62, 17408
s_add_u32 s23, s3, 261120
buffer_load_dwordx4 v138, s[48:51], s23 offen lds
s_add_u32 m0, s62, 18432
s_add_u32 s23, s3, 276480
buffer_load_dwordx4 v138, s[48:51], s23 offen lds
v_and_b32 v24, 31, v1
v_bfe_u32 v26, v24, 1, 3
v_lshlrev_b32 v27, 7, v24
s_lshl_b32 s64, s59, 12
v_or_b32 v28, 0, v2
v_xor_b32 v28, v28, v26
v_lshl_add_u32 v28, v28, 4, v27
v_add_u32 v139, s64, v28
v_or_b32 v28, 2, v2
v_xor_b32 v28, v28, v26
v_lshl_add_u32 v28, v28, 4, v27
v_add_u32 v140, s64, v28
v_or_b32 v28, 4, v2
v_xor_b32 v28, v28, v26
v_lshl_add_u32 v28, v28, 4, v27
v_add_u32 v141, s64, v28
v_or_b32 v28, 6, v2
v_xor_b32 v28, v28, v26
v_lshl_add_u32 v28, v28, 4, v27
v_add_u32 v142, s64, v28
v_bfe_u32 v25, v1, 2, 2
v_lshl_add_u32 v26, v2, 3, v25
v_lshlrev_b32 v26, 8, v26
v_xor_b32 v27, 0, v25
v_lshl_add_u32 v26, v27, 6, v26
v_bfe_u32 v27, v1, 4, 1
v_bfe_u32 v28, v1, 1, 1
v_lshl_add_u32 v27, v27, 1, v28
v_and_b32 v28, 1, v1
v_lshl_add_u32 v27, v28, 2, v27
v_lshl_add_u32 v26, v27, 3, v26
v_add_u32 v143, 86016, v26
v_bfe_u32 v25, v1, 2, 2
v_lshl_add_u32 v26, v2, 3, v25
v_lshlrev_b32 v26, 8, v26
v_xor_b32 v27, 1, v25
v_lshl_add_u32 v26, v27, 6, v26
v_bfe_u32 v27, v1, 4, 1
v_bfe_u32 v28, v1, 1, 1
v_lshl_add_u32 v27, v27, 1, v28
v_and_b32 v28, 1, v1
v_lshl_add_u32 v27, v27, 1, v28
v_lshlrev_b32 v27, 2, v27
v_mov_b32 v29, 0x76534210
v_lshrrev_b32 v27, v27, v29
v_and_b32 v27, 7, v27
v_lshl_add_u32 v26, v27, 3, v26
v_add_u32 v144, 86016, v26
v_bfe_u32 v25, v1, 2, 2
v_lshl_add_u32 v26, v2, 3, v25
v_lshlrev_b32 v26, 8, v26
v_xor_b32 v27, 2, v25
v_lshl_add_u32 v26, v27, 6, v26
v_bfe_u32 v27, v1, 4, 1
v_bfe_u32 v28, v1, 1, 1
v_lshl_add_u32 v27, v27, 1, v28
v_and_b32 v28, 1, v1
v_lshl_add_u32 v27, v28, 2, v27
v_lshl_add_u32 v26, v27, 3, v26
v_add_u32 v145, 86016, v26
v_bfe_u32 v25, v1, 2, 2
v_lshl_add_u32 v26, v2, 3, v25
v_lshlrev_b32 v26, 8, v26
v_xor_b32 v27, 3, v25
v_lshl_add_u32 v26, v27, 6, v26
v_bfe_u32 v27, v1, 4, 1
v_bfe_u32 v28, v1, 1, 1
v_lshl_add_u32 v27, v27, 1, v28
v_and_b32 v28, 1, v1
v_lshl_add_u32 v27, v27, 1, v28
v_lshlrev_b32 v27, 2, v27
v_mov_b32 v29, 0x76534210
v_lshrrev_b32 v27, v27, v29
v_and_b32 v27, 7, v27
v_lshl_add_u32 v26, v27, 3, v26
v_add_u32 v146, 86016, v26
s_waitcnt vmcnt(5)
s_barrier
ds_read_b128 v[96:99], v139 offset:0
ds_read_b64_tr_b16 v[100:101], v143 offset:0
ds_read_b64_tr_b16 v[102:103], v143 offset:1024
ds_read_b64_tr_b16 v[104:105], v144 offset:0
ds_read_b64_tr_b16 v[106:107], v144 offset:1024
ds_read_b64_tr_b16 v[108:109], v145 offset:0
ds_read_b64_tr_b16 v[110:111], v145 offset:1024
ds_read_b64_tr_b16 v[112:113], v146 offset:0
ds_read_b64_tr_b16 v[114:115], v146 offset:1024
s_waitcnt lgkmcnt(0)
v_mfma_f32_32x32x16_bf16 v[32:47], v[100:103], v[96:99], 0
ds_read_b128 v[116:119], v140 offset:0
ds_read_b64_tr_b16 v[120:121], v143 offset:4096
ds_read_b64_tr_b16 v[122:123], v143 offset:5120
s_add_u32 m0, s60, 32768
s_movk_i32 s23, 256
buffer_load_dwordx4 v136, s[40:43], s23 offen lds
v_lshrrev_b32 v20, 3, v1
v_and_b32 v21, 7, v1
v_mov_b32 v23, 2146435072
s_and_b32 s64, s2, 3
s_lshl_b32 s64, s64, 3
v_mfma_f32_32x32x16_bf16 v[48:63], v[104:107], v[96:99], 0
ds_read_b64_tr_b16 v[124:125], v144 offset:4096
ds_read_b64_tr_b16 v[126:127], v144 offset:5120
ds_read_b64_tr_b16 v[128:129], v145 offset:4096
s_add_u32 m0, s60, 33792
s_movk_i32 s23, 256
buffer_load_dwordx4 v137, s[40:43], s23 offen lds
v_add_u32 v22, s64, v21
v_cmp_gt_u32 vcc, 30, v22
v_lshlrev_b32 v22, 7, v22
v_mul_u32_u24 v24, 245760, v20
v_add_u32 v22, v22, v24
v_mfma_f32_32x32x16_bf16 v[64:79], v[108:111], v[96:99], 0
ds_read_b64_tr_b16 v[130:131], v145 offset:5120
ds_read_b64_tr_b16 v[132:133], v146 offset:4096
ds_read_b64_tr_b16 v[134:135], v146 offset:5120
v_cndmask_b32 v22, v23, v22, vcc
s_lshr_b32 s64, s2, 2
s_add_u32 s64, s64, 128
s_mul_i32 s64, s64, 3840
s_cmp_eq_u32 s59, 0
s_cselect_b32 s65, 0, 2146435072
v_mfma_f32_32x32x16_bf16 v[80:95], v[112:115], v[96:99], 0
v_or_b32 v22, s65, v22
buffer_load_dword v251, v22, s[48:51], s64 offen
v_mul_u32_u24 v20, 13108, v1
v_lshrrev_b32 v20, 16, v20
s_waitcnt lgkmcnt(0)
v_mfma_f32_32x32x16_bf16 v[32:47], v[120:123], v[116:119], v[32:47]
ds_read_b128 v[96:99], v141 offset:0
ds_read_b64_tr_b16 v[100:101], v143 offset:8192
ds_read_b64_tr_b16 v[102:103], v143 offset:9216
s_add_u32 m0, s62, 32768
s_add_u32 s23, s3, 491520
buffer_load_dwordx4 v138, s[48:51], s23 offen lds
v_mul_u32_u24 v21, 5, v20
v_sub_u32 v21, v1, v21
s_and_b32 s64, s2, 127
s_mul_i32 s64, s64, 5
v_add_u32 v21, s64, v21
v_mfma_f32_32x32x16_bf16 v[48:63], v[124:127], v[116:119], v[48:63]
ds_read_b64_tr_b16 v[104:105], v144 offset:8192
ds_read_b64_tr_b16 v[106:107], v144 offset:9216
ds_read_b64_tr_b16 v[108:109], v145 offset:8192
s_add_u32 m0, s62, 33792
s_add_u32 s23, s3, 506880
buffer_load_dwordx4 v138, s[48:51], s23 offen lds
v_mul_u32_u24 v21, 1280, v21
v_lshl_add_u32 v21, v20, 7, v21
v_add_u32 v21, 256, v21
s_cmp_eq_u32 s59, 1
s_cselect_b32 s65, 40, 0
v_cmp_gt_u32 vcc, s65, v1
v_mfma_f32_32x32x16_bf16 v[64:79], v[128:131], v[116:119], v[64:79]
ds_read_b64_tr_b16 v[110:111], v145 offset:9216
ds_read_b64_tr_b16 v[112:113], v146 offset:8192
ds_read_b64_tr_b16 v[114:115], v146 offset:9216
v_cndmask_b32 v21, v23, v21, vcc
s_cmp_lt_u32 s2, 128
s_cselect_b32 s72, s10, s12
s_cselect_b32 s65, s11, s13
s_and_b32 s73, s65, 0xffff
s_mov_b32 s74, 819200
s_mov_b32 s75, 0x20000
v_mfma_f32_32x32x16_bf16 v[80:95], v[132:135], v[116:119], v[80:95]
buffer_load_dword v252, v21, s[72:75], 0 offen
v_mov_b32 v23, 2146435072
s_lshr_b32 s64, s59, 1
s_xor_b32 s65, s57, s64
s_waitcnt lgkmcnt(0)
v_mfma_f32_32x32x16_bf16 v[32:47], v[100:103], v[96:99], v[32:47]
ds_read_b128 v[116:119], v142 offset:0
ds_read_b64_tr_b16 v[120:121], v143 offset:12288
ds_read_b64_tr_b16 v[122:123], v143 offset:13312
s_add_u32 m0, s62, 34816
s_add_u32 s23, s3, 522240
buffer_load_dwordx4 v138, s[48:51], s23 offen lds
s_mul_i32 s65, s65, 1600
s_and_b32 s66, s59, 1
s_lshl_b32 s66, s66, 10
v_lshl_add_u32 v20, v1, 4, s66
v_cmp_gt_u32 vcc, 1600, v20
v_mfma_f32_32x32x16_bf16 v[48:63], v[104:107], v[96:99], v[48:63]
ds_read_b64_tr_b16 v[124:125], v144 offset:12288
ds_read_b64_tr_b16 v[126:127], v144 offset:13312
ds_read_b64_tr_b16 v[128:129], v145 offset:12288
v_add_u32 v20, s65, v20
v_cndmask_b32 v20, v23, v20, vcc
s_mov_b32 s72, s26
s_and_b32 s73, s27, 0xffff
s_mov_b32 s74, 25600
v_mfma_f32_32x32x16_bf16 v[64:79], v[108:111], v[96:99], v[64:79]
ds_read_b64_tr_b16 v[130:131], v145 offset:13312
ds_read_b64_tr_b16 v[132:133], v146 offset:12288
ds_read_b64_tr_b16 v[134:135], v146 offset:13312
s_mov_b32 s75, 0x20000
s_mul_i32 s64, s64, 2560
s_add_u32 s64, s64, s66
s_add_u32 m0, s64, 143360
s_nop 0
buffer_load_dwordx4 v20, s[72:75], 0 offen lds
s_mov_b32 s76, 0x3fb8aa3b
v_mfma_f32_32x32x16_bf16 v[80:95], v[112:115], v[96:99], v[80:95]
s_mov_b32 s77, 0x3fb8aa3b
s_mov_b32 s78, 0xbfb8aa3b
s_mov_b32 s79, 0xbfb8aa3b
s_waitcnt lgkmcnt(0)
s_waitcnt vmcnt(8)
s_barrier
v_mfma_f32_32x32x16_bf16 v[32:47], v[120:123], v[116:119], v[32:47]
ds_read_b128 v[96:99], v139 offset:16384
ds_read_b64_tr_b16 v[100:101], v143 offset:16384
ds_read_b64_tr_b16 v[102:103], v143 offset:17408
s_add_u32 m0, s60, 0
s_movk_i32 s23, 384
buffer_load_dwordx4 v136, s[40:43], s23 offen lds
v_bfe_u32 v204, v1, 2, 2
v_bfe_u32 v205, v1, 4, 1
v_bfe_u32 v206, v1, 1, 1
v_lshl_add_u32 v205, v205, 1, v206
v_and_b32 v206, 1, v1
v_mul_u32_u24 v207, 40, v204
v_mfma_f32_32x32x16_bf16 v[48:63], v[124:127], v[116:119], v[48:63]
ds_read_b64_tr_b16 v[104:105], v144 offset:16384
ds_read_b64_tr_b16 v[106:107], v144 offset:17408
ds_read_b64_tr_b16 v[108:109], v145 offset:16384
s_add_u32 m0, s60, 1024
s_movk_i32 s23, 384
buffer_load_dwordx4 v137, s[40:43], s23 offen lds
v_mul_u32_u24 v208, 800, v206
v_add_u32 v207, v207, v208
v_add_u32 v207, 143360, v207
v_mul_u32_u24 v208, 160, v206
v_add_u32 v3, v207, v208
v_sub_u32 v208, 1, v206
v_mfma_f32_32x32x16_bf16 v[64:79], v[128:131], v[116:119], v[64:79]
ds_read_b64_tr_b16 v[110:111], v145 offset:17408
ds_read_b64_tr_b16 v[112:113], v146 offset:16384
ds_read_b64_tr_b16 v[114:115], v146 offset:17408
v_mul_u32_u24 v208, 640, v208
v_add_u32 v4, v207, v208
v_add_u32 v5, 32, v3
v_add_u32 v6, 32, v4
v_lshl_add_u32 v3, v205, 3, v3
v_lshl_add_u32 v4, v205, 3, v4
v_mfma_f32_32x32x16_bf16 v[80:95], v[132:135], v[116:119], v[80:95]
v_mov_b32 v208, 144960
v_cmp_eq_u32 vcc, v206, v2
s_nop 1
v_cndmask_b32 v3, v208, v3, vcc
v_cndmask_b32 v4, v208, v4, vcc
v_cndmask_b32 v5, v208, v5, vcc
v_cndmask_b32 v6, v208, v6, vcc
s_waitcnt lgkmcnt(0)
v_mfma_f32_32x32x16_bf16 v[32:47], v[100:103], v[96:99], v[32:47]
ds_read_b128 v[116:119], v140 offset:16384
ds_read_b64_tr_b16 v[120:121], v143 offset:20480
ds_read_b64_tr_b16 v[122:123], v143 offset:21504
s_add_u32 m0, s62, 0
s_add_u32 s23, s3, 737280
buffer_load_dwordx4 v138, s[48:51], s23 offen lds
v_cmp_eq_u32 vcc, 0, v205
s_nop 1
v_cndmask_b32 v5, v208, v5, vcc
v_cndmask_b32 v6, v208, v6, vcc
v_bfe_u32 v204, v1, 2, 1
v_lshlrev_b32 v204, 4, v204
v_and_b32 v205, 1, v1
v_mfma_f32_32x32x16_bf16 v[48:63], v[104:107], v[96:99], v[48:63]
ds_read_b64_tr_b16 v[124:125], v144 offset:20480
ds_read_b64_tr_b16 v[126:127], v144 offset:21504
ds_read_b64_tr_b16 v[128:129], v145 offset:20480
s_add_u32 m0, s62, 1024
s_add_u32 s23, s3, 752640
buffer_load_dwordx4 v138, s[48:51], s23 offen lds
v_lshl_add_u32 v204, v205, 3, v204
v_bfe_u32 v205, v1, 3, 2
v_lshl_add_u32 v204, v205, 1, v204
v_bfe_u32 v205, v1, 1, 1
v_add_u32 v204, v204, v205
s_lshl_b32 s38, s59, 5
v_mfma_f32_32x32x16_bf16 v[64:79], v[108:111], v[96:99], v[64:79]
ds_read_b64_tr_b16 v[130:131], v145 offset:21504
ds_read_b64_tr_b16 v[132:133], v146 offset:20480
ds_read_b64_tr_b16 v[134:135], v146 offset:21504
v_add_u32 v204, s38, v204
v_mul_u32_u24 v205, 320, v204
v_bfe_u32 v206, v204, 3, 2
v_lshl_add_u32 v205, v206, 4, v205
v_add_u32 v205, 102400, v205
v_mul_u32_u24 v206, 80, v2
v_mfma_f32_32x32x16_bf16 v[80:95], v[112:115], v[96:99], v[80:95]
v_add_u32 v7, v205, v206
v_mul_u32_u24 v206, 56, v2
v_add_u32 v8, v205, v206
v_lshl_add_u32 v9, v2, 4, v205
v_mul_u32_u24 v206, 48, v2
v_add_u32 v10, v205, v206
s_waitcnt lgkmcnt(0)
v_mfma_f32_32x32x16_bf16 v[32:47], v[120:123], v[116:119], v[32:47]
ds_read_b128 v[96:99], v141 offset:16384
ds_read_b64_tr_b16 v[100:101], v143 offset:24576
ds_read_b64_tr_b16 v[102:103], v143 offset:25600
s_add_u32 m0, s62, 2048
s_add_u32 s23, s3, 768000
buffer_load_dwordx4 v138, s[48:51], s23 offen lds
v_mul_u32_u24 v204, 240, v204
v_mul_u32_u24 v206, 40, v2
v_add_u32 v204, v204, v206
v_add_u32 v16, 15520, v204
v_bfe_u32 v204, v1, 2, 2
v_lshl_add_u32 v204, v2, 3, v204
v_mfma_f32_32x32x16_bf16 v[48:63], v[124:127], v[116:119], v[48:63]
ds_read_b64_tr_b16 v[104:105], v144 offset:24576
ds_read_b64_tr_b16 v[106:107], v144 offset:25600
ds_read_b64_tr_b16 v[108:109], v145 offset:24576
v_mul_u32_u24 v204, 320, v204
v_lshl_add_u32 v204, v2, 4, v204
v_bfe_u32 v205, v1, 4, 1
v_and_b32 v206, 3, v1
v_lshl_add_u32 v205, v205, 2, v206
v_lshl_add_u32 v204, v205, 3, v204
v_mfma_f32_32x32x16_bf16 v[64:79], v[128:131], v[116:119], v[64:79]
ds_read_b64_tr_b16 v[110:111], v145 offset:25600
ds_read_b64_tr_b16 v[112:113], v146 offset:24576
ds_read_b64_tr_b16 v[114:115], v146 offset:25600
v_add_u32 v204, 102400, v204
s_lshr_b32 s38, s59, 1
s_and_b32 s39, s59, 1
s_mul_i32 s66, s38, 80
s_lshl_b32 s67, s39, 6
s_add_u32 s66, s66, s67
v_mfma_f32_32x32x16_bf16 v[80:95], v[132:135], v[116:119], v[80:95]
v_add_u32 v11, s66, v204
s_mul_i32 s66, s38, 48
s_add_u32 s66, s66, 160
v_add_u32 v12, s66, v204
v_and_b32 v204, 31, v1
s_mul_i32 s66, s38, 21
s_waitcnt lgkmcnt(0)
v_mfma_f32_32x32x16_bf16 v[32:47], v[100:103], v[96:99], v[32:47]
ds_read_b128 v[116:119], v142 offset:16384
ds_read_b64_tr_b16 v[120:121], v143 offset:28672
ds_read_b64_tr_b16 v[122:123], v143 offset:29696
v_add_u32 v205, s66, v204
v_mul_u32_u24 v205, 80, v205
v_lshl_add_u32 v205, v2, 3, v205
s_lshl_b32 s66, s39, 6
v_add_u32 v205, s66, v205
v_mov_b32 v206, 2146435072
v_mfma_f32_32x32x16_bf16 v[48:63], v[104:107], v[96:99], v[48:63]
ds_read_b64_tr_b16 v[124:125], v144 offset:28672
ds_read_b64_tr_b16 v[126:127], v144 offset:29696
ds_read_b64_tr_b16 v[128:129], v145 offset:28672
v_cmp_gt_u32 vcc, 21, v204
s_nop 1
v_cndmask_b32 v13, v206, v205, vcc
v_and_b32 v204, 31, v1
v_bfe_u32 v205, v204, 2, 1
v_lshrrev_b32 v206, 3, v204
v_and_b32 v207, 3, v204
v_mfma_f32_32x32x16_bf16 v[64:79], v[108:111], v[96:99], v[64:79]
ds_read_b64_tr_b16 v[130:131], v145 offset:29696
ds_read_b64_tr_b16 v[132:133], v146 offset:28672
ds_read_b64_tr_b16 v[134:135], v146 offset:29696
v_lshl_add_u32 v206, v206, 2, v207
v_mul_u32_u24 v207, 21, v205
v_add_u32 v207, v207, v206
v_mul_u32_u24 v207, 80, v207
v_add_u32 v207, 150080, v207
v_mov_b32 v208, 144960
v_mfma_f32_32x32x16_bf16 v[80:95], v[112:115], v[96:99], v[80:95]
v_cmp_eq_u32 vcc, v205, v2
s_nop 1
v_cndmask_b32 v14, v208, v207, vcc
v_add_u32 v207, 1280, v207
v_cndmask_b32 v15, v208, v207, vcc
v_cmp_ge_u32 vcc, 4, v206
s_nop 1
v_cndmask_b32 v15, v208, v15, vcc
s_waitcnt lgkmcnt(0)
s_waitcnt vmcnt(5)
s_barrier
v_mfma_f32_32x32x16_bf16 v[32:47], v[120:123], v[116:119], v[32:47]
ds_read_b128 v[96:99], v139 offset:32768
ds_read_b64_tr_b16 v[100:101], v143 offset:32768
ds_read_b64_tr_b16 v[102:103], v143 offset:33792
s_add_u32 m0, s60, 16384
s_movk_i32 s23, 512
buffer_load_dwordx4 v136, s[40:43], s23 offen lds
v_mfma_f32_32x32x16_bf16 v[48:63], v[124:127], v[116:119], v[48:63]
ds_read_b64_tr_b16 v[104:105], v144 offset:32768
ds_read_b64_tr_b16 v[106:107], v144 offset:33792
ds_read_b64_tr_b16 v[108:109], v145 offset:32768
s_add_u32 m0, s60, 17408
s_movk_i32 s23, 512
buffer_load_dwordx4 v137, s[40:43], s23 offen lds
v_mfma_f32_32x32x16_bf16 v[64:79], v[128:131], v[116:119], v[64:79]
ds_read_b64_tr_b16 v[110:111], v145 offset:33792
ds_read_b64_tr_b16 v[112:113], v146 offset:32768
ds_read_b64_tr_b16 v[114:115], v146 offset:33792
v_mfma_f32_32x32x16_bf16 v[80:95], v[132:135], v[116:119], v[80:95]
s_waitcnt lgkmcnt(0)
v_mfma_f32_32x32x16_bf16 v[32:47], v[100:103], v[96:99], v[32:47]
ds_read_b128 v[116:119], v140 offset:32768
ds_read_b64_tr_b16 v[120:121], v143 offset:36864
ds_read_b64_tr_b16 v[122:123], v143 offset:37888
s_add_u32 m0, s62, 16384
s_add_u32 s23, s3, 983040
buffer_load_dwordx4 v138, s[48:51], s23 offen lds
v_mov_b32 v23, 2146435072
v_mul_u32_u24 v21, 1639, v0
v_lshrrev_b32 v21, 16, v21
v_mul_u32_u24 v20, 40, v21
v_sub_u32 v20, v0, v20
v_mfma_f32_32x32x16_bf16 v[48:63], v[104:107], v[96:99], v[48:63]
ds_read_b64_tr_b16 v[124:125], v144 offset:36864
ds_read_b64_tr_b16 v[126:127], v144 offset:37888
ds_read_b64_tr_b16 v[128:129], v145 offset:36864
s_add_u32 m0, s62, 17408
s_add_u32 s23, s3, 998400
buffer_load_dwordx4 v138, s[48:51], s23 offen lds
v_min_u32 v21, 9, v21
s_mul_i32 s64, s56, 40
v_add_u32 v22, s64, v20
v_min_u32 v22, 639, v22
v_mul_u32_u24 v22, 1280, v22
v_mfma_f32_32x32x16_bf16 v[64:79], v[108:111], v[96:99], v[64:79]
ds_read_b64_tr_b16 v[130:131], v145 offset:37888
ds_read_b64_tr_b16 v[132:133], v146 offset:36864
ds_read_b64_tr_b16 v[134:135], v146 offset:37888
s_mul_i32 s64, s57, 80
v_lshl_add_u32 v22, v21, 3, v22
v_add_u32 v22, s64, v22
global_load_dwordx2 v[182:183], v22, s[14:15]
global_load_dwordx2 v[184:185], v22, s[16:17]
v_mfma_f32_32x32x16_bf16 v[80:95], v[112:115], v[96:99], v[80:95]
s_mul_i32 s64, s57, 10
v_add_u32 v26, s64, v21
v_lshrrev_b32 v27, 2, v26
s_waitcnt lgkmcnt(0)
v_mfma_f32_32x32x16_bf16 v[32:47], v[120:123], v[116:119], v[32:47]
ds_read_b128 v[96:99], v141 offset:32768
ds_read_b64_tr_b16 v[100:101], v143 offset:40960
ds_read_b64_tr_b16 v[102:103], v143 offset:41984
s_add_u32 m0, s62, 18432
s_add_u32 s23, s3, 1013760
buffer_load_dwordx4 v138, s[48:51], s23 offen lds
v_and_b32 v26, 3, v26
s_lshr_b32 s64, s56, 1
s_mul_i32 s64, s64, 60
v_add_u32 v27, s64, v27
v_mul_u32_u24 v27, 5, v27
v_mfma_f32_32x32x16_bf16 v[48:63], v[124:127], v[116:119], v[48:63]
ds_read_b64_tr_b16 v[104:105], v144 offset:40960
ds_read_b64_tr_b16 v[106:107], v144 offset:41984
ds_read_b64_tr_b16 v[108:109], v145 offset:40960
s_and_b32 s64, s56, 1
s_mul_i32 s64, s64, 40
v_add_u32 v28, s64, v20
v_lshrrev_b32 v29, 4, v28
v_add_u32 v27, v27, v29
v_mfma_f32_32x32x16_bf16 v[64:79], v[128:131], v[116:119], v[64:79]
ds_read_b64_tr_b16 v[110:111], v145 offset:41984
ds_read_b64_tr_b16 v[112:113], v146 offset:40960
ds_read_b64_tr_b16 v[114:115], v146 offset:41984
v_and_b32 v28, 15, v28
v_lshlrev_b32 v27, 6, v27
v_lshl_add_u32 v27, v26, 4, v27
v_add_u32 v27, v27, v28
v_lshlrev_b32 v27, 4, v27
v_mfma_f32_32x32x16_bf16 v[80:95], v[132:135], v[116:119], v[80:95]
v_add_u32 v181, 8388608, v27
v_cmp_gt_u32 vcc, 400, v0
s_nop 1
v_cndmask_b32 v181, v23, v181, vcc
s_waitcnt lgkmcnt(0)
v_mfma_f32_32x32x16_bf16 v[32:47], v[100:103], v[96:99], v[32:47]
ds_read_b128 v[116:119], v142 offset:32768
ds_read_b64_tr_b16 v[120:121], v143 offset:45056
ds_read_b64_tr_b16 v[122:123], v143 offset:46080
v_lshlrev_b32 v186, 5, v21
v_add_u32 v186, 148480, v186
v_subrev_u32 v24, 256, v0
v_mul_u32_u24 v20, 13108, v24
v_lshrrev_b32 v20, 16, v20
v_mfma_f32_32x32x16_bf16 v[48:63], v[104:107], v[96:99], v[48:63]
ds_read_b64_tr_b16 v[124:125], v144 offset:45056
ds_read_b64_tr_b16 v[126:127], v144 offset:46080
ds_read_b64_tr_b16 v[128:129], v145 offset:45056
v_mul_u32_u24 v21, 5, v20
v_sub_u32 v21, v24, v21
s_mul_i32 s64, s57, 40
v_add_u32 v22, s64, v20
v_min_u32 v22, 639, v22
v_mfma_f32_32x32x16_bf16 v[64:79], v[108:111], v[96:99], v[64:79]
ds_read_b64_tr_b16 v[130:131], v145 offset:46080
ds_read_b64_tr_b16 v[132:133], v146 offset:45056
ds_read_b64_tr_b16 v[134:135], v146 offset:46080
v_mul_u32_u24 v22, 1280, v22
s_mul_i32 s64, s56, 80
v_lshl_add_u32 v22, v21, 4, v22
v_add_u32 v22, s64, v22
global_load_dwordx4 v[188:191], v22, s[28:29]
v_mfma_f32_32x32x16_bf16 v[80:95], v[112:115], v[96:99], v[80:95]
v_lshlrev_b32 v192, 4, v24
v_add_u32 v192, 153952, v192
v_min_u32 v192, 157152, v192
s_waitcnt lgkmcnt(0)
s_waitcnt vmcnt(8)
s_barrier
v_mfma_f32_32x32x16_bf16 v[32:47], v[120:123], v[116:119], v[32:47]
ds_read_b128 v[96:99], v139 offset:0
ds_read_b64_tr_b16 v[100:101], v143 offset:0
ds_read_b64_tr_b16 v[102:103], v143 offset:1024
s_add_u32 m0, s60, 32768
s_movk_i32 s23, 640
buffer_load_dwordx4 v136, s[40:43], s23 offen lds
v_mfma_f32_32x32x16_bf16 v[48:63], v[124:127], v[116:119], v[48:63]
ds_read_b64_tr_b16 v[104:105], v144 offset:0
ds_read_b64_tr_b16 v[106:107], v144 offset:1024
ds_read_b64_tr_b16 v[108:109], v145 offset:0
s_add_u32 m0, s60, 33792
s_movk_i32 s23, 640
buffer_load_dwordx4 v137, s[40:43], s23 offen lds
v_mfma_f32_32x32x16_bf16 v[64:79], v[128:131], v[116:119], v[64:79]
ds_read_b64_tr_b16 v[110:111], v145 offset:1024
ds_read_b64_tr_b16 v[112:113], v146 offset:0
ds_read_b64_tr_b16 v[114:115], v146 offset:1024
v_mfma_f32_32x32x16_bf16 v[80:95], v[132:135], v[116:119], v[80:95]
s_waitcnt lgkmcnt(0)
v_mfma_f32_32x32x16_bf16 v[32:47], v[100:103], v[96:99], v[32:47]
ds_read_b128 v[116:119], v140 offset:0
ds_read_b64_tr_b16 v[120:121], v143 offset:4096
ds_read_b64_tr_b16 v[122:123], v143 offset:5120
s_add_u32 m0, s62, 32768
s_add_u32 s23, s3, 1228800
buffer_load_dwordx4 v138, s[48:51], s23 offen lds
v_mfma_f32_32x32x16_bf16 v[48:63], v[104:107], v[96:99], v[48:63]
ds_read_b64_tr_b16 v[124:125], v144 offset:4096
ds_read_b64_tr_b16 v[126:127], v144 offset:5120
ds_read_b64_tr_b16 v[128:129], v145 offset:4096
s_add_u32 m0, s62, 33792
s_add_u32 s23, s3, 1244160
buffer_load_dwordx4 v138, s[48:51], s23 offen lds
v_mfma_f32_32x32x16_bf16 v[64:79], v[108:111], v[96:99], v[64:79]
ds_read_b64_tr_b16 v[130:131], v145 offset:5120
ds_read_b64_tr_b16 v[132:133], v146 offset:4096
ds_read_b64_tr_b16 v[134:135], v146 offset:5120
v_mfma_f32_32x32x16_bf16 v[80:95], v[112:115], v[96:99], v[80:95]
s_waitcnt lgkmcnt(0)
v_mfma_f32_32x32x16_bf16 v[32:47], v[120:123], v[116:119], v[32:47]
ds_read_b128 v[96:99], v141 offset:0
ds_read_b64_tr_b16 v[100:101], v143 offset:8192
ds_read_b64_tr_b16 v[102:103], v143 offset:9216
s_add_u32 m0, s62, 34816
s_add_u32 s23, s3, 1259520
buffer_load_dwordx4 v138, s[48:51], s23 offen lds
v_mfma_f32_32x32x16_bf16 v[48:63], v[124:127], v[116:119], v[48:63]
ds_read_b64_tr_b16 v[104:105], v144 offset:8192
ds_read_b64_tr_b16 v[106:107], v144 offset:9216
ds_read_b64_tr_b16 v[108:109], v145 offset:8192
v_mfma_f32_32x32x16_bf16 v[64:79], v[128:131], v[116:119], v[64:79]
ds_read_b64_tr_b16 v[110:111], v145 offset:9216
ds_read_b64_tr_b16 v[112:113], v146 offset:8192
ds_read_b64_tr_b16 v[114:115], v146 offset:9216
v_mfma_f32_32x32x16_bf16 v[80:95], v[132:135], v[116:119], v[80:95]
s_waitcnt lgkmcnt(0)
v_mfma_f32_32x32x16_bf16 v[32:47], v[100:103], v[96:99], v[32:47]
ds_read_b128 v[116:119], v142 offset:0
ds_read_b64_tr_b16 v[120:121], v143 offset:12288
ds_read_b64_tr_b16 v[122:123], v143 offset:13312
v_mfma_f32_32x32x16_bf16 v[48:63], v[104:107], v[96:99], v[48:63]
ds_read_b64_tr_b16 v[124:125], v144 offset:12288
ds_read_b64_tr_b16 v[126:127], v144 offset:13312
ds_read_b64_tr_b16 v[128:129], v145 offset:12288
v_mfma_f32_32x32x16_bf16 v[64:79], v[108:111], v[96:99], v[64:79]
ds_read_b64_tr_b16 v[130:131], v145 offset:13312
ds_read_b64_tr_b16 v[132:133], v146 offset:12288
ds_read_b64_tr_b16 v[134:135], v146 offset:13312
v_mfma_f32_32x32x16_bf16 v[80:95], v[112:115], v[96:99], v[80:95]
s_waitcnt lgkmcnt(0)
s_waitcnt vmcnt(5)
s_barrier
v_mfma_f32_32x32x16_bf16 v[32:47], v[120:123], v[116:119], v[32:47]
ds_read_b128 v[96:99], v139 offset:16384
ds_read_b64_tr_b16 v[100:101], v143 offset:16384
ds_read_b64_tr_b16 v[102:103], v143 offset:17408
s_add_u32 m0, s60, 0
s_movk_i32 s23, 768
buffer_load_dwordx4 v136, s[40:43], s23 offen lds
v_mov_b32 v200, 0
v_mfma_f32_32x32x16_bf16 v[48:63], v[124:127], v[116:119], v[48:63]
ds_read_b64_tr_b16 v[104:105], v144 offset:16384
ds_read_b64_tr_b16 v[106:107], v144 offset:17408
ds_read_b64_tr_b16 v[108:109], v145 offset:16384
s_add_u32 m0, s60, 1024
s_movk_i32 s23, 768
buffer_load_dwordx4 v137, s[40:43], s23 offen lds
global_load_dword v196, v200, s[34:35] sc1
v_mfma_f32_32x32x16_bf16 v[64:79], v[128:131], v[116:119], v[64:79]
ds_read_b64_tr_b16 v[110:111], v145 offset:17408
ds_read_b64_tr_b16 v[112:113], v146 offset:16384
ds_read_b64_tr_b16 v[114:115], v146 offset:17408
v_mfma_f32_32x32x16_bf16 v[80:95], v[132:135], v[116:119], v[80:95]
s_waitcnt lgkmcnt(0)
v_mfma_f32_32x32x16_bf16 v[32:47], v[100:103], v[96:99], v[32:47]
ds_read_b128 v[116:119], v140 offset:16384
ds_read_b64_tr_b16 v[120:121], v143 offset:20480
ds_read_b64_tr_b16 v[122:123], v143 offset:21504
s_add_u32 m0, s62, 0
s_add_u32 s23, s3, 1474560
buffer_load_dwordx4 v138, s[48:51], s23 offen lds
v_mov_b32 v202, 0
v_mfma_f32_32x32x16_bf16 v[48:63], v[104:107], v[96:99], v[48:63]
ds_read_b64_tr_b16 v[124:125], v144 offset:20480
ds_read_b64_tr_b16 v[126:127], v144 offset:21504
ds_read_b64_tr_b16 v[128:129], v145 offset:20480
s_add_u32 m0, s62, 1024
s_add_u32 s23, s3, 1489920
buffer_load_dwordx4 v138, s[48:51], s23 offen lds
v_mov_b32 v203, 0
v_mfma_f32_32x32x16_bf16 v[64:79], v[108:111], v[96:99], v[64:79]
ds_read_b64_tr_b16 v[130:131], v145 offset:21504
ds_read_b64_tr_b16 v[132:133], v146 offset:20480
ds_read_b64_tr_b16 v[134:135], v146 offset:21504
v_mfma_f32_32x32x16_bf16 v[80:95], v[112:115], v[96:99], v[80:95]
s_waitcnt lgkmcnt(0)
v_mfma_f32_32x32x16_bf16 v[32:47], v[120:123], v[116:119], v[32:47]
ds_read_b128 v[96:99], v141 offset:16384
ds_read_b64_tr_b16 v[100:101], v143 offset:24576
ds_read_b64_tr_b16 v[102:103], v143 offset:25600
s_add_u32 m0, s62, 2048
s_add_u32 s23, s3, 1505280
buffer_load_dwordx4 v138, s[48:51], s23 offen lds
ds_write_b128 v192, v[188:191]
v_mfma_f32_32x32x16_bf16 v[48:63], v[124:127], v[116:119], v[48:63]
ds_read_b64_tr_b16 v[104:105], v144 offset:24576
ds_read_b64_tr_b16 v[106:107], v144 offset:25600
ds_read_b64_tr_b16 v[108:109], v145 offset:24576
v_lshlrev_b32 v200, 3, v1
v_mfma_f32_32x32x16_bf16 v[64:79], v[128:131], v[116:119], v[64:79]
ds_read_b64_tr_b16 v[110:111], v145 offset:25600
ds_read_b64_tr_b16 v[112:113], v146 offset:24576
ds_read_b64_tr_b16 v[114:115], v146 offset:25600
v_mfma_f32_32x32x16_bf16 v[80:95], v[132:135], v[116:119], v[80:95]
s_waitcnt lgkmcnt(0)
v_mfma_f32_32x32x16_bf16 v[32:47], v[100:103], v[96:99], v[32:47]
ds_read_b128 v[116:119], v142 offset:16384
ds_read_b64_tr_b16 v[120:121], v143 offset:28672
ds_read_b64_tr_b16 v[122:123], v143 offset:29696
v_add_u32 v200, 144960, v200
v_mfma_f32_32x32x16_bf16 v[48:63], v[104:107], v[96:99], v[48:63]
ds_read_b64_tr_b16 v[124:125], v144 offset:28672
ds_read_b64_tr_b16 v[126:127], v144 offset:29696
ds_read_b64_tr_b16 v[128:129], v145 offset:28672
ds_write_b64 v200, v[202:203]
v_mfma_f32_32x32x16_bf16 v[64:79], v[108:111], v[96:99], v[64:79]
ds_read_b64_tr_b16 v[130:131], v145 offset:29696
ds_read_b64_tr_b16 v[132:133], v146 offset:28672
ds_read_b64_tr_b16 v[134:135], v146 offset:29696
v_mfma_f32_32x32x16_bf16 v[80:95], v[112:115], v[96:99], v[80:95]
s_waitcnt lgkmcnt(0)
s_waitcnt vmcnt(5)
s_barrier
v_mfma_f32_32x32x16_bf16 v[32:47], v[120:123], v[116:119], v[32:47]
ds_read_b128 v[96:99], v139 offset:32768
ds_read_b64_tr_b16 v[100:101], v143 offset:32768
ds_read_b64_tr_b16 v[102:103], v143 offset:33792
s_add_u32 m0, s60, 16384
s_movk_i32 s23, 896
buffer_load_dwordx4 v136, s[40:43], s23 offen lds
ds_write_b64 v200, v[202:203] offset:2560
v_mfma_f32_32x32x16_bf16 v[48:63], v[124:127], v[116:119], v[48:63]
ds_read_b64_tr_b16 v[104:105], v144 offset:32768
ds_read_b64_tr_b16 v[106:107], v144 offset:33792
ds_read_b64_tr_b16 v[108:109], v145 offset:32768
s_add_u32 m0, s60, 17408
s_movk_i32 s23, 896
buffer_load_dwordx4 v137, s[40:43], s23 offen lds
v_and_b32 v201, 15, v1
v_mfma_f32_32x32x16_bf16 v[64:79], v[128:131], v[116:119], v[64:79]
ds_read_b64_tr_b16 v[110:111], v145 offset:33792
ds_read_b64_tr_b16 v[112:113], v146 offset:32768
ds_read_b64_tr_b16 v[114:115], v146 offset:33792
v_mfma_f32_32x32x16_bf16 v[80:95], v[132:135], v[116:119], v[80:95]
s_waitcnt lgkmcnt(0)
v_mfma_f32_32x32x16_bf16 v[32:47], v[100:103], v[96:99], v[32:47]
ds_read_b128 v[116:119], v140 offset:32768
ds_read_b64_tr_b16 v[120:121], v143 offset:36864
ds_read_b64_tr_b16 v[122:123], v143 offset:37888
s_add_u32 m0, s62, 16384
s_add_u32 s23, s3, 1720320
buffer_load_dwordx4 v138, s[48:51], s23 offen lds
v_lshlrev_b32 v201, 3, v201
v_mfma_f32_32x32x16_bf16 v[48:63], v[104:107], v[96:99], v[48:63]
ds_read_b64_tr_b16 v[124:125], v144 offset:36864
ds_read_b64_tr_b16 v[126:127], v144 offset:37888
ds_read_b64_tr_b16 v[128:129], v145 offset:36864
s_add_u32 m0, s62, 17408
s_add_u32 s23, s3, 1735680
buffer_load_dwordx4 v138, s[48:51], s23 offen lds
v_add_u32 v201, 153504, v201
v_mfma_f32_32x32x16_bf16 v[64:79], v[108:111], v[96:99], v[64:79]
ds_read_b64_tr_b16 v[130:131], v145 offset:37888
ds_read_b64_tr_b16 v[132:133], v146 offset:36864
ds_read_b64_tr_b16 v[134:135], v146 offset:37888
v_mfma_f32_32x32x16_bf16 v[80:95], v[112:115], v[96:99], v[80:95]
s_waitcnt lgkmcnt(0)
v_mfma_f32_32x32x16_bf16 v[32:47], v[120:123], v[116:119], v[32:47]
ds_read_b128 v[96:99], v141 offset:32768
ds_read_b64_tr_b16 v[100:101], v143 offset:40960
ds_read_b64_tr_b16 v[102:103], v143 offset:41984
s_add_u32 m0, s62, 18432
s_add_u32 s23, s3, 1751040
buffer_load_dwordx4 v138, s[48:51], s23 offen lds
ds_write_b64 v201, v[202:203]
v_mfma_f32_32x32x16_bf16 v[48:63], v[124:127], v[116:119], v[48:63]
ds_read_b64_tr_b16 v[104:105], v144 offset:40960
ds_read_b64_tr_b16 v[106:107], v144 offset:41984
ds_read_b64_tr_b16 v[108:109], v145 offset:40960
v_mfma_f32_32x32x16_bf16 v[64:79], v[128:131], v[116:119], v[64:79]
ds_read_b64_tr_b16 v[110:111], v145 offset:41984
ds_read_b64_tr_b16 v[112:113], v146 offset:40960
ds_read_b64_tr_b16 v[114:115], v146 offset:41984
v_mfma_f32_32x32x16_bf16 v[80:95], v[132:135], v[116:119], v[80:95]
s_waitcnt lgkmcnt(0)
v_mfma_f32_32x32x16_bf16 v[32:47], v[100:103], v[96:99], v[32:47]
ds_read_b128 v[116:119], v142 offset:32768
ds_read_b64_tr_b16 v[120:121], v143 offset:45056
ds_read_b64_tr_b16 v[122:123], v143 offset:46080
v_mfma_f32_32x32x16_bf16 v[48:63], v[104:107], v[96:99], v[48:63]
ds_read_b64_tr_b16 v[124:125], v144 offset:45056
ds_read_b64_tr_b16 v[126:127], v144 offset:46080
ds_read_b64_tr_b16 v[128:129], v145 offset:45056
v_mfma_f32_32x32x16_bf16 v[64:79], v[108:111], v[96:99], v[64:79]
ds_read_b64_tr_b16 v[130:131], v145 offset:46080
ds_read_b64_tr_b16 v[132:133], v146 offset:45056
ds_read_b64_tr_b16 v[134:135], v146 offset:46080
v_mfma_f32_32x32x16_bf16 v[80:95], v[112:115], v[96:99], v[80:95]
s_waitcnt lgkmcnt(0)
s_waitcnt vmcnt(5)
s_barrier
v_mfma_f32_32x32x16_bf16 v[32:47], v[120:123], v[116:119], v[32:47]
ds_read_b128 v[96:99], v139 offset:0
ds_read_b64_tr_b16 v[100:101], v143 offset:0
ds_read_b64_tr_b16 v[102:103], v143 offset:1024
s_add_u32 m0, s60, 32768
s_movk_i32 s23, 1024
buffer_load_dwordx4 v136, s[40:43], s23 offen lds
ds_read_b128 v[200:203], v186
ds_read_b128 v[204:207], v186 offset:16
v_lshrrev_b32 v216, 4, v1
s_lshl_b32 s38, s59, 2
v_add_u32 v216, s38, v216
v_min_u32 v216, 14, v216
v_mul_u32_u24 v217, 13108, v216
v_mfma_f32_32x32x16_bf16 v[48:63], v[124:127], v[116:119], v[48:63]
ds_read_b64_tr_b16 v[104:105], v144 offset:0
ds_read_b64_tr_b16 v[106:107], v144 offset:1024
ds_read_b64_tr_b16 v[108:109], v145 offset:0
s_add_u32 m0, s60, 33792
s_movk_i32 s23, 1024
buffer_load_dwordx4 v137, s[40:43], s23 offen lds
v_lshrrev_b32 v217, 16, v217
v_mul_u32_u24 v218, 5, v217
v_sub_u32 v218, v216, v218
v_bfe_u32 v219, v1, 2, 2
v_lshl_add_u32 v219, v218, 3, v219
v_mul_u32_u24 v219, 80, v219
v_and_b32 v220, 3, v1
v_mfma_f32_32x32x16_bf16 v[64:79], v[128:131], v[116:119], v[64:79]
ds_read_b64_tr_b16 v[110:111], v145 offset:1024
ds_read_b64_tr_b16 v[112:113], v146 offset:0
ds_read_b64_tr_b16 v[114:115], v146 offset:1024
v_lshl_add_u32 v220, v217, 2, v220
v_lshl_add_u32 v219, v220, 3, v219
v_add_u32 v219, 153952, v219
ds_read_b64_tr_b16 v[188:189], v219
ds_read_b64_tr_b16 v[190:191], v219 offset:320
v_and_b32 v20, 15, v1
v_lshl_add_u32 v20, v217, 4, v20
v_mfma_f32_32x32x16_bf16 v[80:95], v[132:135], v[116:119], v[80:95]
v_mov_b32 v21, v218
s_mul_i32 s38, s57, 5
s_add_u32 s38, s38, 160
v_add_u32 v26, s38, v21
s_waitcnt lgkmcnt(0)
v_mfma_f32_32x32x16_bf16 v[32:47], v[100:103], v[96:99], v[32:47]
ds_read_b128 v[116:119], v140 offset:0
ds_read_b64_tr_b16 v[120:121], v143 offset:4096
ds_read_b64_tr_b16 v[122:123], v143 offset:5120
s_add_u32 m0, s62, 32768
s_add_u32 s23, s3, 1966080
buffer_load_dwordx4 v138, s[48:51], s23 offen lds
v_lshrrev_b32 v27, 2, v26
v_and_b32 v26, 3, v26
s_lshr_b32 s38, s56, 1
s_mul_i32 s38, s38, 60
v_add_u32 v27, s38, v27
v_mul_u32_u24 v27, 5, v27
s_and_b32 s38, s56, 1
v_mfma_f32_32x32x16_bf16 v[48:63], v[104:107], v[96:99], v[48:63]
ds_read_b64_tr_b16 v[124:125], v144 offset:4096
ds_read_b64_tr_b16 v[126:127], v144 offset:5120
ds_read_b64_tr_b16 v[128:129], v145 offset:4096
s_add_u32 m0, s62, 33792
s_add_u32 s23, s3, 1981440
buffer_load_dwordx4 v138, s[48:51], s23 offen lds
s_mul_i32 s38, s38, 40
v_add_u32 v28, s38, v20
v_lshrrev_b32 v29, 4, v28
v_add_u32 v27, v27, v29
v_and_b32 v28, 15, v28
v_lshlrev_b32 v27, 6, v27
v_lshl_add_u32 v27, v26, 4, v27
v_mfma_f32_32x32x16_bf16 v[64:79], v[108:111], v[96:99], v[64:79]
ds_read_b64_tr_b16 v[130:131], v145 offset:5120
ds_read_b64_tr_b16 v[132:133], v146 offset:4096
ds_read_b64_tr_b16 v[134:135], v146 offset:5120
v_add_u32 v27, v27, v28
v_lshlrev_b32 v27, 4, v27
v_add_u32 v187, 8388608, v27
v_mov_b32 v23, 2146435072
v_cmp_gt_u32 vcc, 40, v20
s_nop 1
v_cndmask_b32 v187, v23, v187, vcc
v_lshrrev_b32 v20, 4, v1
v_mfma_f32_32x32x16_bf16 v[80:95], v[112:115], v[96:99], v[80:95]
s_lshl_b32 s38, s59, 2
v_add_u32 v20, s38, v20
v_cmp_gt_u32 vcc, 15, v20
s_nop 1
v_cndmask_b32 v187, v23, v187, vcc
s_waitcnt lgkmcnt(0)
v_mfma_f32_32x32x16_bf16 v[32:47], v[120:123], v[116:119], v[32:47]
ds_read_b128 v[96:99], v141 offset:0
ds_read_b64_tr_b16 v[100:101], v143 offset:8192
ds_read_b64_tr_b16 v[102:103], v143 offset:9216
s_add_u32 m0, s62, 34816
s_add_u32 s23, s3, 1996800
buffer_load_dwordx4 v138, s[48:51], s23 offen lds
v_readfirstlane_b32 s63, v196
v_mfma_f32_32x32x16_bf16 v[48:63], v[124:127], v[116:119], v[48:63]
ds_read_b64_tr_b16 v[104:105], v144 offset:8192
ds_read_b64_tr_b16 v[106:107], v144 offset:9216
ds_read_b64_tr_b16 v[108:109], v145 offset:8192
v_mfma_f32_32x32x16_bf16 v[64:79], v[128:131], v[116:119], v[64:79]
ds_read_b64_tr_b16 v[110:111], v145 offset:9216
ds_read_b64_tr_b16 v[112:113], v146 offset:8192
ds_read_b64_tr_b16 v[114:115], v146 offset:9216
v_mfma_f32_32x32x16_bf16 v[80:95], v[132:135], v[116:119], v[80:95]
s_waitcnt lgkmcnt(0)
v_mfma_f32_32x32x16_bf16 v[32:47], v[100:103], v[96:99], v[32:47]
ds_read_b128 v[116:119], v142 offset:0
ds_read_b64_tr_b16 v[120:121], v143 offset:12288
ds_read_b64_tr_b16 v[122:123], v143 offset:13312
buffer_store_dwordx4 v[188:191], v187, s[52:55], 0 offen sc1
v_lshlrev_b32 v208, 16, v182
v_lshlrev_b32 v209, 16, v184
v_mul_f32 v210, v208, v200
v_mfma_f32_32x32x16_bf16 v[48:63], v[104:107], v[96:99], v[48:63]
ds_read_b64_tr_b16 v[124:125], v144 offset:12288
ds_read_b64_tr_b16 v[126:127], v144 offset:13312
ds_read_b64_tr_b16 v[128:129], v145 offset:12288
v_fma_f32 v210, -v209, v201, v210
v_mul_f32 v211, v208, v201
v_fma_f32 v211, v209, v200, v211
v_cvt_pk_bf16_f32 v212, v210, -v211
v_mfma_f32_32x32x16_bf16 v[64:79], v[108:111], v[96:99], v[64:79]
ds_read_b64_tr_b16 v[130:131], v145 offset:13312
ds_read_b64_tr_b16 v[132:133], v146 offset:12288
ds_read_b64_tr_b16 v[134:135], v146 offset:13312
v_and_b32 v208, 0xffff0000, v182
v_and_b32 v209, 0xffff0000, v184
v_mul_f32 v210, v208, v202
v_fma_f32 v210, -v209, v203, v210
v_mfma_f32_32x32x16_bf16 v[80:95], v[112:115], v[96:99], v[80:95]
v_mul_f32 v211, v208, v203
v_fma_f32 v211, v209, v202, v211
v_cvt_pk_bf16_f32 v213, v210, -v211
s_waitcnt lgkmcnt(0)
s_waitcnt vmcnt(6)
s_barrier
v_mfma_f32_32x32x16_bf16 v[32:47], v[120:123], v[116:119], v[32:47]
ds_read_b128 v[96:99], v139 offset:16384
ds_read_b64_tr_b16 v[100:101], v143 offset:16384
ds_read_b64_tr_b16 v[102:103], v143 offset:17408
s_add_u32 m0, s60, 0
s_movk_i32 s23, 1152
buffer_load_dwordx4 v136, s[40:43], s23 offen lds
v_lshlrev_b32 v208, 16, v183
v_lshlrev_b32 v209, 16, v185
v_mul_f32 v210, v208, v204
v_fma_f32 v210, -v209, v205, v210
v_mfma_f32_32x32x16_bf16 v[48:63], v[124:127], v[116:119], v[48:63]
ds_read_b64_tr_b16 v[104:105], v144 offset:16384
ds_read_b64_tr_b16 v[106:107], v144 offset:17408
ds_read_b64_tr_b16 v[108:109], v145 offset:16384
s_add_u32 m0, s60, 1024
s_movk_i32 s23, 1152
buffer_load_dwordx4 v137, s[40:43], s23 offen lds
v_mul_f32 v211, v208, v205
v_fma_f32 v211, v209, v204, v211
v_cvt_pk_bf16_f32 v214, v210, -v211
v_and_b32 v208, 0xffff0000, v183
v_mfma_f32_32x32x16_bf16 v[64:79], v[128:131], v[116:119], v[64:79]
ds_read_b64_tr_b16 v[110:111], v145 offset:17408
ds_read_b64_tr_b16 v[112:113], v146 offset:16384
ds_read_b64_tr_b16 v[114:115], v146 offset:17408
v_and_b32 v209, 0xffff0000, v185
v_mul_f32 v210, v208, v206
v_fma_f32 v210, -v209, v207, v210
v_mul_f32 v211, v208, v207
v_mfma_f32_32x32x16_bf16 v[80:95], v[132:135], v[116:119], v[80:95]
v_fma_f32 v211, v209, v206, v211
v_cvt_pk_bf16_f32 v215, v210, -v211
buffer_store_dwordx4 v[212:215], v181, s[52:55], 0 offen sc1
s_waitcnt lgkmcnt(0)
v_mfma_f32_32x32x16_bf16 v[32:47], v[100:103], v[96:99], v[32:47]
ds_read_b128 v[116:119], v140 offset:16384
ds_read_b64_tr_b16 v[120:121], v143 offset:20480
ds_read_b64_tr_b16 v[122:123], v143 offset:21504
s_add_u32 m0, s62, 0
s_add_u32 s23, s3, 2211840
buffer_load_dwordx4 v138, s[48:51], s23 offen lds
v_mfma_f32_32x32x16_bf16 v[48:63], v[104:107], v[96:99], v[48:63]
ds_read_b64_tr_b16 v[124:125], v144 offset:20480
ds_read_b64_tr_b16 v[126:127], v144 offset:21504
ds_read_b64_tr_b16 v[128:129], v145 offset:20480
s_add_u32 m0, s62, 1024
s_add_u32 s23, s3, 2227200
buffer_load_dwordx4 v138, s[48:51], s23 offen lds
v_mfma_f32_32x32x16_bf16 v[64:79], v[108:111], v[96:99], v[64:79]
ds_read_b64_tr_b16 v[130:131], v145 offset:21504
ds_read_b64_tr_b16 v[132:133], v146 offset:20480
ds_read_b64_tr_b16 v[134:135], v146 offset:21504
v_mfma_f32_32x32x16_bf16 v[80:95], v[112:115], v[96:99], v[80:95]
s_waitcnt lgkmcnt(0)
v_mfma_f32_32x32x16_bf16 v[32:47], v[120:123], v[116:119], v[32:47]
ds_read_b128 v[96:99], v141 offset:16384
ds_read_b64_tr_b16 v[100:101], v143 offset:24576
ds_read_b64_tr_b16 v[102:103], v143 offset:25600
s_add_u32 m0, s62, 2048
s_add_u32 s23, s3, 2242560
buffer_load_dwordx4 v138, s[48:51], s23 offen lds
v_mfma_f32_32x32x16_bf16 v[48:63], v[124:127], v[116:119], v[48:63]
ds_read_b64_tr_b16 v[104:105], v144 offset:24576
ds_read_b64_tr_b16 v[106:107], v144 offset:25600
ds_read_b64_tr_b16 v[108:109], v145 offset:24576
v_mfma_f32_32x32x16_bf16 v[64:79], v[128:131], v[116:119], v[64:79]
ds_read_b64_tr_b16 v[110:111], v145 offset:25600
ds_read_b64_tr_b16 v[112:113], v146 offset:24576
ds_read_b64_tr_b16 v[114:115], v146 offset:25600
v_mfma_f32_32x32x16_bf16 v[80:95], v[132:135], v[116:119], v[80:95]
s_waitcnt lgkmcnt(0)
v_mfma_f32_32x32x16_bf16 v[32:47], v[100:103], v[96:99], v[32:47]
ds_read_b128 v[116:119], v142 offset:16384
ds_read_b64_tr_b16 v[120:121], v143 offset:28672
ds_read_b64_tr_b16 v[122:123], v143 offset:29696
v_mfma_f32_32x32x16_bf16 v[48:63], v[104:107], v[96:99], v[48:63]
ds_read_b64_tr_b16 v[124:125], v144 offset:28672
ds_read_b64_tr_b16 v[126:127], v144 offset:29696
ds_read_b64_tr_b16 v[128:129], v145 offset:28672
v_mfma_f32_32x32x16_bf16 v[64:79], v[108:111], v[96:99], v[64:79]
ds_read_b64_tr_b16 v[130:131], v145 offset:29696
ds_read_b64_tr_b16 v[132:133], v146 offset:28672
ds_read_b64_tr_b16 v[134:135], v146 offset:29696
v_mfma_f32_32x32x16_bf16 v[80:95], v[112:115], v[96:99], v[80:95]
s_waitcnt lgkmcnt(0)
s_waitcnt vmcnt(7)
s_barrier
v_mfma_f32_32x32x16_bf16 v[32:47], v[120:123], v[116:119], v[32:47]
ds_read_b128 v[96:99], v139 offset:32768
ds_read_b64_tr_b16 v[100:101], v143 offset:32768
ds_read_b64_tr_b16 v[102:103], v143 offset:33792
v_mfma_f32_32x32x16_bf16 v[48:63], v[124:127], v[116:119], v[48:63]
ds_read_b64_tr_b16 v[104:105], v144 offset:32768
ds_read_b64_tr_b16 v[106:107], v144 offset:33792
ds_read_b64_tr_b16 v[108:109], v145 offset:32768
v_mfma_f32_32x32x16_bf16 v[64:79], v[128:131], v[116:119], v[64:79]
ds_read_b64_tr_b16 v[110:111], v145 offset:33792
ds_read_b64_tr_b16 v[112:113], v146 offset:32768
ds_read_b64_tr_b16 v[114:115], v146 offset:33792
v_mfma_f32_32x32x16_bf16 v[80:95], v[132:135], v[116:119], v[80:95]
s_waitcnt lgkmcnt(0)
v_mfma_f32_32x32x16_bf16 v[32:47], v[100:103], v[96:99], v[32:47]
ds_read_b128 v[116:119], v140 offset:32768
ds_read_b64_tr_b16 v[120:121], v143 offset:36864
ds_read_b64_tr_b16 v[122:123], v143 offset:37888
v_mfma_f32_32x32x16_bf16 v[48:63], v[104:107], v[96:99], v[48:63]
ds_read_b64_tr_b16 v[124:125], v144 offset:36864
ds_read_b64_tr_b16 v[126:127], v144 offset:37888
ds_read_b64_tr_b16 v[128:129], v145 offset:36864
v_mfma_f32_32x32x16_bf16 v[64:79], v[108:111], v[96:99], v[64:79]
ds_read_b64_tr_b16 v[130:131], v145 offset:37888
ds_read_b64_tr_b16 v[132:133], v146 offset:36864
ds_read_b64_tr_b16 v[134:135], v146 offset:37888
v_mfma_f32_32x32x16_bf16 v[80:95], v[112:115], v[96:99], v[80:95]
s_waitcnt lgkmcnt(0)
v_mfma_f32_32x32x16_bf16 v[32:47], v[120:123], v[116:119], v[32:47]
ds_read_b128 v[96:99], v141 offset:32768
ds_read_b64_tr_b16 v[100:101], v143 offset:40960
ds_read_b64_tr_b16 v[102:103], v143 offset:41984
v_mfma_f32_32x32x16_bf16 v[48:63], v[124:127], v[116:119], v[48:63]
ds_read_b64_tr_b16 v[104:105], v144 offset:40960
ds_read_b64_tr_b16 v[106:107], v144 offset:41984
ds_read_b64_tr_b16 v[108:109], v145 offset:40960
v_mfma_f32_32x32x16_bf16 v[64:79], v[128:131], v[116:119], v[64:79]
ds_read_b64_tr_b16 v[110:111], v145 offset:41984
ds_read_b64_tr_b16 v[112:113], v146 offset:40960
ds_read_b64_tr_b16 v[114:115], v146 offset:41984
v_mfma_f32_32x32x16_bf16 v[80:95], v[132:135], v[116:119], v[80:95]
s_waitcnt lgkmcnt(0)
v_mfma_f32_32x32x16_bf16 v[32:47], v[100:103], v[96:99], v[32:47]
ds_read_b128 v[116:119], v142 offset:32768
ds_read_b64_tr_b16 v[120:121], v143 offset:45056
ds_read_b64_tr_b16 v[122:123], v143 offset:46080
v_mfma_f32_32x32x16_bf16 v[48:63], v[104:107], v[96:99], v[48:63]
ds_read_b64_tr_b16 v[124:125], v144 offset:45056
ds_read_b64_tr_b16 v[126:127], v144 offset:46080
ds_read_b64_tr_b16 v[128:129], v145 offset:45056
v_mfma_f32_32x32x16_bf16 v[64:79], v[108:111], v[96:99], v[64:79]
ds_read_b64_tr_b16 v[130:131], v145 offset:46080
ds_read_b64_tr_b16 v[132:133], v146 offset:45056
ds_read_b64_tr_b16 v[134:135], v146 offset:46080
v_mfma_f32_32x32x16_bf16 v[80:95], v[112:115], v[96:99], v[80:95]
s_waitcnt lgkmcnt(0)
s_waitcnt vmcnt(0)
s_barrier
s_cmp_lg_u32 s63, 0
s_cbranch_scc1 L_nonce_ok_Y
s_mov_b32 s22, 0
L_nonce_Y:
v_mov_b32 v20, 0
global_load_dword v21, v20, s[34:35] sc1
s_waitcnt vmcnt(0)
v_readfirstlane_b32 s63, v21
s_add_u32 s22, s22, 1
s_cmp_ge_u32 s22, 0x100000
s_cbranch_scc1 L_nonce_ok_Y
s_cmp_eq_u32 s63, 0
s_cbranch_scc1 L_nonce_Y
L_nonce_ok_Y:
v_mfma_f32_32x32x16_bf16 v[32:47], v[120:123], v[116:119], v[32:47]
ds_read_b128 v[96:99], v139 offset:0
ds_read_b64_tr_b16 v[100:101], v143 offset:0
ds_read_b64_tr_b16 v[102:103], v143 offset:1024
v_mfma_f32_32x32x16_bf16 v[48:63], v[124:127], v[116:119], v[48:63]
ds_read_b64_tr_b16 v[104:105], v144 offset:0
ds_read_b64_tr_b16 v[106:107], v144 offset:1024
ds_read_b64_tr_b16 v[108:109], v145 offset:0
v_mfma_f32_32x32x16_bf16 v[64:79], v[128:131], v[116:119], v[64:79]
ds_read_b64_tr_b16 v[110:111], v145 offset:1024
ds_read_b64_tr_b16 v[112:113], v146 offset:0
ds_read_b64_tr_b16 v[114:115], v146 offset:1024
v_mfma_f32_32x32x16_bf16 v[80:95], v[132:135], v[116:119], v[80:95]
s_waitcnt lgkmcnt(0)
v_mfma_f32_32x32x16_bf16 v[32:47], v[100:103], v[96:99], v[32:47]
ds_read_b128 v[116:119], v140 offset:0
ds_read_b64_tr_b16 v[120:121], v143 offset:4096
ds_read_b64_tr_b16 v[122:123], v143 offset:5120
v_mfma_f32_32x32x16_bf16 v[48:63], v[104:107], v[96:99], v[48:63]
ds_read_b64_tr_b16 v[124:125], v144 offset:4096
ds_read_b64_tr_b16 v[126:127], v144 offset:5120
ds_read_b64_tr_b16 v[128:129], v145 offset:4096
v_mfma_f32_32x32x16_bf16 v[64:79], v[108:111], v[96:99], v[64:79]
ds_read_b64_tr_b16 v[130:131], v145 offset:5120
ds_read_b64_tr_b16 v[132:133], v146 offset:4096
ds_read_b64_tr_b16 v[134:135], v146 offset:5120
v_mfma_f32_32x32x16_bf16 v[80:95], v[112:115], v[96:99], v[80:95]
s_waitcnt lgkmcnt(0)
v_mfma_f32_32x32x16_bf16 v[32:47], v[120:123], v[116:119], v[32:47]
ds_read_b128 v[96:99], v141 offset:0
ds_read_b64_tr_b16 v[100:101], v143 offset:8192
ds_read_b64_tr_b16 v[102:103], v143 offset:9216
v_mfma_f32_32x32x16_bf16 v[48:63], v[124:127], v[116:119], v[48:63]
ds_read_b64_tr_b16 v[104:105], v144 offset:8192
ds_read_b64_tr_b16 v[106:107], v144 offset:9216
ds_read_b64_tr_b16 v[108:109], v145 offset:8192
v_mfma_f32_32x32x16_bf16 v[64:79], v[128:131], v[116:119], v[64:79]
ds_read_b64_tr_b16 v[110:111], v145 offset:9216
ds_read_b64_tr_b16 v[112:113], v146 offset:8192
ds_read_b64_tr_b16 v[114:115], v146 offset:9216
v_mfma_f32_32x32x16_bf16 v[80:95], v[132:135], v[116:119], v[80:95]
s_waitcnt lgkmcnt(0)
v_mfma_f32_32x32x16_bf16 v[32:47], v[100:103], v[96:99], v[32:47]
ds_read_b128 v[116:119], v142 offset:0
ds_read_b64_tr_b16 v[120:121], v143 offset:12288
ds_read_b64_tr_b16 v[122:123], v143 offset:13312
v_mfma_f32_32x32x16_bf16 v[48:63], v[104:107], v[96:99], v[48:63]
ds_read_b64_tr_b16 v[124:125], v144 offset:12288
ds_read_b64_tr_b16 v[126:127], v144 offset:13312
ds_read_b64_tr_b16 v[128:129], v145 offset:12288
v_mfma_f32_32x32x16_bf16 v[64:79], v[108:111], v[96:99], v[64:79]
ds_read_b64_tr_b16 v[130:131], v145 offset:13312
ds_read_b64_tr_b16 v[132:133], v146 offset:12288
ds_read_b64_tr_b16 v[134:135], v146 offset:13312
v_mfma_f32_32x32x16_bf16 v[80:95], v[112:115], v[96:99], v[80:95]
s_waitcnt lgkmcnt(0)
v_mfma_f32_32x32x16_bf16 v[32:47], v[120:123], v[116:119], v[32:47]
v_mfma_f32_32x32x16_bf16 v[48:63], v[124:127], v[116:119], v[48:63]
v_mfma_f32_32x32x16_bf16 v[64:79], v[128:131], v[116:119], v[64:79]
v_mfma_f32_32x32x16_bf16 v[80:95], v[132:135], v[116:119], v[80:95]
ds_read_b64_tr_b16 v[108:109], v3 offset:0
ds_read_b64_tr_b16 v[110:111], v3 offset:160
ds_read_b64_tr_b16 v[112:113], v3 offset:320
ds_read_b64_tr_b16 v[114:115], v3 offset:480
ds_read_b64_tr_b16 v[116:117], v4 offset:0
v_mov_b32 v118, 0
v_mov_b32 v119, 0
ds_read_b64_tr_b16 v[120:121], v5 offset:0
ds_read_b64_tr_b16 v[122:123], v5 offset:160
ds_read_b64_tr_b16 v[124:125], v5 offset:320
ds_read_b64_tr_b16 v[126:127], v5 offset:480
ds_read_b64_tr_b16 v[128:129], v6 offset:0
v_mov_b32 v130, 0
v_mov_b32 v131, 0
v_cvt_pk_bf16_f32 v96, v64, v65
v_cvt_pk_bf16_f32 v97, v66, v67
v_cvt_pk_bf16_f32 v98, v68, v69
v_cvt_pk_bf16_f32 v99, v70, v71
v_cvt_pk_bf16_f32 v100, v72, v73
v_cvt_pk_bf16_f32 v101, v74, v75
v_cvt_pk_bf16_f32 v102, v76, v77
v_cvt_pk_bf16_f32 v103, v78, v79
v_cvt_pk_bf16_f32 v104, v80, v81
v_cvt_pk_bf16_f32 v105, v82, v83
v_mov_b32 v106, 0
v_mov_b32 v107, 0
s_waitcnt lgkmcnt(0)
v_mfma_f32_32x32x16_bf16 v[136:151], v[108:111], v[96:99], 0
v_mfma_f32_32x32x16_bf16 v[152:167], v[120:123], v[96:99], 0
v_mfma_f32_32x32x16_bf16 v[136:151], v[112:115], v[100:103], v[136:151]
v_mfma_f32_32x32x16_bf16 v[152:167], v[124:127], v[100:103], v[152:167]
v_mfma_f32_32x32x16_bf16 v[136:151], v[116:119], v[104:107], v[136:151]
v_mfma_f32_32x32x16_bf16 v[152:167], v[128:131], v[104:107], v[152:167]
s_nop 10
v_max3_f32 v20, v136, v137, v138
v_min3_f32 v21, v136, v137, v138
v_max3_f32 v20, v20, v139, v140
v_min3_f32 v21, v21, v139, v140
v_max3_f32 v20, v20, v141, v142
v_min3_f32 v21, v21, v141, v142
v_max3_f32 v20, v20, v143, v144
v_min3_f32 v21, v21, v143, v144
v_max3_f32 v20, v20, v145, v146
v_min3_f32 v21, v21, v145, v146
v_max3_f32 v20, v20, v147, v148
v_min3_f32 v21, v21, v147, v148
v_max3_f32 v20, v20, v149, v150
v_min3_f32 v21, v21, v149, v150
v_max3_f32 v20, v20, v151, v152
v_min3_f32 v21, v21, v151, v152
v_max3_f32 v20, v20, v153, v154
v_min3_f32 v21, v21, v153, v154
v_max_f32 v20, v20, v155
v_min_f32 v21, v21, v155
v_mul_f32 v22, s78, v20
v_mul_f32 v23, s76, v21
v_pk_fma_f32 v[96:97], v[136:137], s[76:77], v[22:23] op_sel_hi:[1,1,0]
v_pk_fma_f32 v[116:117], v[136:137], s[78:79], v[22:23] op_sel:[0,0,1] op_sel_hi:[1,1,1]
v_pk_fma_f32 v[98:99], v[138:139], s[76:77], v[22:23] op_sel_hi:[1,1,0]
v_pk_fma_f32 v[118:119], v[138:139], s[78:79], v[22:23] op_sel:[0,0,1] op_sel_hi:[1,1,1]
v_pk_fma_f32 v[100:101], v[140:141], s[76:77], v[22:23] op_sel_hi:[1,1,0]
v_pk_fma_f32 v[120:121], v[140:141], s[78:79], v[22:23] op_sel:[0,0,1] op_sel_hi:[1,1,1]
v_pk_fma_f32 v[102:103], v[142:143], s[76:77], v[22:23] op_sel_hi:[1,1,0]
v_pk_fma_f32 v[122:123], v[142:143], s[78:79], v[22:23] op_sel:[0,0,1] op_sel_hi:[1,1,1]
v_pk_fma_f32 v[104:105], v[144:145], s[76:77], v[22:23] op_sel_hi:[1,1,0]
v_pk_fma_f32 v[124:125], v[144:145], s[78:79], v[22:23] op_sel:[0,0,1] op_sel_hi:[1,1,1]
v_pk_fma_f32 v[106:107], v[146:147], s[76:77], v[22:23] op_sel_hi:[1,1,0]
v_pk_fma_f32 v[126:127], v[146:147], s[78:79], v[22:23] op_sel:[0,0,1] op_sel_hi:[1,1,1]
v_pk_fma_f32 v[108:109], v[148:149], s[76:77], v[22:23] op_sel_hi:[1,1,0]
v_pk_fma_f32 v[128:129], v[148:149], s[78:79], v[22:23] op_sel:[0,0,1] op_sel_hi:[1,1,1]
v_pk_fma_f32 v[110:111], v[150:151], s[76:77], v[22:23] op_sel_hi:[1,1,0]
v_pk_fma_f32 v[130:131], v[150:151], s[78:79], v[22:23] op_sel:[0,0,1] op_sel_hi:[1,1,1]
v_pk_fma_f32 v[112:113], v[152:153], s[76:77], v[22:23] op_sel_hi:[1,1,0]
v_pk_fma_f32 v[132:133], v[152:153], s[78:79], v[22:23] op_sel:[0,0,1] op_sel_hi:[1,1,1]
v_pk_fma_f32 v[114:115], v[154:155], s[76:77], v[22:23] op_sel_hi:[1,1,0]
v_pk_fma_f32 v[134:135], v[154:155], s[78:79], v[22:23] op_sel:[0,0,1] op_sel_hi:[1,1,1]
v_exp_f32 v96, v96
v_exp_f32 v116, v116
v_exp_f32 v97, v97
v_exp_f32 v117, v117
v_exp_f32 v98, v98
v_exp_f32 v118, v118
v_exp_f32 v99, v99
v_exp_f32 v119, v119
v_exp_f32 v100, v100
v_exp_f32 v120, v120
v_exp_f32 v101, v101
v_exp_f32 v121, v121
v_exp_f32 v102, v102
v_exp_f32 v122, v122
v_exp_f32 v103, v103
v_exp_f32 v123, v123
v_exp_f32 v104, v104
v_exp_f32 v124, v124
v_exp_f32 v105, v105
v_exp_f32 v125, v125
v_exp_f32 v106, v106
v_exp_f32 v126, v126
v_exp_f32 v107, v107
v_exp_f32 v127, v127
v_exp_f32 v108, v108
v_exp_f32 v128, v128
v_exp_f32 v109, v109
v_exp_f32 v129, v129
v_exp_f32 v110, v110
v_exp_f32 v130, v130
v_exp_f32 v111, v111
v_exp_f32 v131, v131
v_exp_f32 v112, v112
v_exp_f32 v132, v132
v_exp_f32 v113, v113
v_exp_f32 v133, v133
v_exp_f32 v114, v114
v_exp_f32 v134, v134
v_exp_f32 v115, v115
v_exp_f32 v135, v135
v_pk_add_f32 v[24:25], v[96:97], v[98:99]
v_pk_add_f32 v[26:27], v[116:117], v[118:119]
v_pk_add_f32 v[24:25], v[24:25], v[100:101]
v_pk_add_f32 v[26:27], v[26:27], v[120:121]
v_pk_add_f32 v[24:25], v[24:25], v[102:103]
v_pk_add_f32 v[26:27], v[26:27], v[122:123]
v_pk_add_f32 v[24:25], v[24:25], v[104:105]
v_pk_add_f32 v[26:27], v[26:27], v[124:125]
v_pk_add_f32 v[24:25], v[24:25], v[106:107]
v_pk_add_f32 v[26:27], v[26:27], v[126:127]
v_pk_add_f32 v[24:25], v[24:25], v[108:109]
v_pk_add_f32 v[26:27], v[26:27], v[128:129]
v_pk_add_f32 v[24:25], v[24:25], v[110:111]
v_pk_add_f32 v[26:27], v[26:27], v[130:131]
v_pk_add_f32 v[24:25], v[24:25], v[112:113]
v_pk_add_f32 v[26:27], v[26:27], v[132:133]
v_pk_add_f32 v[24:25], v[24:25], v[114:115]
v_pk_add_f32 v[26:27], v[26:27], v[134:135]
v_add_f32 v24, v24, v25
v_add_f32 v26, v26, v27
v_rcp_f32 v24, v24
v_rcp_f32 v25, v26
s_nop 0
v_pk_mul_f32 v[96:97], v[96:97], v[24:25] op_sel_hi:[1,0]
v_pk_mul_f32 v[116:117], v[116:117], v[24:25] op_sel:[0,1] op_sel_hi:[1,1]
v_pk_mul_f32 v[98:99], v[98:99], v[24:25] op_sel_hi:[1,0]
v_pk_mul_f32 v[118:119], v[118:119], v[24:25] op_sel:[0,1] op_sel_hi:[1,1]
v_pk_mul_f32 v[100:101], v[100:101], v[24:25] op_sel_hi:[1,0]
v_pk_mul_f32 v[120:121], v[120:121], v[24:25] op_sel:[0,1] op_sel_hi:[1,1]
v_pk_mul_f32 v[102:103], v[102:103], v[24:25] op_sel_hi:[1,0]
v_pk_mul_f32 v[122:123], v[122:123], v[24:25] op_sel:[0,1] op_sel_hi:[1,1]
v_pk_mul_f32 v[104:105], v[104:105], v[24:25] op_sel_hi:[1,0]
v_pk_mul_f32 v[124:125], v[124:125], v[24:25] op_sel:[0,1] op_sel_hi:[1,1]
v_pk_mul_f32 v[106:107], v[106:107], v[24:25] op_sel_hi:[1,0]
v_pk_mul_f32 v[126:127], v[126:127], v[24:25] op_sel:[0,1] op_sel_hi:[1,1]
v_pk_mul_f32 v[108:109], v[108:109], v[24:25] op_sel_hi:[1,0]
v_pk_mul_f32 v[128:129], v[128:129], v[24:25] op_sel:[0,1] op_sel_hi:[1,1]
v_pk_mul_f32 v[110:111], v[110:111], v[24:25] op_sel_hi:[1,0]
v_pk_mul_f32 v[130:131], v[130:131], v[24:25] op_sel:[0,1] op_sel_hi:[1,1]
v_pk_mul_f32 v[112:113], v[112:113], v[24:25] op_sel_hi:[1,0]
v_pk_mul_f32 v[132:133], v[132:133], v[24:25] op_sel:[0,1] op_sel_hi:[1,1]
v_pk_mul_f32 v[114:115], v[114:115], v[24:25] op_sel_hi:[1,0]
v_pk_mul_f32 v[134:135], v[134:135], v[24:25] op_sel:[0,1] op_sel_hi:[1,1]
v_cvt_pk_bf16_f32 v136, v96, v97
v_cvt_pk_bf16_f32 v146, v116, v117
v_cvt_pk_bf16_f32 v137, v98, v99
v_cvt_pk_bf16_f32 v147, v118, v119
v_cvt_pk_bf16_f32 v138, v100, v101
v_cvt_pk_bf16_f32 v148, v120, v121
v_cvt_pk_bf16_f32 v139, v102, v103
v_cvt_pk_bf16_f32 v149, v122, v123
v_cvt_pk_bf16_f32 v140, v104, v105
v_cvt_pk_bf16_f32 v150, v124, v125
v_cvt_pk_bf16_f32 v141, v106, v107
v_cvt_pk_bf16_f32 v151, v126, v127
v_cvt_pk_bf16_f32 v142, v108, v109
v_cvt_pk_bf16_f32 v152, v128, v129
v_cvt_pk_bf16_f32 v143, v110, v111
v_cvt_pk_bf16_f32 v153, v130, v131
v_cvt_pk_bf16_f32 v144, v112, v113
v_cvt_pk_bf16_f32 v154, v132, v133
v_cvt_pk_bf16_f32 v145, v114, v115
v_cvt_pk_bf16_f32 v155, v134, v135
ds_write_b128 v7, v[136:139] offset:0
ds_write_b128 v7, v[140:143] offset:16
ds_write_b128 v7, v[144:147] offset:32
ds_write_b128 v7, v[148:151] offset:48
ds_write_b128 v7, v[152:155] offset:64
v_cvt_pk_bf16_f32 v24, v52, v53
v_cvt_pk_bf16_f32 v25, v54, v55
ds_write_b64 v8, v[24:25] offset:160
v_cvt_pk_bf16_f32 v24, v56, v57
v_cvt_pk_bf16_f32 v25, v58, v59
ds_write_b64 v8, v[24:25] offset:168
v_cvt_pk_bf16_f32 v24, v60, v61
v_cvt_pk_bf16_f32 v25, v62, v63
ds_write_b64 v9, v[24:25] offset:192
v_cvt_pk_bf16_f32 v24, v84, v85
v_cvt_pk_bf16_f32 v25, v86, v87
ds_write_b64 v8, v[24:25] offset:176
v_cvt_pk_bf16_f32 v24, v88, v89
v_cvt_pk_bf16_f32 v25, v90, v91
ds_write_b64 v8, v[24:25] offset:184
v_mov_b32 v24, 0x3f80
v_mov_b32 v25, 0
ds_write_b64 v10, v[24:25] offset:200
s_waitcnt lgkmcnt(0)
v_mov_b32 v20, 153520
v_mov_b32 v21, 1
v_cmp_eq_u32 vcc, 0, v1
s_and_saveexec_b64 s[22:23], vcc
ds_add_rtn_u32 v22, v20, v21
s_mov_b64 exec, s[22:23]
s_waitcnt lgkmcnt(0)
v_readfirstlane_b32 s66, v22
v_mov_b32 v20, 153520
s_mov_b32 s22, 0
L_lw_81:
ds_read_b32 v21, v20
s_waitcnt lgkmcnt(0)
v_readfirstlane_b32 s64, v21
s_add_u32 s22, s22, 1
s_cmp_ge_u32 s64, 4
s_cbranch_scc1 L_lwok_81
s_cmp_lt_u32 s22, 4194304
s_cbranch_scc1 L_lw_81
L_lwok_81:
ds_read_b64_tr_b16 v[96:97], v11 offset:0
ds_read_b64_tr_b16 v[100:101], v12 offset:0
ds_read_b64_tr_b16 v[98:99], v11 offset:1280
ds_read_b64_tr_b16 v[102:103], v12 offset:1280
ds_read_b64_tr_b16 v[104:105], v11 offset:5152
ds_read_b64_tr_b16 v[108:109], v12 offset:5152
ds_read_b64_tr_b16 v[106:107], v11 offset:6432
ds_read_b64_tr_b16 v[110:111], v12 offset:6432
ds_read_b64_tr_b16 v[112:113], v11 offset:10240
ds_read_b64_tr_b16 v[116:117], v12 offset:10240
ds_read_b64_tr_b16 v[114:115], v11 offset:11520
ds_read_b64_tr_b16 v[118:119], v12 offset:11520
ds_read_b64_tr_b16 v[120:121], v11 offset:15392
ds_read_b64_tr_b16 v[124:125], v12 offset:15392
ds_read_b64_tr_b16 v[122:123], v11 offset:16672
ds_read_b64_tr_b16 v[126:127], v12 offset:16672
ds_read_b64_tr_b16 v[128:129], v11 offset:20480
ds_read_b64_tr_b16 v[132:133], v12 offset:20480
ds_read_b64_tr_b16 v[130:131], v11 offset:21760
ds_read_b64_tr_b16 v[134:135], v12 offset:21760
ds_read_b64_tr_b16 v[64:65], v11 offset:25632
ds_read_b64_tr_b16 v[68:69], v12 offset:25632
ds_read_b64_tr_b16 v[66:67], v11 offset:26912
ds_read_b64_tr_b16 v[70:71], v12 offset:26912
ds_read_b64_tr_b16 v[72:73], v11 offset:30720
ds_read_b64_tr_b16 v[76:77], v12 offset:30720
ds_read_b64_tr_b16 v[74:75], v11 offset:32000
ds_read_b64_tr_b16 v[78:79], v12 offset:32000
ds_read_b64_tr_b16 v[80:81], v11 offset:35872
ds_read_b64_tr_b16 v[84:85], v12 offset:35872
ds_read_b64_tr_b16 v[82:83], v11 offset:37152
ds_read_b64_tr_b16 v[86:87], v12 offset:37152
s_waitcnt lgkmcnt(15)
v_mfma_f32_32x32x16_bf16 v[156:171], v[96:99], v[100:103], 0
v_mfma_f32_32x32x16_bf16 v[136:151], v[104:107], v[108:111], 0
s_waitcnt lgkmcnt(15)
v_mfma_f32_32x32x16_bf16 v[156:171], v[112:115], v[116:119], v[156:171]
v_mfma_f32_32x32x16_bf16 v[136:151], v[120:123], v[124:127], v[136:151]
s_waitcnt lgkmcnt(8)
v_mfma_f32_32x32x16_bf16 v[156:171], v[128:131], v[132:135], v[156:171]
v_mfma_f32_32x32x16_bf16 v[136:151], v[64:67], v[68:71], v[136:151]
s_waitcnt lgkmcnt(0)
v_mfma_f32_32x32x16_bf16 v[156:171], v[72:75], v[76:79], v[156:171]
v_mfma_f32_32x32x16_bf16 v[136:151], v[80:83], v[84:87], v[136:151]
s_nop 11
v_pk_add_f32 v[156:157], v[156:157], v[136:137]
v_pk_add_f32 v[158:159], v[158:159], v[138:139]
v_pk_add_f32 v[160:161], v[160:161], v[140:141]
v_pk_add_f32 v[162:163], v[162:163], v[142:143]
v_pk_add_f32 v[164:165], v[164:165], v[144:145]
v_pk_add_f32 v[166:167], v[166:167], v[146:147]
v_pk_add_f32 v[168:169], v[168:169], v[148:149]
v_pk_add_f32 v[170:171], v[170:171], v[150:151]
s_lshl_b32 s66, s57, 4
s_add_u32 s66, s66, s56
s_lshl_b32 s66, s66, 12
s_add_u32 s66, s66, 12582912
v_cvt_pk_bf16_f32 v96, v156, v157
v_cvt_pk_bf16_f32 v97, v158, v159
v_cvt_pk_bf16_f32 v98, v160, v161
v_cvt_pk_bf16_f32 v99, v162, v163
v_cvt_pk_bf16_f32 v100, v164, v165
v_cvt_pk_bf16_f32 v101, v166, v167
v_cvt_pk_bf16_f32 v102, v168, v169
v_cvt_pk_bf16_f32 v103, v170, v171
v_add_u32 v26, 61440, v13
v_min_u32 v26, 64800, v26
ds_write_b64 v26, v[96:97]
s_and_b32 s65, s59, 1
s_cmp_lg_u32 s65, 0
s_cbranch_scc1 L_kvw
ds_write_b64 v26, v[98:99] offset:16
ds_write_b64 v26, v[100:101] offset:32
ds_write_b64 v26, v[102:103] offset:48
L_kvw:
s_waitcnt lgkmcnt(0)
v_mov_b32 v20, 153572
v_mov_b32 v21, 1
v_cmp_eq_u32 vcc, 0, v1
s_and_saveexec_b64 s[22:23], vcc
ds_add_rtn_u32 v22, v20, v21
s_mov_b64 exec, s[22:23]
s_waitcnt lgkmcnt(0)
v_readfirstlane_b32 s66, v22
v_mov_b32 v20, 153572
s_mov_b32 s22, 0
L_lw_82:
ds_read_b32 v21, v20
s_waitcnt lgkmcnt(0)
v_readfirstlane_b32 s64, v21
s_add_u32 s22, s22, 1
s_cmp_ge_u32 s64, 4
s_cbranch_scc1 L_lwok_82
s_cmp_lt_u32 s22, 4194304
s_cbranch_scc1 L_lw_82
L_lwok_82:
s_lshl_b32 s66, s57, 4
s_add_u32 s66, s66, s56
s_lshl_b32 s66, s66, 12
s_add_u32 s66, s66, 12582912
s_lshl_b32 s64, s59, 6
v_add_u32 v22, s64, v1
v_lshlrev_b32 v27, 4, v22
v_add_u32 v26, 61440, v27
ds_read_b128 v[96:99], v26
v_mov_b32 v24, 2146435072
v_cmp_gt_u32 vcc, 210, v22
s_nop 1
v_cndmask_b32 v27, v24, v27, vcc
s_waitcnt lgkmcnt(0)
buffer_store_dwordx4 v[96:99], v27, s[52:55], s66 offen sc1
v_bfe_u32 v24, v1, 2, 1
v_lshlrev_b32 v24, 4, v24
v_and_b32 v25, 1, v1
v_lshl_add_u32 v24, v25, 3, v24
v_bfe_u32 v25, v1, 3, 2
v_lshl_add_u32 v24, v25, 1, v24
v_bfe_u32 v25, v1, 1, 1
v_add_u32 v24, v24, v25
s_lshl_b32 s64, s59, 5
v_add_u32 v24, s64, v24
v_lshrrev_b32 v25, 4, v24
s_lshl_b32 s64, s56, 3
v_add_u32 v25, s64, v25
v_mul_u32_u24 v25, 61440, v25
v_and_b32 v24, 15, v24
v_lshl_add_u32 v25, v24, 4, v25
s_xor_b32 s64, s57, 1
s_mul_i32 s64, s64, 5
s_add_u32 s64, s64, 160
s_lshl_b32 s64, s64, 8
v_add_u32 v25, s64, v25
v_mul_u32_u24 v24, 768, v2
v_add_u32 v16, v25, v24
v_lshl_add_u32 v10, v2, 3, v25
v_add_u32 v10, 512, v10
s_waitcnt vmcnt(0)
s_waitcnt lgkmcnt(0)
v_mov_b32 v20, 153504
v_mov_b32 v21, 1
v_cmp_eq_u32 vcc, 0, v1
s_and_saveexec_b64 s[22:23], vcc
ds_add_rtn_u32 v22, v20, v21
s_mov_b64 exec, s[22:23]
s_waitcnt lgkmcnt(0)
v_readfirstlane_b32 s66, v22
s_cmp_lg_u32 s66, 3
s_cbranch_scc1 L_sig_kv
s_lshl_b32 s66, s57, 4
s_add_u32 s66, s66, s56
s_lshl_b32 s66, s66, 6
s_add_u32 s66, s66, 14811136
v_lshlrev_b32 v21, 2, v1
v_mov_b32 v20, 2146435072
v_cmp_gt_u32 vcc, 16, v1
s_nop 1
v_cndmask_b32 v20, v20, v21, vcc
v_mov_b32 v21, s63
buffer_store_dword v21, v20, s[52:55], s66 offen sc1
L_sig_kv:
v_mov_b32 v20, 153564
s_mov_b32 s22, 0
L_lw_83:
ds_read_b32 v21, v20
s_waitcnt lgkmcnt(0)
v_readfirstlane_b32 s64, v21
s_add_u32 s22, s22, 1
s_cmp_ge_u32 s64, 1
s_cbranch_scc1 L_lwok_83
s_cmp_lt_u32 s22, 4194304
s_cbranch_scc1 L_lw_83
L_lwok_83:
s_and_b32 s64, s2, 7
s_lshr_b32 s65, s2, 3
s_and_b32 s8, s64, 3
s_lshl_b32 s8, s8, 3
s_and_b32 s66, s65, 7
s_add_u32 s8, s8, s66
s_lshr_b32 s9, s64, 2
s_lshl_b32 s9, s9, 2
s_lshr_b32 s66, s65, 3
s_add_u32 s9, s9, s66
s_lshl_b32 s6, s58, 3
s_cmp_eq_u32 s58, 6
s_cselect_b32 s6, 47, s6
s_cmp_eq_u32 s58, 7
s_cselect_b32 s6, 54, s6
s_mov_b32 s7, 8
s_cmp_ge_u32 s58, 5
s_cselect_b32 s7, 7, s7
s_cmp_eq_u32 s58, 7
s_cselect_b32 s7, 6, s7
s_mul_i32 s10, s9, 60
s_add_u32 s10, s10, s6
s_mul_i32 s10, s10, 5120
s_add_u32 s10, s10, 8388608
v_lshlrev_b32 v18, 4, v1
s_cmp_gt_u32 s7, 6
s_cselect_b32 s64, 0, 2146435072
v_add_u32 v17, s64, v18
s_cmp_gt_u32 s7, 7
s_cselect_b32 s64, 0, 2146435072
v_add_u32 v19, s64, v18
ds_read_b64_tr_b16 v[108:109], v3 offset:2560
ds_read_b64_tr_b16 v[110:111], v3 offset:2720
ds_read_b64_tr_b16 v[112:113], v3 offset:2880
ds_read_b64_tr_b16 v[114:115], v3 offset:3040
ds_read_b64_tr_b16 v[116:117], v4 offset:2560
v_mov_b32 v118, 0
v_mov_b32 v119, 0
ds_read_b64_tr_b16 v[120:121], v5 offset:2560
ds_read_b64_tr_b16 v[122:123], v5 offset:2720
ds_read_b64_tr_b16 v[124:125], v5 offset:2880
s_add_u32 s39, s10, 20480
buffer_load_dwordx4 v[176:179], v18, s[52:55], s39 offen
ds_read_b64_tr_b16 v[126:127], v5 offset:3040
ds_read_b64_tr_b16 v[128:129], v6 offset:2560
v_mov_b32 v130, 0
v_mov_b32 v131, 0
v_cvt_pk_bf16_f32 v96, v32, v33
v_cvt_pk_bf16_f32 v97, v34, v35
v_cvt_pk_bf16_f32 v98, v36, v37
v_cvt_pk_bf16_f32 v99, v38, v39
v_cvt_pk_bf16_f32 v100, v40, v41
v_cvt_pk_bf16_f32 v101, v42, v43
s_add_u32 s39, s10, 21504
buffer_load_dwordx4 v[180:183], v18, s[52:55], s39 offen
v_cvt_pk_bf16_f32 v102, v44, v45
v_cvt_pk_bf16_f32 v103, v46, v47
v_cvt_pk_bf16_f32 v104, v48, v49
v_cvt_pk_bf16_f32 v105, v50, v51
v_mov_b32 v106, 0
v_mov_b32 v107, 0
s_waitcnt lgkmcnt(0)
v_mfma_f32_32x32x16_bf16 v[136:151], v[108:111], v[96:99], 0
v_mfma_f32_32x32x16_bf16 v[152:167], v[120:123], v[96:99], 0
v_mfma_f32_32x32x16_bf16 v[136:151], v[112:115], v[100:103], v[136:151]
s_add_u32 s39, s10, 22528
buffer_load_dwordx4 v[184:187], v18, s[52:55], s39 offen
v_mfma_f32_32x32x16_bf16 v[152:167], v[124:127], v[100:103], v[152:167]
v_mfma_f32_32x32x16_bf16 v[136:151], v[116:119], v[104:107], v[136:151]
v_mfma_f32_32x32x16_bf16 v[152:167], v[128:131], v[104:107], v[152:167]
s_nop 10
v_max3_f32 v20, v136, v137, v138
v_min3_f32 v21, v136, v137, v138
v_max3_f32 v20, v20, v139, v140
v_min3_f32 v21, v21, v139, v140
v_max3_f32 v20, v20, v141, v142
v_min3_f32 v21, v21, v141, v142
v_max3_f32 v20, v20, v143, v144
s_add_u32 s39, s10, 23552
buffer_load_dwordx4 v[188:191], v18, s[52:55], s39 offen
v_min3_f32 v21, v21, v143, v144
v_max3_f32 v20, v20, v145, v146
v_min3_f32 v21, v21, v145, v146
v_max3_f32 v20, v20, v147, v148
v_min3_f32 v21, v21, v147, v148
v_max3_f32 v20, v20, v149, v150
v_min3_f32 v21, v21, v149, v150
v_max3_f32 v20, v20, v151, v152
v_min3_f32 v21, v21, v151, v152
v_max3_f32 v20, v20, v153, v154
s_add_u32 s39, s10, 24576
buffer_load_dwordx4 v[192:195], v18, s[52:55], s39 offen
v_min3_f32 v21, v21, v153, v154
v_max_f32 v20, v20, v155
v_min_f32 v21, v21, v155
v_mul_f32 v22, s78, v20
v_mul_f32 v23, s76, v21
v_pk_fma_f32 v[96:97], v[136:137], s[76:77], v[22:23] op_sel_hi:[1,1,0]
v_pk_fma_f32 v[116:117], v[136:137], s[78:79], v[22:23] op_sel:[0,0,1] op_sel_hi:[1,1,1]
v_pk_fma_f32 v[98:99], v[138:139], s[76:77], v[22:23] op_sel_hi:[1,1,0]
v_pk_fma_f32 v[118:119], v[138:139], s[78:79], v[22:23] op_sel:[0,0,1] op_sel_hi:[1,1,1]
v_pk_fma_f32 v[100:101], v[140:141], s[76:77], v[22:23] op_sel_hi:[1,1,0]
s_add_u32 s39, s10, 25600
buffer_load_dwordx4 v[196:199], v18, s[52:55], s39 offen
v_pk_fma_f32 v[120:121], v[140:141], s[78:79], v[22:23] op_sel:[0,0,1] op_sel_hi:[1,1,1]
v_pk_fma_f32 v[102:103], v[142:143], s[76:77], v[22:23] op_sel_hi:[1,1,0]
v_pk_fma_f32 v[122:123], v[142:143], s[78:79], v[22:23] op_sel:[0,0,1] op_sel_hi:[1,1,1]
v_pk_fma_f32 v[104:105], v[144:145], s[76:77], v[22:23] op_sel_hi:[1,1,0]
v_pk_fma_f32 v[124:125], v[144:145], s[78:79], v[22:23] op_sel:[0,0,1] op_sel_hi:[1,1,1]
v_pk_fma_f32 v[106:107], v[146:147], s[76:77], v[22:23] op_sel_hi:[1,1,0]
v_pk_fma_f32 v[126:127], v[146:147], s[78:79], v[22:23] op_sel:[0,0,1] op_sel_hi:[1,1,1]
v_pk_fma_f32 v[108:109], v[148:149], s[76:77], v[22:23] op_sel_hi:[1,1,0]
v_pk_fma_f32 v[128:129], v[148:149], s[78:79], v[22:23] op_sel:[0,0,1] op_sel_hi:[1,1,1]
v_pk_fma_f32 v[110:111], v[150:151], s[76:77], v[22:23] op_sel_hi:[1,1,0]
s_add_u32 s39, s10, 26624
buffer_load_dwordx4 v[200:203], v18, s[52:55], s39 offen
v_pk_fma_f32 v[130:131], v[150:151], s[78:79], v[22:23] op_sel:[0,0,1] op_sel_hi:[1,1,1]
v_pk_fma_f32 v[112:113], v[152:153], s[76:77], v[22:23] op_sel_hi:[1,1,0]
v_pk_fma_f32 v[132:133], v[152:153], s[78:79], v[22:23] op_sel:[0,0,1] op_sel_hi:[1,1,1]
v_pk_fma_f32 v[114:115], v[154:155], s[76:77], v[22:23] op_sel_hi:[1,1,0]
v_pk_fma_f32 v[134:135], v[154:155], s[78:79], v[22:23] op_sel:[0,0,1] op_sel_hi:[1,1,1]
v_exp_f32 v96, v96
v_exp_f32 v116, v116
v_exp_f32 v97, v97
v_exp_f32 v117, v117
v_exp_f32 v98, v98
s_add_u32 s39, s10, 27648
buffer_load_dwordx4 v[204:207], v18, s[52:55], s39 offen
v_exp_f32 v118, v118
v_exp_f32 v99, v99
v_exp_f32 v119, v119
v_exp_f32 v100, v100
v_exp_f32 v120, v120
v_exp_f32 v101, v101
v_exp_f32 v121, v121
v_exp_f32 v102, v102
v_exp_f32 v122, v122
v_exp_f32 v103, v103
s_add_u32 s39, s10, 28672
buffer_load_dwordx4 v[208:211], v18, s[52:55], s39 offen
v_exp_f32 v123, v123
v_exp_f32 v104, v104
v_exp_f32 v124, v124
v_exp_f32 v105, v105
v_exp_f32 v125, v125
v_exp_f32 v106, v106
v_exp_f32 v126, v126
v_exp_f32 v107, v107
v_exp_f32 v127, v127
v_exp_f32 v108, v108
s_add_u32 s39, s10, 29696
buffer_load_dwordx4 v[212:215], v18, s[52:55], s39 offen
v_exp_f32 v128, v128
v_exp_f32 v109, v109
v_exp_f32 v129, v129
v_exp_f32 v110, v110
v_exp_f32 v130, v130
v_exp_f32 v111, v111
v_exp_f32 v131, v131
v_exp_f32 v112, v112
v_exp_f32 v132, v132
v_exp_f32 v113, v113
s_add_u32 s39, s10, 30720
buffer_load_dwordx4 v[216:219], v17, s[52:55], s39 offen
v_exp_f32 v133, v133
v_exp_f32 v114, v114
v_exp_f32 v134, v134
v_exp_f32 v115, v115
v_exp_f32 v135, v135
v_pk_add_f32 v[24:25], v[96:97], v[98:99]
v_pk_add_f32 v[26:27], v[116:117], v[118:119]
v_pk_add_f32 v[24:25], v[24:25], v[100:101]
v_pk_add_f32 v[26:27], v[26:27], v[120:121]
v_pk_add_f32 v[24:25], v[24:25], v[102:103]
s_add_u32 s39, s10, 31744
buffer_load_dwordx4 v[220:223], v17, s[52:55], s39 offen
v_pk_add_f32 v[26:27], v[26:27], v[122:123]
v_pk_add_f32 v[24:25], v[24:25], v[104:105]
v_pk_add_f32 v[26:27], v[26:27], v[124:125]
v_pk_add_f32 v[24:25], v[24:25], v[106:107]
v_pk_add_f32 v[26:27], v[26:27], v[126:127]
v_pk_add_f32 v[24:25], v[24:25], v[108:109]
v_pk_add_f32 v[26:27], v[26:27], v[128:129]
v_pk_add_f32 v[24:25], v[24:25], v[110:111]
v_pk_add_f32 v[26:27], v[26:27], v[130:131]
v_pk_add_f32 v[24:25], v[24:25], v[112:113]
s_add_u32 s39, s10, 32768
buffer_load_dwordx4 v[224:227], v17, s[52:55], s39 offen
v_pk_add_f32 v[26:27], v[26:27], v[132:133]
v_pk_add_f32 v[24:25], v[24:25], v[114:115]
v_pk_add_f32 v[26:27], v[26:27], v[134:135]
v_add_f32 v24, v24, v25
v_add_f32 v26, v26, v27
v_rcp_f32 v24, v24
v_rcp_f32 v25, v26
s_nop 0
v_pk_mul_f32 v[96:97], v[96:97], v[24:25] op_sel_hi:[1,0]
v_pk_mul_f32 v[116:117], v[116:117], v[24:25] op_sel:[0,1] op_sel_hi:[1,1]
v_pk_mul_f32 v[98:99], v[98:99], v[24:25] op_sel_hi:[1,0]
s_add_u32 s39, s10, 33792
buffer_load_dwordx4 v[228:231], v17, s[52:55], s39 offen
v_pk_mul_f32 v[118:119], v[118:119], v[24:25] op_sel:[0,1] op_sel_hi:[1,1]
v_pk_mul_f32 v[100:101], v[100:101], v[24:25] op_sel_hi:[1,0]
v_pk_mul_f32 v[120:121], v[120:121], v[24:25] op_sel:[0,1] op_sel_hi:[1,1]
v_pk_mul_f32 v[102:103], v[102:103], v[24:25] op_sel_hi:[1,0]
v_pk_mul_f32 v[122:123], v[122:123], v[24:25] op_sel:[0,1] op_sel_hi:[1,1]
v_pk_mul_f32 v[104:105], v[104:105], v[24:25] op_sel_hi:[1,0]
v_pk_mul_f32 v[124:125], v[124:125], v[24:25] op_sel:[0,1] op_sel_hi:[1,1]
v_pk_mul_f32 v[106:107], v[106:107], v[24:25] op_sel_hi:[1,0]
v_pk_mul_f32 v[126:127], v[126:127], v[24:25] op_sel:[0,1] op_sel_hi:[1,1]
v_pk_mul_f32 v[108:109], v[108:109], v[24:25] op_sel_hi:[1,0]
s_add_u32 s39, s10, 34816
buffer_load_dwordx4 v[232:235], v17, s[52:55], s39 offen
v_pk_mul_f32 v[128:129], v[128:129], v[24:25] op_sel:[0,1] op_sel_hi:[1,1]
v_pk_mul_f32 v[110:111], v[110:111], v[24:25] op_sel_hi:[1,0]
v_pk_mul_f32 v[130:131], v[130:131], v[24:25] op_sel:[0,1] op_sel_hi:[1,1]
v_pk_mul_f32 v[112:113], v[112:113], v[24:25] op_sel_hi:[1,0]
v_pk_mul_f32 v[132:133], v[132:133], v[24:25] op_sel:[0,1] op_sel_hi:[1,1]
v_pk_mul_f32 v[114:115], v[114:115], v[24:25] op_sel_hi:[1,0]
v_pk_mul_f32 v[134:135], v[134:135], v[24:25] op_sel:[0,1] op_sel_hi:[1,1]
v_cvt_pk_bf16_f32 v136, v96, v97
v_cvt_pk_bf16_f32 v146, v116, v117
v_cvt_pk_bf16_f32 v137, v98, v99
s_add_u32 s39, s10, 35840
buffer_load_dwordx4 v[236:239], v19, s[52:55], s39 offen
v_cvt_pk_bf16_f32 v147, v118, v119
v_cvt_pk_bf16_f32 v138, v100, v101
v_cvt_pk_bf16_f32 v148, v120, v121
v_cvt_pk_bf16_f32 v139, v102, v103
v_cvt_pk_bf16_f32 v149, v122, v123
v_cvt_pk_bf16_f32 v140, v104, v105
v_cvt_pk_bf16_f32 v150, v124, v125
v_cvt_pk_bf16_f32 v141, v106, v107
v_cvt_pk_bf16_f32 v151, v126, v127
v_cvt_pk_bf16_f32 v142, v108, v109
s_add_u32 s39, s10, 36864
buffer_load_dwordx4 v[240:243], v19, s[52:55], s39 offen
v_cvt_pk_bf16_f32 v152, v128, v129
v_cvt_pk_bf16_f32 v143, v110, v111
v_cvt_pk_bf16_f32 v153, v130, v131
v_cvt_pk_bf16_f32 v144, v112, v113
v_cvt_pk_bf16_f32 v154, v132, v133
v_cvt_pk_bf16_f32 v145, v114, v115
v_cvt_pk_bf16_f32 v155, v134, v135
s_add_u32 s39, s10, 37888
buffer_load_dwordx4 v[244:247], v19, s[52:55], s39 offen
s_add_u32 s39, s10, 38912
buffer_load_dwordx4 v[248:251], v19, s[52:55], s39 offen
s_add_u32 s39, s10, 39936
buffer_load_dwordx4 v[252:255], v19, s[52:55], s39 offen
s_xor_b32 s38, s57, 1
s_cmp_lg_u32 s59, 1
s_cbranch_scc1 L_noty1
s_lshl_b32 s66, s38, 10
s_add_u32 s66, s66, 14811136
v_and_b32 v26, 15, v1
v_lshlrev_b32 v26, 2, v26
s_mov_b32 s22, 0
L_spoll_kv:
s_mov_b32 s64, 0
s_add_u32 s65, s66, 0
s_load_dword s40, s[36:37], s65 glc
s_add_u32 s65, s66, 64
s_load_dword s41, s[36:37], s65 glc
s_add_u32 s65, s66, 128
s_load_dword s42, s[36:37], s65 glc
s_add_u32 s65, s66, 192
s_load_dword s43, s[36:37], s65 glc
s_add_u32 s65, s66, 256
s_load_dword s44, s[36:37], s65 glc
s_add_u32 s65, s66, 320
s_load_dword s45, s[36:37], s65 glc
s_add_u32 s65, s66, 384
s_load_dword s46, s[36:37], s65 glc
s_add_u32 s65, s66, 448
s_load_dword s47, s[36:37], s65 glc
s_add_u32 s65, s66, 512
s_load_dword s68, s[36:37], s65 glc
s_add_u32 s65, s66, 576
s_load_dword s69, s[36:37], s65 glc
s_add_u32 s65, s66, 640
s_load_dword s70, s[36:37], s65 glc
s_add_u32 s65, s66, 704
s_load_dword s71, s[36:37], s65 glc
s_add_u32 s65, s66, 768
s_load_dword s72, s[36:37], s65 glc
s_add_u32 s65, s66, 832
s_load_dword s73, s[36:37], s65 glc
s_add_u32 s65, s66, 896
s_load_dword s74, s[36:37], s65 glc
s_add_u32 s65, s66, 960
s_load_dword s75, s[36:37], s65 glc
s_waitcnt lgkmcnt(0)
s_xor_b32 s40, s40, s63
s_or_b32 s64, s64, s40
s_xor_b32 s41, s41, s63
s_or_b32 s64, s64, s41
s_xor_b32 s42, s42, s63
s_or_b32 s64, s64, s42
s_xor_b32 s43, s43, s63
s_or_b32 s64, s64, s43
s_xor_b32 s44, s44, s63
s_or_b32 s64, s64, s44
s_xor_b32 s45, s45, s63
s_or_b32 s64, s64, s45
s_xor_b32 s46, s46, s63
s_or_b32 s64, s64, s46
s_xor_b32 s47, s47, s63
s_or_b32 s64, s64, s47
s_xor_b32 s68, s68, s63
s_or_b32 s64, s64, s68
s_xor_b32 s69, s69, s63
s_or_b32 s64, s64, s69
s_xor_b32 s70, s70, s63
s_or_b32 s64, s64, s70
s_xor_b32 s71, s71, s63
s_or_b32 s64, s64, s71
s_xor_b32 s72, s72, s63
s_or_b32 s64, s64, s72
s_xor_b32 s73, s73, s63
s_or_b32 s64, s64, s73
s_xor_b32 s74, s74, s63
s_or_b32 s64, s64, s74
s_xor_b32 s75, s75, s63
s_or_b32 s64, s64, s75
s_add_u32 s22, s22, 1
s_cmp_eq_u32 s64, 0
s_cbranch_scc1 L_spollok_kv
s_cmp_lt_u32 s22, 262144
s_cbranch_scc1 L_spoll_kv
L_spollok_kv:
v_mov_b32 v20, 153512
v_mov_b32 v21, 1
s_waitcnt lgkmcnt(0)
ds_write_b32 v20, v21
L_noty1:
v_mov_b32 v20, 153512
s_mov_b32 s22, 0
L_lw_84:
ds_read_b32 v21, v20
s_waitcnt lgkmcnt(0)
v_readfirstlane_b32 s64, v21
s_add_u32 s22, s22, 1
s_cmp_ge_u32 s64, 1
s_cbranch_scc1 L_lwok_84
s_cmp_lt_u32 s22, 4194304
s_cbranch_scc1 L_lw_84
L_lwok_84:
v_mov_b32 v20, 153516
s_mov_b32 s22, 0
L_lw_85:
ds_read_b32 v21, v20
s_waitcnt lgkmcnt(0)
v_readfirstlane_b32 s64, v21
s_add_u32 s22, s22, 1
s_cmp_ge_u32 s64, 4
s_cbranch_scc1 L_lwok_85
s_cmp_lt_u32 s22, 4194304
s_cbranch_scc1 L_lw_85
L_lwok_85:
s_lshl_b32 s64, s59, 6
v_add_u32 v22, s64, v1
v_lshlrev_b32 v27, 4, v22
v_mov_b32 v24, 2146435072
v_cmp_gt_u32 vcc, 210, v22
s_nop 1
v_cndmask_b32 v23, v24, v27, vcc
s_lshl_b32 s66, s38, 16
s_add_u32 s66, s66, 12582912
buffer_load_dwordx4 v[32:35], v23, s[52:55], s66 offen
s_add_u32 s66, s66, 4096
buffer_load_dwordx4 v[36:39], v23, s[52:55], s66 offen
s_add_u32 s66, s66, 4096
buffer_load_dwordx4 v[40:43], v23, s[52:55], s66 offen
s_add_u32 s66, s66, 4096
buffer_load_dwordx4 v[44:47], v23, s[52:55], s66 offen
s_add_u32 s66, s66, 4096
buffer_load_dwordx4 v[48:51], v23, s[52:55], s66 offen
s_add_u32 s66, s66, 4096
buffer_load_dwordx4 v[52:55], v23, s[52:55], s66 offen
s_add_u32 s66, s66, 4096
buffer_load_dwordx4 v[56:59], v23, s[52:55], s66 offen
s_add_u32 s66, s66, 4096
buffer_load_dwordx4 v[60:63], v23, s[52:55], s66 offen
s_add_u32 s66, s66, 4096
s_mov_b32 s64, 0x3f80
s_mov_b32 s65, 0x3f800000
v_mov_b32 v96, 0
v_mov_b32 v97, 0
v_mov_b32 v98, 0
v_mov_b32 v99, 0
v_mov_b32 v100, 0
v_mov_b32 v101, 0
v_mov_b32 v102, 0
v_mov_b32 v103, 0
s_waitcnt vmcnt(7)
buffer_load_dwordx4 v[64:67], v23, s[52:55], s66 offen
s_add_u32 s66, s66, 4096
v_dot2_f32_bf16 v96, v32, s64, v96
v_dot2_f32_bf16 v97, v32, s65, v97
v_dot2_f32_bf16 v98, v33, s64, v98
v_dot2_f32_bf16 v99, v33, s65, v99
v_dot2_f32_bf16 v100, v34, s64, v100
v_dot2_f32_bf16 v101, v34, s65, v101
v_dot2_f32_bf16 v102, v35, s64, v102
v_dot2_f32_bf16 v103, v35, s65, v103
s_waitcnt vmcnt(7)
buffer_load_dwordx4 v[68:71], v23, s[52:55], s66 offen
s_add_u32 s66, s66, 4096
v_dot2_f32_bf16 v96, v36, s64, v96
v_dot2_f32_bf16 v97, v36, s65, v97
v_dot2_f32_bf16 v98, v37, s64, v98
v_dot2_f32_bf16 v99, v37, s65, v99
v_dot2_f32_bf16 v100, v38, s64, v100
v_dot2_f32_bf16 v101, v38, s65, v101
v_dot2_f32_bf16 v102, v39, s64, v102
v_dot2_f32_bf16 v103, v39, s65, v103
s_waitcnt vmcnt(7)
buffer_load_dwordx4 v[72:75], v23, s[52:55], s66 offen
s_add_u32 s66, s66, 4096
v_dot2_f32_bf16 v96, v40, s64, v96
v_dot2_f32_bf16 v97, v40, s65, v97
v_dot2_f32_bf16 v98, v41, s64, v98
v_dot2_f32_bf16 v99, v41, s65, v99
v_dot2_f32_bf16 v100, v42, s64, v100
v_dot2_f32_bf16 v101, v42, s65, v101
v_dot2_f32_bf16 v102, v43, s64, v102
v_dot2_f32_bf16 v103, v43, s65, v103
s_waitcnt vmcnt(7)
buffer_load_dwordx4 v[76:79], v23, s[52:55], s66 offen
s_add_u32 s66, s66, 4096
v_dot2_f32_bf16 v96, v44, s64, v96
v_dot2_f32_bf16 v97, v44, s65, v97
v_dot2_f32_bf16 v98, v45, s64, v98
v_dot2_f32_bf16 v99, v45, s65, v99
v_dot2_f32_bf16 v100, v46, s64, v100
v_dot2_f32_bf16 v101, v46, s65, v101
v_dot2_f32_bf16 v102, v47, s64, v102
v_dot2_f32_bf16 v103, v47, s65, v103
s_waitcnt vmcnt(7)
buffer_load_dwordx4 v[80:83], v23, s[52:55], s66 offen
s_add_u32 s66, s66, 4096
v_dot2_f32_bf16 v96, v48, s64, v96
v_dot2_f32_bf16 v97, v48, s65, v97
v_dot2_f32_bf16 v98, v49, s64, v98
v_dot2_f32_bf16 v99, v49, s65, v99
v_dot2_f32_bf16 v100, v50, s64, v100
v_dot2_f32_bf16 v101, v50, s65, v101
v_dot2_f32_bf16 v102, v51, s64, v102
v_dot2_f32_bf16 v103, v51, s65, v103
s_waitcnt vmcnt(7)
buffer_load_dwordx4 v[84:87], v23, s[52:55], s66 offen
s_add_u32 s66, s66, 4096
v_dot2_f32_bf16 v96, v52, s64, v96
v_dot2_f32_bf16 v97, v52, s65, v97
v_dot2_f32_bf16 v98, v53, s64, v98
v_dot2_f32_bf16 v99, v53, s65, v99
v_dot2_f32_bf16 v100, v54, s64, v100
v_dot2_f32_bf16 v101, v54, s65, v101
v_dot2_f32_bf16 v102, v55, s64, v102
v_dot2_f32_bf16 v103, v55, s65, v103
s_waitcnt vmcnt(7)
buffer_load_dwordx4 v[88:91], v23, s[52:55], s66 offen
s_add_u32 s66, s66, 4096
v_dot2_f32_bf16 v96, v56, s64, v96
v_dot2_f32_bf16 v97, v56, s65, v97
v_dot2_f32_bf16 v98, v57, s64, v98
v_dot2_f32_bf16 v99, v57, s65, v99
v_dot2_f32_bf16 v100, v58, s64, v100
v_dot2_f32_bf16 v101, v58, s65, v101
v_dot2_f32_bf16 v102, v59, s64, v102
v_dot2_f32_bf16 v103, v59, s65, v103
s_waitcnt vmcnt(7)
buffer_load_dwordx4 v[92:95], v23, s[52:55], s66 offen
v_dot2_f32_bf16 v96, v60, s64, v96
v_dot2_f32_bf16 v97, v60, s65, v97
v_dot2_f32_bf16 v98, v61, s64, v98
v_dot2_f32_bf16 v99, v61, s65, v99
v_dot2_f32_bf16 v100, v62, s64, v100
v_dot2_f32_bf16 v101, v62, s65, v101
v_dot2_f32_bf16 v102, v63, s64, v102
v_dot2_f32_bf16 v103, v63, s65, v103
s_waitcnt vmcnt(7)
v_dot2_f32_bf16 v96, v64, s64, v96
v_dot2_f32_bf16 v97, v64, s65, v97
v_dot2_f32_bf16 v98, v65, s64, v98
v_dot2_f32_bf16 v99, v65, s65, v99
v_dot2_f32_bf16 v100, v66, s64, v100
v_dot2_f32_bf16 v101, v66, s65, v101
v_dot2_f32_bf16 v102, v67, s64, v102
v_dot2_f32_bf16 v103, v67, s65, v103
s_waitcnt vmcnt(6)
v_dot2_f32_bf16 v96, v68, s64, v96
v_dot2_f32_bf16 v97, v68, s65, v97
v_dot2_f32_bf16 v98, v69, s64, v98
v_dot2_f32_bf16 v99, v69, s65, v99
v_dot2_f32_bf16 v100, v70, s64, v100
v_dot2_f32_bf16 v101, v70, s65, v101
v_dot2_f32_bf16 v102, v71, s64, v102
v_dot2_f32_bf16 v103, v71, s65, v103
s_waitcnt vmcnt(5)
v_dot2_f32_bf16 v96, v72, s64, v96
v_dot2_f32_bf16 v97, v72, s65, v97
v_dot2_f32_bf16 v98, v73, s64, v98
v_dot2_f32_bf16 v99, v73, s65, v99
v_dot2_f32_bf16 v100, v74, s64, v100
v_dot2_f32_bf16 v101, v74, s65, v101
v_dot2_f32_bf16 v102, v75, s64, v102
v_dot2_f32_bf16 v103, v75, s65, v103
s_waitcnt vmcnt(4)
v_dot2_f32_bf16 v96, v76, s64, v96
v_dot2_f32_bf16 v97, v76, s65, v97
v_dot2_f32_bf16 v98, v77, s64, v98
v_dot2_f32_bf16 v99, v77, s65, v99
v_dot2_f32_bf16 v100, v78, s64, v100
v_dot2_f32_bf16 v101, v78, s65, v101
v_dot2_f32_bf16 v102, v79, s64, v102
v_dot2_f32_bf16 v103, v79, s65, v103
s_waitcnt vmcnt(3)
v_dot2_f32_bf16 v96, v80, s64, v96
v_dot2_f32_bf16 v97, v80, s65, v97
v_dot2_f32_bf16 v98, v81, s64, v98
v_dot2_f32_bf16 v99, v81, s65, v99
v_dot2_f32_bf16 v100, v82, s64, v100
v_dot2_f32_bf16 v101, v82, s65, v101
v_dot2_f32_bf16 v102, v83, s64, v102
v_dot2_f32_bf16 v103, v83, s65, v103
s_waitcnt vmcnt(2)
v_dot2_f32_bf16 v96, v84, s64, v96
v_dot2_f32_bf16 v97, v84, s65, v97
v_dot2_f32_bf16 v98, v85, s64, v98
v_dot2_f32_bf16 v99, v85, s65, v99
v_dot2_f32_bf16 v100, v86, s64, v100
v_dot2_f32_bf16 v101, v86, s65, v101
v_dot2_f32_bf16 v102, v87, s64, v102
v_dot2_f32_bf16 v103, v87, s65, v103
s_waitcnt vmcnt(1)
v_dot2_f32_bf16 v96, v88, s64, v96
v_dot2_f32_bf16 v97, v88, s65, v97
v_dot2_f32_bf16 v98, v89, s64, v98
v_dot2_f32_bf16 v99, v89, s65, v99
v_dot2_f32_bf16 v100, v90, s64, v100
v_dot2_f32_bf16 v101, v90, s65, v101
v_dot2_f32_bf16 v102, v91, s64, v102
v_dot2_f32_bf16 v103, v91, s65, v103
s_waitcnt vmcnt(0)
v_dot2_f32_bf16 v96, v92, s64, v96
v_dot2_f32_bf16 v97, v92, s65, v97
v_dot2_f32_bf16 v98, v93, s64, v98
v_dot2_f32_bf16 v99, v93, s65, v99
v_dot2_f32_bf16 v100, v94, s64, v100
v_dot2_f32_bf16 v101, v94, s65, v101
v_dot2_f32_bf16 v102, v95, s64, v102
v_dot2_f32_bf16 v103, v95, s65, v103
v_cvt_pk_bf16_f32 v104, v96, v97
v_cvt_pk_bf16_f32 v105, v98, v99
v_cvt_pk_bf16_f32 v106, v100, v101
v_cvt_pk_bf16_f32 v107, v102, v103
v_add_u32 v27, 150080, v27
v_min_u32 v27, 153440, v27
ds_write_b128 v27, v[104:107]
s_waitcnt lgkmcnt(0)
v_mov_b32 v20, 153524
v_mov_b32 v21, 1
v_cmp_eq_u32 vcc, 0, v1
s_and_saveexec_b64 s[22:23], vcc
ds_add_rtn_u32 v22, v20, v21
s_mov_b64 exec, s[22:23]
s_waitcnt lgkmcnt(0)
v_readfirstlane_b32 s66, v22
v_mov_b32 v20, 153524
s_mov_b32 s22, 0
L_lw_86:
ds_read_b32 v21, v20
s_waitcnt lgkmcnt(0)
v_readfirstlane_b32 s64, v21
s_add_u32 s22, s22, 1
s_cmp_ge_u32 s64, 4
s_cbranch_scc1 L_lwok_86
s_cmp_lt_u32 s22, 4194304
s_cbranch_scc1 L_lw_86
L_lwok_86:
ds_read_b128 v[96:99], v14 offset:0
ds_read_b128 v[116:119], v15 offset:0
ds_read_b128 v[100:103], v14 offset:16
ds_read_b128 v[120:123], v15 offset:16
ds_read_b128 v[104:107], v14 offset:32
ds_read_b128 v[124:127], v15 offset:32
ds_read_b128 v[108:111], v14 offset:48
ds_read_b128 v[128:131], v15 offset:48
ds_read_b128 v[112:115], v14 offset:64
ds_read_b128 v[132:135], v15 offset:64
s_waitcnt lgkmcnt(0)
v_mfma_f32_32x32x16_bf16 v[64:79], v[96:99], v[136:139], 0
v_mfma_f32_32x32x16_bf16 v[80:95], v[116:119], v[136:139], 0
v_mfma_f32_32x32x16_bf16 v[64:79], v[100:103], v[140:143], v[64:79]
v_mfma_f32_32x32x16_bf16 v[80:95], v[120:123], v[140:143], v[80:95]
v_mfma_f32_32x32x16_bf16 v[64:79], v[104:107], v[144:147], v[64:79]
v_mfma_f32_32x32x16_bf16 v[80:95], v[124:127], v[144:147], v[80:95]
v_mfma_f32_32x32x16_bf16 v[64:79], v[108:111], v[148:151], v[64:79]
v_mfma_f32_32x32x16_bf16 v[80:95], v[128:131], v[148:151], v[80:95]
v_mfma_f32_32x32x16_bf16 v[64:79], v[112:115], v[152:155], v[64:79]
v_mfma_f32_32x32x16_bf16 v[80:95], v[132:135], v[152:155], v[80:95]
s_nop 11
v_add_f32 v22, 0x358637bd, v84
v_rcp_f32 v22, v22
s_nop 0
v_pk_mul_f32 v[64:65], v[64:65], v[22:23] op_sel_hi:[1,0]
v_pk_mul_f32 v[66:67], v[66:67], v[22:23] op_sel_hi:[1,0]
v_pk_mul_f32 v[68:69], v[68:69], v[22:23] op_sel_hi:[1,0]
v_pk_mul_f32 v[70:71], v[70:71], v[22:23] op_sel_hi:[1,0]
v_pk_mul_f32 v[72:73], v[72:73], v[22:23] op_sel_hi:[1,0]
v_pk_mul_f32 v[74:75], v[74:75], v[22:23] op_sel_hi:[1,0]
v_pk_mul_f32 v[76:77], v[76:77], v[22:23] op_sel_hi:[1,0]
v_pk_mul_f32 v[78:79], v[78:79], v[22:23] op_sel_hi:[1,0]
v_pk_mul_f32 v[80:81], v[80:81], v[22:23] op_sel_hi:[1,0]
v_pk_mul_f32 v[82:83], v[82:83], v[22:23] op_sel_hi:[1,0]
v_cvt_pk_bf16_f32 v32, v64, v65
v_cvt_pk_bf16_f32 v33, v66, v67
v_cvt_pk_bf16_f32 v34, v68, v69
v_cvt_pk_bf16_f32 v35, v70, v71
v_cvt_pk_bf16_f32 v36, v72, v73
v_cvt_pk_bf16_f32 v37, v74, v75
v_cvt_pk_bf16_f32 v38, v76, v77
v_cvt_pk_bf16_f32 v39, v78, v79
v_cvt_pk_bf16_f32 v40, v80, v81
v_cvt_pk_bf16_f32 v41, v82, v83
v_cmp_eq_u32 vcc, 1, v2
s_nop 1
v_cndmask_b32 v44, v32, v34, vcc
v_cndmask_b32 v48, v36, v38, vcc
v_cndmask_b32 v45, v33, v35, vcc
v_cndmask_b32 v49, v37, v39, vcc
v_cndmask_b32 v46, v34, v36, vcc
v_cndmask_b32 v50, v38, v40, vcc
v_cndmask_b32 v47, v35, v37, vcc
v_cndmask_b32 v51, v39, v41, vcc
v_cndmask_b32 v52, v40, v32, vcc
v_cndmask_b32 v53, v41, v33, vcc
buffer_store_dwordx4 v[44:47], v16, s[52:55], 0 offen sc1
buffer_store_dwordx4 v[48:51], v16, s[52:55], 0 offen offset:256 sc1
buffer_store_dwordx2 v[52:53], v10, s[52:55], 0 offen sc1
s_waitcnt vmcnt(0)
s_waitcnt lgkmcnt(0)
v_mov_b32 v20, 153540
v_mov_b32 v21, 1
v_cmp_eq_u32 vcc, 0, v1
s_and_saveexec_b64 s[22:23], vcc
ds_add_rtn_u32 v22, v20, v21
s_mov_b64 exec, s[22:23]
s_waitcnt lgkmcnt(0)
v_readfirstlane_b32 s66, v22
s_cmp_lg_u32 s66, 3
s_cbranch_scc1 L_sig_b
s_lshl_b32 s66, s56, 4
s_add_u32 s66, s66, s57
s_lshl_b32 s66, s66, 6
s_add_u32 s66, s66, 14942208
v_lshlrev_b32 v21, 2, v1
v_mov_b32 v20, 2146435072
v_cmp_gt_u32 vcc, 16, v1
s_nop 1
v_cndmask_b32 v20, v20, v21, vcc
v_mov_b32 v21, s63
buffer_store_dword v21, v20, s[52:55], s66 offen sc1
L_sig_b:
v_lshlrev_b32 v3, 4, v1
s_cmp_gt_u32 s7, 6
s_cselect_b32 s64, 0, 2146435072
v_add_u32 v4, s64, v3
s_cmp_gt_u32 s7, 7
s_cselect_b32 s64, 0, 2146435072
v_add_u32 v5, s64, v3
v_and_b32 v6, 15, v1
s_lshl_b32 s64, s8, 6
v_add_u32 v6, s64, v6
s_add_u32 s39, s10, 10240
buffer_load_dwordx4 v[136:139], v3, s[52:55], s39 offen
s_add_u32 s39, s10, 11264
buffer_load_dwordx4 v[140:143], v3, s[52:55], s39 offen
s_add_u32 s39, s10, 12288
buffer_load_dwordx4 v[144:147], v3, s[52:55], s39 offen
s_add_u32 s39, s10, 13312
buffer_load_dwordx4 v[148:151], v3, s[52:55], s39 offen
s_add_u32 s39, s10, 14336
buffer_load_dwordx4 v[152:155], v3, s[52:55], s39 offen
s_add_u32 s39, s10, 15360
buffer_load_dwordx4 v[156:159], v3, s[52:55], s39 offen
s_add_u32 s39, s10, 16384
buffer_load_dwordx4 v[160:163], v3, s[52:55], s39 offen
s_add_u32 s39, s10, 17408
buffer_load_dwordx4 v[164:167], v3, s[52:55], s39 offen
s_add_u32 s39, s10, 18432
buffer_load_dwordx4 v[168:171], v3, s[52:55], s39 offen
s_add_u32 s39, s10, 19456
buffer_load_dwordx4 v[172:175], v3, s[52:55], s39 offen
s_add_u32 s39, s10, 0
buffer_load_dwordx4 v[96:99], v3, s[52:55], s39 offen
s_add_u32 s39, s10, 1024
buffer_load_dwordx4 v[100:103], v3, s[52:55], s39 offen
s_add_u32 s39, s10, 2048
buffer_load_dwordx4 v[104:107], v3, s[52:55], s39 offen
s_add_u32 s39, s10, 3072
buffer_load_dwordx4 v[108:111], v3, s[52:55], s39 offen
s_add_u32 s39, s10, 4096
buffer_load_dwordx4 v[112:115], v3, s[52:55], s39 offen
s_add_u32 s39, s10, 5120
buffer_load_dwordx4 v[116:119], v3, s[52:55], s39 offen
s_add_u32 s39, s10, 6144
buffer_load_dwordx4 v[120:123], v3, s[52:55], s39 offen
s_add_u32 s39, s10, 7168
buffer_load_dwordx4 v[124:127], v3, s[52:55], s39 offen
s_add_u32 s39, s10, 8192
buffer_load_dwordx4 v[128:131], v3, s[52:55], s39 offen
s_add_u32 s39, s10, 9216
buffer_load_dwordx4 v[132:135], v3, s[52:55], s39 offen
v_mov_b32 v20, 153544
s_mov_b32 s22, 0
L_lw_87:
ds_read_b32 v21, v20
s_waitcnt lgkmcnt(0)
v_readfirstlane_b32 s64, v21
s_add_u32 s22, s22, 1
s_cmp_ge_u32 s64, 1
s_cbranch_scc1 L_lwok_87
s_cmp_lt_u32 s22, 4194304
s_cbranch_scc1 L_lw_87
L_lwok_87:
s_lshl_b32 s38, s8, 2
s_mul_i32 s38, s38, 60
s_add_u32 s38, s38, s6
s_lshl_b32 s38, s38, 10
v_lshlrev_b32 v20, 2, v6
s_add_u32 s39, s59, 1
s_and_b32 s39, s39, 3
s_mul_i32 s12, s39, 61440
s_add_u32 s12, s12, s38
s_lshl_b32 s39, s39, 6
s_add_u32 s39, s39, 14680064
buffer_load_dword v8, v20, s[52:55], s39 offen
s_add_u32 s39, s59, 2
s_and_b32 s39, s39, 3
s_mul_i32 s13, s39, 61440
s_add_u32 s13, s13, s38
s_lshl_b32 s39, s39, 6
s_add_u32 s39, s39, 14680064
buffer_load_dword v9, v20, s[52:55], s39 offen
s_add_u32 s39, s59, 3
s_and_b32 s39, s39, 3
s_mul_i32 s14, s39, 61440
s_add_u32 s14, s14, s38
s_lshl_b32 s39, s39, 6
s_add_u32 s39, s39, 14680064
buffer_load_dword v10, v20, s[52:55], s39 offen
s_add_u32 s39, s59, 4
s_and_b32 s39, s39, 3
s_mul_i32 s15, s39, 61440
s_add_u32 s15, s15, s38
s_lshl_b32 s39, s39, 6
s_add_u32 s39, s39, 14680064
buffer_load_dword v11, v20, s[52:55], s39 offen
v_mov_b32 v0, 1
s_cmp_lg_u32 s59, 0
s_cbranch_scc1 L_y_b
s_mov_b32 s72, s4
s_and_b32 s73, s5, 0xffff
s_mov_b32 s74, 2621440
s_mov_b32 s75, 0x20000
s_mov_b32 s40, s20
s_and_b32 s41, s21, 0xffff
s_mov_b32 s42, 1280
s_mov_b32 s43, 0x20000
s_mov_b32 s48, s32
s_and_b32 s49, s33, 0xffff
s_mov_b32 s50, 5242880
s_mov_b32 s51, 0x20000
v_mov_b32 v20, 153532
s_mov_b32 s22, 0
L_lw_88:
ds_read_b32 v21, v20
s_waitcnt lgkmcnt(0)
v_readfirstlane_b32 s64, v21
s_add_u32 s22, s22, 1
s_cmp_ge_u32 s64, 4
s_cbranch_scc1 L_lwok_88
s_cmp_lt_u32 s22, 4194304
s_cbranch_scc1 L_lw_88
L_lwok_88:
s_waitcnt vmcnt(0)
v_mul_f32 v8, 0xbfb8aa3b, v8
v_exp_f32 v8, v8
s_nop 0
v_add_f32 v8, 1.0, v8
v_rcp_f32 v8, v8
v_mul_f32 v9, 0xbfb8aa3b, v9
v_exp_f32 v9, v9
s_nop 0
v_add_f32 v9, 1.0, v9
v_rcp_f32 v9, v9
v_mul_f32 v10, 0xbfb8aa3b, v10
v_exp_f32 v10, v10
s_nop 0
v_add_f32 v10, 1.0, v10
v_rcp_f32 v10, v10
v_mul_f32 v11, 0xbfb8aa3b, v11
v_exp_f32 v11, v11
s_nop 0
v_add_f32 v11, 1.0, v11
v_rcp_f32 v11, v11
s_nop 0
v_mov_b32 v2, v11
s_add_u32 s64, s12, 0
buffer_load_dwordx4 v[72:75], v3, s[52:55], s64 offen
s_add_u32 s64, s12, 1024
buffer_load_dwordx4 v[76:79], v3, s[52:55], s64 offen
s_add_u32 s64, s12, 2048
buffer_load_dwordx4 v[80:83], v3, s[52:55], s64 offen
s_add_u32 s64, s12, 3072
buffer_load_dwordx4 v[84:87], v3, s[52:55], s64 offen
s_add_u32 s64, s12, 4096
buffer_load_dwordx4 v[88:91], v3, s[52:55], s64 offen
s_add_u32 s64, s12, 5120
buffer_load_dwordx4 v[92:95], v3, s[52:55], s64 offen
s_add_u32 s64, s12, 6144
buffer_load_dwordx4 v[12:15], v3, s[52:55], s64 offen
s_add_u32 s64, s12, 7168
buffer_load_dwordx4 v[16:19], v3, s[52:55], s64 offen
s_add_u32 s64, s13, 0
buffer_load_dwordx4 v[20:23], v3, s[52:55], s64 offen
s_add_u32 s64, s13, 1024
buffer_load_dwordx4 v[24:27], v3, s[52:55], s64 offen
s_add_u32 s64, s13, 2048
buffer_load_dwordx4 v[28:31], v3, s[52:55], s64 offen
s_mov_b32 s67, 0
s_cmp_eq_u32 s59, 1
s_cselect_b32 s67, 15360, s67
s_cmp_eq_u32 s59, 2
s_cselect_b32 s67, 30720, s67
s_cmp_eq_u32 s59, 3
s_cselect_b32 s67, 87040, s67
v_add_u32 v7, s67, v3
s_waitcnt vmcnt(10)
v_mfma_f32_16x16x32_bf16 v[32:35], v[96:99], v[72:75], 0
v_mfma_f32_16x16x32_bf16 v[36:39], v[100:103], v[72:75], 0
v_mfma_f32_16x16x32_bf16 v[40:43], v[104:107], v[72:75], 0
v_mfma_f32_16x16x32_bf16 v[44:47], v[108:111], v[72:75], 0
v_mfma_f32_16x16x32_bf16 v[48:51], v[112:115], v[72:75], 0
s_add_u32 s64, s13, 3072
buffer_load_dwordx4 v[72:75], v3, s[52:55], s64 offen
s_waitcnt vmcnt(10)
v_mfma_f32_16x16x32_bf16 v[32:35], v[116:119], v[76:79], v[32:35]
v_mfma_f32_16x16x32_bf16 v[36:39], v[120:123], v[76:79], v[36:39]
v_mfma_f32_16x16x32_bf16 v[40:43], v[124:127], v[76:79], v[40:43]
v_mfma_f32_16x16x32_bf16 v[44:47], v[128:131], v[76:79], v[44:47]
v_mfma_f32_16x16x32_bf16 v[48:51], v[132:135], v[76:79], v[48:51]
s_add_u32 s64, s13, 4096
buffer_load_dwordx4 v[76:79], v3, s[52:55], s64 offen
s_waitcnt vmcnt(10)
v_mfma_f32_16x16x32_bf16 v[32:35], v[136:139], v[80:83], v[32:35]
v_mfma_f32_16x16x32_bf16 v[36:39], v[140:143], v[80:83], v[36:39]
v_mfma_f32_16x16x32_bf16 v[40:43], v[144:147], v[80:83], v[40:43]
v_mfma_f32_16x16x32_bf16 v[44:47], v[148:151], v[80:83], v[44:47]
v_mfma_f32_16x16x32_bf16 v[48:51], v[152:155], v[80:83], v[48:51]
s_add_u32 s64, s13, 5120
buffer_load_dwordx4 v[80:83], v3, s[52:55], s64 offen
s_waitcnt vmcnt(10)
v_mfma_f32_16x16x32_bf16 v[32:35], v[156:159], v[84:87], v[32:35]
v_mfma_f32_16x16x32_bf16 v[36:39], v[160:163], v[84:87], v[36:39]
v_mfma_f32_16x16x32_bf16 v[40:43], v[164:167], v[84:87], v[40:43]
v_mfma_f32_16x16x32_bf16 v[44:47], v[168:171], v[84:87], v[44:47]
v_mfma_f32_16x16x32_bf16 v[48:51], v[172:175], v[84:87], v[48:51]
s_add_u32 s64, s13, 6144
buffer_load_dwordx4 v[84:87], v3, s[52:55], s64 offen
s_waitcnt vmcnt(10)
v_mfma_f32_16x16x32_bf16 v[32:35], v[176:179], v[88:91], v[32:35]
v_mfma_f32_16x16x32_bf16 v[36:39], v[180:183], v[88:91], v[36:39]
v_mfma_f32_16x16x32_bf16 v[40:43], v[184:187], v[88:91], v[40:43]
v_mfma_f32_16x16x32_bf16 v[44:47], v[188:191], v[88:91], v[44:47]
v_mfma_f32_16x16x32_bf16 v[48:51], v[192:195], v[88:91], v[48:51]
s_add_u32 s64, s13, 7168
buffer_load_dwordx4 v[88:91], v3, s[52:55], s64 offen
s_waitcnt vmcnt(10)
v_mfma_f32_16x16x32_bf16 v[32:35], v[196:199], v[92:95], v[32:35]
v_mfma_f32_16x16x32_bf16 v[36:39], v[200:203], v[92:95], v[36:39]
v_mfma_f32_16x16x32_bf16 v[40:43], v[204:207], v[92:95], v[40:43]
v_mfma_f32_16x16x32_bf16 v[44:47], v[208:211], v[92:95], v[44:47]
v_mfma_f32_16x16x32_bf16 v[48:51], v[212:215], v[92:95], v[48:51]
s_add_u32 s64, s14, 0
buffer_load_dwordx4 v[92:95], v3, s[52:55], s64 offen
s_waitcnt vmcnt(10)
v_mfma_f32_16x16x32_bf16 v[32:35], v[216:219], v[12:15], v[32:35]
v_mfma_f32_16x16x32_bf16 v[36:39], v[220:223], v[12:15], v[36:39]
v_mfma_f32_16x16x32_bf16 v[40:43], v[224:227], v[12:15], v[40:43]
v_mfma_f32_16x16x32_bf16 v[44:47], v[228:231], v[12:15], v[44:47]
v_mfma_f32_16x16x32_bf16 v[48:51], v[232:235], v[12:15], v[48:51]
s_add_u32 s64, s14, 1024
buffer_load_dwordx4 v[12:15], v3, s[52:55], s64 offen
s_waitcnt vmcnt(10)
v_mfma_f32_16x16x32_bf16 v[32:35], v[236:239], v[16:19], v[32:35]
v_mfma_f32_16x16x32_bf16 v[36:39], v[240:243], v[16:19], v[36:39]
v_mfma_f32_16x16x32_bf16 v[40:43], v[244:247], v[16:19], v[40:43]
v_mfma_f32_16x16x32_bf16 v[44:47], v[248:251], v[16:19], v[44:47]
v_mfma_f32_16x16x32_bf16 v[48:51], v[252:255], v[16:19], v[48:51]
s_add_u32 s64, s14, 2048
buffer_load_dwordx4 v[16:19], v3, s[52:55], s64 offen
s_nop 1
v_pk_mul_f32 v[32:33], v[32:33], v[8:9] op_sel_hi:[1,0]
v_pk_mul_f32 v[34:35], v[34:35], v[8:9] op_sel_hi:[1,0]
v_pk_mul_f32 v[36:37], v[36:37], v[8:9] op_sel_hi:[1,0]
v_pk_mul_f32 v[38:39], v[38:39], v[8:9] op_sel_hi:[1,0]
v_pk_mul_f32 v[40:41], v[40:41], v[8:9] op_sel_hi:[1,0]
v_pk_mul_f32 v[42:43], v[42:43], v[8:9] op_sel_hi:[1,0]
v_pk_mul_f32 v[44:45], v[44:45], v[8:9] op_sel_hi:[1,0]
v_pk_mul_f32 v[46:47], v[46:47], v[8:9] op_sel_hi:[1,0]
v_pk_mul_f32 v[48:49], v[48:49], v[8:9] op_sel_hi:[1,0]
v_pk_mul_f32 v[50:51], v[50:51], v[8:9] op_sel_hi:[1,0]
ds_write_b128 v7, v[32:35] offset:0
ds_write_b128 v7, v[36:39] offset:1024
ds_write_b128 v7, v[40:43] offset:2048
ds_write_b128 v7, v[44:47] offset:3072
ds_write_b128 v7, v[48:51] offset:4096
s_add_u32 s64, s59, 1
s_and_b32 s64, s64, 3
s_lshl_b32 s64, s64, 2
s_add_u32 s64, s64, 153576
v_mov_b32 v5, s64
s_mov_b64 exec, 1
ds_add_u32 v5, v0
s_mov_b64 exec, -1
s_waitcnt vmcnt(10)
v_mfma_f32_16x16x32_bf16 v[52:55], v[96:99], v[20:23], 0
v_mfma_f32_16x16x32_bf16 v[56:59], v[100:103], v[20:23], 0
v_mfma_f32_16x16x32_bf16 v[60:63], v[104:107], v[20:23], 0
v_mfma_f32_16x16x32_bf16 v[64:67], v[108:111], v[20:23], 0
v_mfma_f32_16x16x32_bf16 v[68:71], v[112:115], v[20:23], 0
s_add_u32 s64, s14, 3072
buffer_load_dwordx4 v[20:23], v3, s[52:55], s64 offen
s_waitcnt vmcnt(10)
v_mfma_f32_16x16x32_bf16 v[52:55], v[116:119], v[24:27], v[52:55]
v_mfma_f32_16x16x32_bf16 v[56:59], v[120:123], v[24:27], v[56:59]
v_mfma_f32_16x16x32_bf16 v[60:63], v[124:127], v[24:27], v[60:63]
v_mfma_f32_16x16x32_bf16 v[64:67], v[128:131], v[24:27], v[64:67]
v_mfma_f32_16x16x32_bf16 v[68:71], v[132:135], v[24:27], v[68:71]
s_add_u32 s64, s14, 4096
buffer_load_dwordx4 v[24:27], v3, s[52:55], s64 offen
s_waitcnt vmcnt(10)
v_mfma_f32_16x16x32_bf16 v[52:55], v[136:139], v[28:31], v[52:55]
v_mfma_f32_16x16x32_bf16 v[56:59], v[140:143], v[28:31], v[56:59]
v_mfma_f32_16x16x32_bf16 v[60:63], v[144:147], v[28:31], v[60:63]
v_mfma_f32_16x16x32_bf16 v[64:67], v[148:151], v[28:31], v[64:67]
v_mfma_f32_16x16x32_bf16 v[68:71], v[152:155], v[28:31], v[68:71]
s_add_u32 s64, s14, 5120
buffer_load_dwordx4 v[28:31], v3, s[52:55], s64 offen
s_waitcnt vmcnt(10)
v_mfma_f32_16x16x32_bf16 v[52:55], v[156:159], v[72:75], v[52:55]
v_mfma_f32_16x16x32_bf16 v[56:59], v[160:163], v[72:75], v[56:59]
v_mfma_f32_16x16x32_bf16 v[60:63], v[164:167], v[72:75], v[60:63]
v_mfma_f32_16x16x32_bf16 v[64:67], v[168:171], v[72:75], v[64:67]
v_mfma_f32_16x16x32_bf16 v[68:71], v[172:175], v[72:75], v[68:71]
s_add_u32 s64, s14, 6144
buffer_load_dwordx4 v[72:75], v3, s[52:55], s64 offen
s_waitcnt vmcnt(10)
v_mfma_f32_16x16x32_bf16 v[52:55], v[176:179], v[76:79], v[52:55]
v_mfma_f32_16x16x32_bf16 v[56:59], v[180:183], v[76:79], v[56:59]
v_mfma_f32_16x16x32_bf16 v[60:63], v[184:187], v[76:79], v[60:63]
v_mfma_f32_16x16x32_bf16 v[64:67], v[188:191], v[76:79], v[64:67]
v_mfma_f32_16x16x32_bf16 v[68:71], v[192:195], v[76:79], v[68:71]
s_add_u32 s64, s14, 7168
buffer_load_dwordx4 v[76:79], v3, s[52:55], s64 offen
s_waitcnt vmcnt(10)
v_mfma_f32_16x16x32_bf16 v[52:55], v[196:199], v[80:83], v[52:55]
v_mfma_f32_16x16x32_bf16 v[56:59], v[200:203], v[80:83], v[56:59]
v_mfma_f32_16x16x32_bf16 v[60:63], v[204:207], v[80:83], v[60:63]
v_mfma_f32_16x16x32_bf16 v[64:67], v[208:211], v[80:83], v[64:67]
v_mfma_f32_16x16x32_bf16 v[68:71], v[212:215], v[80:83], v[68:71]
s_add_u32 s64, s15, 0
buffer_load_dwordx4 v[80:83], v3, s[52:55], s64 offen
s_waitcnt vmcnt(10)
v_mfma_f32_16x16x32_bf16 v[52:55], v[216:219], v[84:87], v[52:55]
v_mfma_f32_16x16x32_bf16 v[56:59], v[220:223], v[84:87], v[56:59]
v_mfma_f32_16x16x32_bf16 v[60:63], v[224:227], v[84:87], v[60:63]
v_mfma_f32_16x16x32_bf16 v[64:67], v[228:231], v[84:87], v[64:67]
v_mfma_f32_16x16x32_bf16 v[68:71], v[232:235], v[84:87], v[68:71]
s_add_u32 s64, s15, 1024
buffer_load_dwordx4 v[84:87], v3, s[52:55], s64 offen
s_waitcnt vmcnt(10)
v_mfma_f32_16x16x32_bf16 v[52:55], v[236:239], v[88:91], v[52:55]
v_mfma_f32_16x16x32_bf16 v[56:59], v[240:243], v[88:91], v[56:59]
v_mfma_f32_16x16x32_bf16 v[60:63], v[244:247], v[88:91], v[60:63]
v_mfma_f32_16x16x32_bf16 v[64:67], v[248:251], v[88:91], v[64:67]
v_mfma_f32_16x16x32_bf16 v[68:71], v[252:255], v[88:91], v[68:71]
s_add_u32 s64, s15, 2048
buffer_load_dwordx4 v[88:91], v3, s[52:55], s64 offen
s_nop 1
v_pk_mul_f32 v[52:53], v[52:53], v[8:9] op_sel:[0,1] op_sel_hi:[1,1]
v_pk_mul_f32 v[54:55], v[54:55], v[8:9] op_sel:[0,1] op_sel_hi:[1,1]
v_pk_mul_f32 v[56:57], v[56:57], v[8:9] op_sel:[0,1] op_sel_hi:[1,1]
v_pk_mul_f32 v[58:59], v[58:59], v[8:9] op_sel:[0,1] op_sel_hi:[1,1]
v_pk_mul_f32 v[60:61], v[60:61], v[8:9] op_sel:[0,1] op_sel_hi:[1,1]
v_pk_mul_f32 v[62:63], v[62:63], v[8:9] op_sel:[0,1] op_sel_hi:[1,1]
v_pk_mul_f32 v[64:65], v[64:65], v[8:9] op_sel:[0,1] op_sel_hi:[1,1]
v_pk_mul_f32 v[66:67], v[66:67], v[8:9] op_sel:[0,1] op_sel_hi:[1,1]
v_pk_mul_f32 v[68:69], v[68:69], v[8:9] op_sel:[0,1] op_sel_hi:[1,1]
v_pk_mul_f32 v[70:71], v[70:71], v[8:9] op_sel:[0,1] op_sel_hi:[1,1]
ds_write_b128 v7, v[52:55] offset:5120
ds_write_b128 v7, v[56:59] offset:6144
ds_write_b128 v7, v[60:63] offset:7168
ds_write_b128 v7, v[64:67] offset:8192
ds_write_b128 v7, v[68:71] offset:9216
s_add_u32 s64, s59, 2
s_and_b32 s64, s64, 3
s_lshl_b32 s64, s64, 2
s_add_u32 s64, s64, 153576
v_mov_b32 v5, s64
s_mov_b64 exec, 1
ds_add_u32 v5, v0
s_mov_b64 exec, -1
s_waitcnt vmcnt(10)
v_mfma_f32_16x16x32_bf16 v[32:35], v[96:99], v[92:95], 0
v_mfma_f32_16x16x32_bf16 v[36:39], v[100:103], v[92:95], 0
v_mfma_f32_16x16x32_bf16 v[40:43], v[104:107], v[92:95], 0
v_mfma_f32_16x16x32_bf16 v[44:47], v[108:111], v[92:95], 0
v_mfma_f32_16x16x32_bf16 v[48:51], v[112:115], v[92:95], 0
s_add_u32 s64, s15, 3072
buffer_load_dwordx4 v[92:95], v3, s[52:55], s64 offen
s_waitcnt vmcnt(10)
v_mfma_f32_16x16x32_bf16 v[32:35], v[116:119], v[12:15], v[32:35]
v_mfma_f32_16x16x32_bf16 v[36:39], v[120:123], v[12:15], v[36:39]
v_mfma_f32_16x16x32_bf16 v[40:43], v[124:127], v[12:15], v[40:43]
v_mfma_f32_16x16x32_bf16 v[44:47], v[128:131], v[12:15], v[44:47]
v_mfma_f32_16x16x32_bf16 v[48:51], v[132:135], v[12:15], v[48:51]
s_add_u32 s64, s15, 4096
buffer_load_dwordx4 v[12:15], v3, s[52:55], s64 offen
s_waitcnt vmcnt(10)
v_mfma_f32_16x16x32_bf16 v[32:35], v[136:139], v[16:19], v[32:35]
v_mfma_f32_16x16x32_bf16 v[36:39], v[140:143], v[16:19], v[36:39]
v_mfma_f32_16x16x32_bf16 v[40:43], v[144:147], v[16:19], v[40:43]
v_mfma_f32_16x16x32_bf16 v[44:47], v[148:151], v[16:19], v[44:47]
v_mfma_f32_16x16x32_bf16 v[48:51], v[152:155], v[16:19], v[48:51]
s_add_u32 s64, s15, 5120
buffer_load_dwordx4 v[16:19], v3, s[52:55], s64 offen
s_waitcnt vmcnt(10)
v_mfma_f32_16x16x32_bf16 v[32:35], v[156:159], v[20:23], v[32:35]
v_mfma_f32_16x16x32_bf16 v[36:39], v[160:163], v[20:23], v[36:39]
v_mfma_f32_16x16x32_bf16 v[40:43], v[164:167], v[20:23], v[40:43]
v_mfma_f32_16x16x32_bf16 v[44:47], v[168:171], v[20:23], v[44:47]
v_mfma_f32_16x16x32_bf16 v[48:51], v[172:175], v[20:23], v[48:51]
s_add_u32 s64, s15, 6144
buffer_load_dwordx4 v[20:23], v3, s[52:55], s64 offen
s_waitcnt vmcnt(10)
v_mfma_f32_16x16x32_bf16 v[32:35], v[176:179], v[24:27], v[32:35]
v_mfma_f32_16x16x32_bf16 v[36:39], v[180:183], v[24:27], v[36:39]
v_mfma_f32_16x16x32_bf16 v[40:43], v[184:187], v[24:27], v[40:43]
v_mfma_f32_16x16x32_bf16 v[44:47], v[188:191], v[24:27], v[44:47]
v_mfma_f32_16x16x32_bf16 v[48:51], v[192:195], v[24:27], v[48:51]
s_add_u32 s64, s15, 7168
buffer_load_dwordx4 v[24:27], v3, s[52:55], s64 offen
s_waitcnt vmcnt(10)
v_mfma_f32_16x16x32_bf16 v[32:35], v[196:199], v[28:31], v[32:35]
v_mfma_f32_16x16x32_bf16 v[36:39], v[200:203], v[28:31], v[36:39]
v_mfma_f32_16x16x32_bf16 v[40:43], v[204:207], v[28:31], v[40:43]
v_mfma_f32_16x16x32_bf16 v[44:47], v[208:211], v[28:31], v[44:47]
v_mfma_f32_16x16x32_bf16 v[48:51], v[212:215], v[28:31], v[48:51]
s_waitcnt vmcnt(9)
v_mfma_f32_16x16x32_bf16 v[32:35], v[216:219], v[72:75], v[32:35]
v_mfma_f32_16x16x32_bf16 v[36:39], v[220:223], v[72:75], v[36:39]
v_mfma_f32_16x16x32_bf16 v[40:43], v[224:227], v[72:75], v[40:43]
v_mfma_f32_16x16x32_bf16 v[44:47], v[228:231], v[72:75], v[44:47]
v_mfma_f32_16x16x32_bf16 v[48:51], v[232:235], v[72:75], v[48:51]
s_waitcnt vmcnt(8)
v_mfma_f32_16x16x32_bf16 v[32:35], v[236:239], v[76:79], v[32:35]
v_mfma_f32_16x16x32_bf16 v[36:39], v[240:243], v[76:79], v[36:39]
v_mfma_f32_16x16x32_bf16 v[40:43], v[244:247], v[76:79], v[40:43]
v_mfma_f32_16x16x32_bf16 v[44:47], v[248:251], v[76:79], v[44:47]
v_mfma_f32_16x16x32_bf16 v[48:51], v[252:255], v[76:79], v[48:51]
s_nop 3
v_pk_mul_f32 v[32:33], v[32:33], v[10:11] op_sel_hi:[1,0]
v_pk_mul_f32 v[34:35], v[34:35], v[10:11] op_sel_hi:[1,0]
v_pk_mul_f32 v[36:37], v[36:37], v[10:11] op_sel_hi:[1,0]
v_pk_mul_f32 v[38:39], v[38:39], v[10:11] op_sel_hi:[1,0]
v_pk_mul_f32 v[40:41], v[40:41], v[10:11] op_sel_hi:[1,0]
v_pk_mul_f32 v[42:43], v[42:43], v[10:11] op_sel_hi:[1,0]
v_pk_mul_f32 v[44:45], v[44:45], v[10:11] op_sel_hi:[1,0]
v_pk_mul_f32 v[46:47], v[46:47], v[10:11] op_sel_hi:[1,0]
v_pk_mul_f32 v[48:49], v[48:49], v[10:11] op_sel_hi:[1,0]
v_pk_mul_f32 v[50:51], v[50:51], v[10:11] op_sel_hi:[1,0]
ds_write_b128 v7, v[32:35] offset:10240
ds_write_b128 v7, v[36:39] offset:11264
ds_write_b128 v7, v[40:43] offset:12288
ds_write_b128 v7, v[44:47] offset:13312
ds_write_b128 v7, v[48:51] offset:14336
s_add_u32 s64, s59, 3
s_and_b32 s64, s64, 3
s_lshl_b32 s64, s64, 2
s_add_u32 s64, s64, 153576
v_mov_b32 v5, s64
s_mov_b64 exec, 1
ds_add_u32 v5, v0
s_mov_b64 exec, -1
s_waitcnt vmcnt(7)
v_mfma_f32_16x16x32_bf16 v[52:55], v[96:99], v[80:83], 0
v_mfma_f32_16x16x32_bf16 v[56:59], v[100:103], v[80:83], 0
v_mfma_f32_16x16x32_bf16 v[60:63], v[104:107], v[80:83], 0
v_mfma_f32_16x16x32_bf16 v[64:67], v[108:111], v[80:83], 0
v_mfma_f32_16x16x32_bf16 v[68:71], v[112:115], v[80:83], 0
s_waitcnt vmcnt(6)
v_mfma_f32_16x16x32_bf16 v[52:55], v[116:119], v[84:87], v[52:55]
v_mfma_f32_16x16x32_bf16 v[56:59], v[120:123], v[84:87], v[56:59]
v_mfma_f32_16x16x32_bf16 v[60:63], v[124:127], v[84:87], v[60:63]
v_mfma_f32_16x16x32_bf16 v[64:67], v[128:131], v[84:87], v[64:67]
v_mfma_f32_16x16x32_bf16 v[68:71], v[132:135], v[84:87], v[68:71]
s_waitcnt vmcnt(5)
v_mfma_f32_16x16x32_bf16 v[52:55], v[136:139], v[88:91], v[52:55]
v_mfma_f32_16x16x32_bf16 v[56:59], v[140:143], v[88:91], v[56:59]
v_mfma_f32_16x16x32_bf16 v[60:63], v[144:147], v[88:91], v[60:63]
v_mfma_f32_16x16x32_bf16 v[64:67], v[148:151], v[88:91], v[64:67]
v_mfma_f32_16x16x32_bf16 v[68:71], v[152:155], v[88:91], v[68:71]
s_waitcnt vmcnt(4)
v_mfma_f32_16x16x32_bf16 v[52:55], v[156:159], v[92:95], v[52:55]
v_mfma_f32_16x16x32_bf16 v[56:59], v[160:163], v[92:95], v[56:59]
v_mfma_f32_16x16x32_bf16 v[60:63], v[164:167], v[92:95], v[60:63]
v_mfma_f32_16x16x32_bf16 v[64:67], v[168:171], v[92:95], v[64:67]
v_mfma_f32_16x16x32_bf16 v[68:71], v[172:175], v[92:95], v[68:71]
s_lshl_b32 s65, s59, 2
s_add_u32 s65, s65, 153576
v_mov_b32 v5, s65
s_mov_b32 s22, 0
L_er8:
ds_read_b32 v97, v5
v_mov_b32 v98, 153560
ds_read_b32 v99, v98
s_waitcnt lgkmcnt(0)
v_readfirstlane_b32 s64, v97
v_readfirstlane_b32 s65, v99
s_add_u32 s22, s22, 1
s_cmp_ge_u32 s22, 0x400000
s_cbranch_scc1 L_er8ok
s_cmp_lt_u32 s64, 3
s_cbranch_scc1 L_er8
s_cmp_lt_u32 s65, 4
s_cbranch_scc1 L_er8
L_er8ok:
s_add_u32 s64, s59, 1
s_and_b32 s64, s64, 3
s_mov_b32 s65, 0
s_cmp_eq_u32 s64, 1
s_cselect_b32 s65, 15360, s65
s_cmp_eq_u32 s64, 2
s_cselect_b32 s65, 30720, s65
s_cmp_eq_u32 s64, 3
s_cselect_b32 s65, 87040, s65
s_add_u32 s65, s65, 10240
v_add_u32 v5, s65, v3
ds_read_b128 v[96:99], v5 offset:0
ds_read_b128 v[100:103], v5 offset:1024
ds_read_b128 v[104:107], v5 offset:2048
ds_read_b128 v[108:111], v5 offset:3072
ds_read_b128 v[112:115], v5 offset:4096
s_add_u32 s64, s59, 2
s_and_b32 s64, s64, 3
s_mov_b32 s65, 0
s_cmp_eq_u32 s64, 1
s_cselect_b32 s65, 15360, s65
s_cmp_eq_u32 s64, 2
s_cselect_b32 s65, 30720, s65
s_cmp_eq_u32 s64, 3
s_cselect_b32 s65, 87040, s65
s_add_u32 s65, s65, 5120
v_add_u32 v5, s65, v3
ds_read_b128 v[116:119], v5 offset:0
ds_read_b128 v[120:123], v5 offset:1024
ds_read_b128 v[124:127], v5 offset:2048
ds_read_b128 v[128:131], v5 offset:3072
ds_read_b128 v[132:135], v5 offset:4096
s_add_u32 s64, s59, 3
s_and_b32 s64, s64, 3
s_mov_b32 s65, 0
s_cmp_eq_u32 s64, 1
s_cselect_b32 s65, 15360, s65
s_cmp_eq_u32 s64, 2
s_cselect_b32 s65, 30720, s65
s_cmp_eq_u32 s64, 3
s_cselect_b32 s65, 87040, s65
s_add_u32 s65, s65, 0
v_add_u32 v5, s65, v3
ds_read_b128 v[136:139], v5 offset:0
ds_read_b128 v[140:143], v5 offset:1024
ds_read_b128 v[144:147], v5 offset:2048
ds_read_b128 v[148:151], v5 offset:3072
ds_read_b128 v[152:155], v5 offset:4096
s_mov_b32 s65, 46080
s_cmp_eq_u32 s59, 1
s_cselect_b32 s65, 66560, s65
s_cmp_eq_u32 s59, 2
s_cselect_b32 s65, 102400, s65
s_cmp_eq_u32 s59, 3
s_cselect_b32 s65, 122880, s65
s_add_u32 s65, s65, 15360
v_add_u32 v5, s65, v3
ds_read_b128 v[156:159], v5 offset:0
ds_read_b128 v[160:163], v5 offset:1024
ds_read_b128 v[164:167], v5 offset:2048
ds_read_b128 v[168:171], v5 offset:3072
ds_read_b128 v[172:175], v5 offset:4096
s_waitcnt vmcnt(3)
v_mfma_f32_16x16x32_bf16 v[52:55], v[176:179], v[12:15], v[52:55]
v_mfma_f32_16x16x32_bf16 v[56:59], v[180:183], v[12:15], v[56:59]
v_mfma_f32_16x16x32_bf16 v[60:63], v[184:187], v[12:15], v[60:63]
v_mfma_f32_16x16x32_bf16 v[64:67], v[188:191], v[12:15], v[64:67]
v_mfma_f32_16x16x32_bf16 v[68:71], v[192:195], v[12:15], v[68:71]
s_waitcnt vmcnt(2)
v_mfma_f32_16x16x32_bf16 v[52:55], v[196:199], v[16:19], v[52:55]
v_mfma_f32_16x16x32_bf16 v[56:59], v[200:203], v[16:19], v[56:59]
v_mfma_f32_16x16x32_bf16 v[60:63], v[204:207], v[16:19], v[60:63]
v_mfma_f32_16x16x32_bf16 v[64:67], v[208:211], v[16:19], v[64:67]
v_mfma_f32_16x16x32_bf16 v[68:71], v[212:215], v[16:19], v[68:71]
s_waitcnt vmcnt(1)
v_mfma_f32_16x16x32_bf16 v[52:55], v[216:219], v[20:23], v[52:55]
v_mfma_f32_16x16x32_bf16 v[56:59], v[220:223], v[20:23], v[56:59]
v_mfma_f32_16x16x32_bf16 v[60:63], v[224:227], v[20:23], v[60:63]
v_mfma_f32_16x16x32_bf16 v[64:67], v[228:231], v[20:23], v[64:67]
v_mfma_f32_16x16x32_bf16 v[68:71], v[232:235], v[20:23], v[68:71]
s_waitcnt vmcnt(0)
v_mfma_f32_16x16x32_bf16 v[52:55], v[236:239], v[24:27], v[52:55]
v_mfma_f32_16x16x32_bf16 v[56:59], v[240:243], v[24:27], v[56:59]
v_mfma_f32_16x16x32_bf16 v[60:63], v[244:247], v[24:27], v[60:63]
v_mfma_f32_16x16x32_bf16 v[64:67], v[248:251], v[24:27], v[64:67]
v_mfma_f32_16x16x32_bf16 v[68:71], v[252:255], v[24:27], v[68:71]
s_nop 3
v_pk_mul_f32 v[52:53], v[52:53], v[10:11] op_sel:[0,1] op_sel_hi:[1,1]
v_pk_mul_f32 v[54:55], v[54:55], v[10:11] op_sel:[0,1] op_sel_hi:[1,1]
v_pk_mul_f32 v[56:57], v[56:57], v[10:11] op_sel:[0,1] op_sel_hi:[1,1]
v_pk_mul_f32 v[58:59], v[58:59], v[10:11] op_sel:[0,1] op_sel_hi:[1,1]
v_pk_mul_f32 v[60:61], v[60:61], v[10:11] op_sel:[0,1] op_sel_hi:[1,1]
v_pk_mul_f32 v[62:63], v[62:63], v[10:11] op_sel:[0,1] op_sel_hi:[1,1]
v_pk_mul_f32 v[64:65], v[64:65], v[10:11] op_sel:[0,1] op_sel_hi:[1,1]
v_pk_mul_f32 v[66:67], v[66:67], v[10:11] op_sel:[0,1] op_sel_hi:[1,1]
v_pk_mul_f32 v[68:69], v[68:69], v[10:11] op_sel:[0,1] op_sel_hi:[1,1]
v_pk_mul_f32 v[70:71], v[70:71], v[10:11] op_sel:[0,1] op_sel_hi:[1,1]
s_lshl_b32 s65, s59, 4
v_add_u32 v72, s65, v6
s_mul_i32 s67, s9, 80
v_lshrrev_b32 v73, 4, v1
v_lshlrev_b32 v73, 2, v73
v_add_u32 v73, s67, v73
v_mul_u32_u24 v4, 640, v72
v_add_u32 v4, v4, v73
v_lshlrev_b32 v75, 1, v4
v_lshlrev_b32 v76, 1, v73
buffer_load_dwordx2 v[236:237], v75, s[72:75], 0 offen offset:0
buffer_load_dwordx2 v[246:247], v76, s[40:43], 0 offen offset:0
buffer_load_dwordx2 v[238:239], v75, s[72:75], 0 offen offset:32
buffer_load_dwordx2 v[248:249], v76, s[40:43], 0 offen offset:32
buffer_load_dwordx2 v[240:241], v75, s[72:75], 0 offen offset:64
buffer_load_dwordx2 v[250:251], v76, s[40:43], 0 offen offset:64
buffer_load_dwordx2 v[242:243], v75, s[72:75], 0 offen offset:96
buffer_load_dwordx2 v[252:253], v76, s[40:43], 0 offen offset:96
buffer_load_dwordx2 v[244:245], v75, s[72:75], 0 offen offset:128
buffer_load_dwordx2 v[254:255], v76, s[40:43], 0 offen offset:128
s_branch L_y_fin
L_y_b:
s_cmp_lg_u32 s59, 1
s_cbranch_scc1 L_y_w
s_lshr_b32 s66, s8, 1
s_lshl_b32 s66, s66, 10
s_add_u32 s66, s66, 14942208
s_mov_b32 s22, 0
L_spoll_f3:
s_mov_b32 s64, 0
s_add_u32 s65, s66, 0
s_load_dword s40, s[36:37], s65 glc
s_add_u32 s65, s66, 64
s_load_dword s41, s[36:37], s65 glc
s_add_u32 s65, s66, 128
s_load_dword s42, s[36:37], s65 glc
s_add_u32 s65, s66, 192
s_load_dword s43, s[36:37], s65 glc
s_add_u32 s65, s66, 256
s_load_dword s44, s[36:37], s65 glc
s_add_u32 s65, s66, 320
s_load_dword s45, s[36:37], s65 glc
s_add_u32 s65, s66, 384
s_load_dword s46, s[36:37], s65 glc
s_add_u32 s65, s66, 448
s_load_dword s47, s[36:37], s65 glc
s_add_u32 s65, s66, 512
s_load_dword s68, s[36:37], s65 glc
s_add_u32 s65, s66, 576
s_load_dword s69, s[36:37], s65 glc
s_add_u32 s65, s66, 640
s_load_dword s70, s[36:37], s65 glc
s_add_u32 s65, s66, 704
s_load_dword s71, s[36:37], s65 glc
s_add_u32 s65, s66, 768
s_load_dword s72, s[36:37], s65 glc
s_add_u32 s65, s66, 832
s_load_dword s73, s[36:37], s65 glc
s_add_u32 s65, s66, 896
s_load_dword s74, s[36:37], s65 glc
s_add_u32 s65, s66, 960
s_load_dword s75, s[36:37], s65 glc
s_waitcnt lgkmcnt(0)
s_xor_b32 s40, s40, s63
s_or_b32 s64, s64, s40
s_xor_b32 s41, s41, s63
s_or_b32 s64, s64, s41
s_xor_b32 s42, s42, s63
s_or_b32 s64, s64, s42
s_xor_b32 s43, s43, s63
s_or_b32 s64, s64, s43
s_xor_b32 s44, s44, s63
s_or_b32 s64, s64, s44
s_xor_b32 s45, s45, s63
s_or_b32 s64, s64, s45
s_xor_b32 s46, s46, s63
s_or_b32 s64, s64, s46
s_xor_b32 s47, s47, s63
s_or_b32 s64, s64, s47
s_xor_b32 s68, s68, s63
s_or_b32 s64, s64, s68
s_xor_b32 s69, s69, s63
s_or_b32 s64, s64, s69
s_xor_b32 s70, s70, s63
s_or_b32 s64, s64, s70
s_xor_b32 s71, s71, s63
s_or_b32 s64, s64, s71
s_xor_b32 s72, s72, s63
s_or_b32 s64, s64, s72
s_xor_b32 s73, s73, s63
s_or_b32 s64, s64, s73
s_xor_b32 s74, s74, s63
s_or_b32 s64, s64, s74
s_xor_b32 s75, s75, s63
s_or_b32 s64, s64, s75
s_add_u32 s22, s22, 1
s_cmp_eq_u32 s64, 0
s_cbranch_scc1 L_spollok_f3
s_cmp_lt_u32 s22, 262144
s_cbranch_scc1 L_spoll_f3
L_spollok_f3:
v_mov_b32 v20, 153548
v_mov_b32 v21, 1
s_waitcnt lgkmcnt(0)
ds_write_b32 v20, v21
L_y_w:
s_waitcnt vmcnt(0)
v_mul_f32 v8, 0xbfb8aa3b, v8
v_exp_f32 v8, v8
s_nop 0
v_add_f32 v8, 1.0, v8
v_rcp_f32 v8, v8
v_mul_f32 v9, 0xbfb8aa3b, v9
v_exp_f32 v9, v9
s_nop 0
v_add_f32 v9, 1.0, v9
v_rcp_f32 v9, v9
v_mul_f32 v10, 0xbfb8aa3b, v10
v_exp_f32 v10, v10
s_nop 0
v_add_f32 v10, 1.0, v10
v_rcp_f32 v10, v10
v_mul_f32 v11, 0xbfb8aa3b, v11
v_exp_f32 v11, v11
s_nop 0
v_add_f32 v11, 1.0, v11
v_rcp_f32 v11, v11
s_nop 0
v_mov_b32 v2, v11
v_sub_f32 v8, 1.0, v8
v_sub_f32 v9, 1.0, v9
v_sub_f32 v10, 1.0, v10
v_sub_f32 v11, 1.0, v11
s_mov_b32 s72, s4
s_and_b32 s73, s5, 0xffff
s_mov_b32 s74, 2621440
s_mov_b32 s75, 0x20000
s_mov_b32 s40, s20
s_and_b32 s41, s21, 0xffff
s_mov_b32 s42, 1280
s_mov_b32 s43, 0x20000
s_mov_b32 s48, s32
s_and_b32 s49, s33, 0xffff
s_mov_b32 s50, 5242880
s_mov_b32 s51, 0x20000
s_lshl_b32 s65, s59, 4
v_add_u32 v72, s65, v6
s_mul_i32 s67, s9, 80
v_lshrrev_b32 v73, 4, v1
v_lshlrev_b32 v73, 2, v73
v_add_u32 v73, s67, v73
v_mul_u32_u24 v4, 640, v72
v_add_u32 v4, v4, v73
v_lshlrev_b32 v75, 1, v4
v_lshlrev_b32 v76, 1, v73
buffer_load_dwordx2 v[236:237], v75, s[72:75], 0 offen offset:0
buffer_load_dwordx2 v[246:247], v76, s[40:43], 0 offen offset:0
buffer_load_dwordx2 v[238:239], v75, s[72:75], 0 offen offset:32
buffer_load_dwordx2 v[248:249], v76, s[40:43], 0 offen offset:32
buffer_load_dwordx2 v[240:241], v75, s[72:75], 0 offen offset:64
buffer_load_dwordx2 v[250:251], v76, s[40:43], 0 offen offset:64
buffer_load_dwordx2 v[242:243], v75, s[72:75], 0 offen offset:96
buffer_load_dwordx2 v[252:253], v76, s[40:43], 0 offen offset:96
buffer_load_dwordx2 v[244:245], v75, s[72:75], 0 offen offset:128
buffer_load_dwordx2 v[254:255], v76, s[40:43], 0 offen offset:128
v_mov_b32 v20, 153532
s_mov_b32 s22, 0
L_lw_89:
ds_read_b32 v21, v20
s_waitcnt lgkmcnt(0)
v_readfirstlane_b32 s64, v21
s_add_u32 s22, s22, 1
s_cmp_ge_u32 s64, 4
s_cbranch_scc1 L_lwok_89
s_cmp_lt_u32 s22, 4194304
s_cbranch_scc1 L_lw_89
L_lwok_89:
v_mov_b32 v20, 153548
s_mov_b32 s22, 0
L_lw_90:
ds_read_b32 v21, v20
s_waitcnt lgkmcnt(0)
v_readfirstlane_b32 s64, v21
s_add_u32 s22, s22, 1
s_cmp_ge_u32 s64, 1
s_cbranch_scc1 L_lwok_90
s_cmp_lt_u32 s22, 4194304
s_cbranch_scc1 L_lw_90
L_lwok_90:
s_cmp_eq_u32 s59, 3
s_cbranch_scc1 L_y_k6
s_add_u32 s64, s12, 0
buffer_load_dwordx4 v[72:75], v3, s[52:55], s64 offen
s_add_u32 s64, s12, 1024
buffer_load_dwordx4 v[76:79], v3, s[52:55], s64 offen
s_add_u32 s64, s12, 2048
buffer_load_dwordx4 v[80:83], v3, s[52:55], s64 offen
s_add_u32 s64, s12, 3072
buffer_load_dwordx4 v[84:87], v3, s[52:55], s64 offen
s_add_u32 s64, s12, 4096
buffer_load_dwordx4 v[88:91], v3, s[52:55], s64 offen
s_add_u32 s64, s12, 5120
buffer_load_dwordx4 v[92:95], v3, s[52:55], s64 offen
s_add_u32 s64, s12, 6144
buffer_load_dwordx4 v[12:15], v3, s[52:55], s64 offen
s_add_u32 s64, s13, 0
buffer_load_dwordx4 v[16:19], v3, s[52:55], s64 offen
s_add_u32 s64, s13, 1024
buffer_load_dwordx4 v[20:23], v3, s[52:55], s64 offen
s_add_u32 s64, s13, 2048
buffer_load_dwordx4 v[24:27], v3, s[52:55], s64 offen
s_add_u32 s64, s13, 3072
buffer_load_dwordx4 v[28:31], v3, s[52:55], s64 offen
s_mov_b32 s67, 0
s_cmp_eq_u32 s59, 1
s_cselect_b32 s67, 15360, s67
s_cmp_eq_u32 s59, 2
s_cselect_b32 s67, 30720, s67
s_cmp_eq_u32 s59, 3
s_cselect_b32 s67, 87040, s67
v_add_u32 v7, s67, v3
s_waitcnt vmcnt(10)
v_mfma_f32_16x16x32_bf16 v[32:35], v[96:99], v[72:75], 0
v_mfma_f32_16x16x32_bf16 v[36:39], v[100:103], v[72:75], 0
v_mfma_f32_16x16x32_bf16 v[40:43], v[104:107], v[72:75], 0
v_mfma_f32_16x16x32_bf16 v[44:47], v[108:111], v[72:75], 0
v_mfma_f32_16x16x32_bf16 v[48:51], v[112:115], v[72:75], 0
s_add_u32 s64, s13, 4096
buffer_load_dwordx4 v[72:75], v3, s[52:55], s64 offen
s_waitcnt vmcnt(10)
v_mfma_f32_16x16x32_bf16 v[32:35], v[116:119], v[76:79], v[32:35]
v_mfma_f32_16x16x32_bf16 v[36:39], v[120:123], v[76:79], v[36:39]
v_mfma_f32_16x16x32_bf16 v[40:43], v[124:127], v[76:79], v[40:43]
v_mfma_f32_16x16x32_bf16 v[44:47], v[128:131], v[76:79], v[44:47]
v_mfma_f32_16x16x32_bf16 v[48:51], v[132:135], v[76:79], v[48:51]
s_add_u32 s64, s13, 5120
buffer_load_dwordx4 v[76:79], v3, s[52:55], s64 offen
s_waitcnt vmcnt(10)
v_mfma_f32_16x16x32_bf16 v[32:35], v[136:139], v[80:83], v[32:35]
v_mfma_f32_16x16x32_bf16 v[36:39], v[140:143], v[80:83], v[36:39]
v_mfma_f32_16x16x32_bf16 v[40:43], v[144:147], v[80:83], v[40:43]
v_mfma_f32_16x16x32_bf16 v[44:47], v[148:151], v[80:83], v[44:47]
v_mfma_f32_16x16x32_bf16 v[48:51], v[152:155], v[80:83], v[48:51]
s_add_u32 s64, s13, 6144
buffer_load_dwordx4 v[80:83], v3, s[52:55], s64 offen
s_waitcnt vmcnt(10)
v_mfma_f32_16x16x32_bf16 v[32:35], v[156:159], v[84:87], v[32:35]
v_mfma_f32_16x16x32_bf16 v[36:39], v[160:163], v[84:87], v[36:39]
v_mfma_f32_16x16x32_bf16 v[40:43], v[164:167], v[84:87], v[40:43]
v_mfma_f32_16x16x32_bf16 v[44:47], v[168:171], v[84:87], v[44:47]
v_mfma_f32_16x16x32_bf16 v[48:51], v[172:175], v[84:87], v[48:51]
s_add_u32 s64, s14, 0
buffer_load_dwordx4 v[84:87], v3, s[52:55], s64 offen
s_waitcnt vmcnt(10)
v_mfma_f32_16x16x32_bf16 v[32:35], v[176:179], v[88:91], v[32:35]
v_mfma_f32_16x16x32_bf16 v[36:39], v[180:183], v[88:91], v[36:39]
v_mfma_f32_16x16x32_bf16 v[40:43], v[184:187], v[88:91], v[40:43]
v_mfma_f32_16x16x32_bf16 v[44:47], v[188:191], v[88:91], v[44:47]
v_mfma_f32_16x16x32_bf16 v[48:51], v[192:195], v[88:91], v[48:51]
s_add_u32 s64, s14, 1024
buffer_load_dwordx4 v[88:91], v3, s[52:55], s64 offen
s_waitcnt vmcnt(10)
v_mfma_f32_16x16x32_bf16 v[32:35], v[196:199], v[92:95], v[32:35]
v_mfma_f32_16x16x32_bf16 v[36:39], v[200:203], v[92:95], v[36:39]
v_mfma_f32_16x16x32_bf16 v[40:43], v[204:207], v[92:95], v[40:43]
v_mfma_f32_16x16x32_bf16 v[44:47], v[208:211], v[92:95], v[44:47]
v_mfma_f32_16x16x32_bf16 v[48:51], v[212:215], v[92:95], v[48:51]
s_add_u32 s64, s14, 2048
buffer_load_dwordx4 v[92:95], v3, s[52:55], s64 offen
s_waitcnt vmcnt(10)
v_mfma_f32_16x16x32_bf16 v[32:35], v[216:219], v[12:15], v[32:35]
v_mfma_f32_16x16x32_bf16 v[36:39], v[220:223], v[12:15], v[36:39]
v_mfma_f32_16x16x32_bf16 v[40:43], v[224:227], v[12:15], v[40:43]
v_mfma_f32_16x16x32_bf16 v[44:47], v[228:231], v[12:15], v[44:47]
v_mfma_f32_16x16x32_bf16 v[48:51], v[232:235], v[12:15], v[48:51]
s_add_u32 s64, s14, 3072
buffer_load_dwordx4 v[12:15], v3, s[52:55], s64 offen
s_nop 1
v_pk_mul_f32 v[32:33], v[32:33], v[8:9] op_sel_hi:[1,0]
v_pk_mul_f32 v[34:35], v[34:35], v[8:9] op_sel_hi:[1,0]
v_pk_mul_f32 v[36:37], v[36:37], v[8:9] op_sel_hi:[1,0]
v_pk_mul_f32 v[38:39], v[38:39], v[8:9] op_sel_hi:[1,0]
v_pk_mul_f32 v[40:41], v[40:41], v[8:9] op_sel_hi:[1,0]
v_pk_mul_f32 v[42:43], v[42:43], v[8:9] op_sel_hi:[1,0]
v_pk_mul_f32 v[44:45], v[44:45], v[8:9] op_sel_hi:[1,0]
v_pk_mul_f32 v[46:47], v[46:47], v[8:9] op_sel_hi:[1,0]
v_pk_mul_f32 v[48:49], v[48:49], v[8:9] op_sel_hi:[1,0]
v_pk_mul_f32 v[50:51], v[50:51], v[8:9] op_sel_hi:[1,0]
ds_write_b128 v7, v[32:35] offset:0
ds_write_b128 v7, v[36:39] offset:1024
ds_write_b128 v7, v[40:43] offset:2048
ds_write_b128 v7, v[44:47] offset:3072
ds_write_b128 v7, v[48:51] offset:4096
s_add_u32 s64, s59, 1
s_and_b32 s64, s64, 3
s_lshl_b32 s64, s64, 2
s_add_u32 s64, s64, 153576
v_mov_b32 v5, s64
s_mov_b64 exec, 1
ds_add_u32 v5, v0
s_mov_b64 exec, -1
s_waitcnt vmcnt(10)
v_mfma_f32_16x16x32_bf16 v[52:55], v[96:99], v[16:19], 0
v_mfma_f32_16x16x32_bf16 v[56:59], v[100:103], v[16:19], 0
v_mfma_f32_16x16x32_bf16 v[60:63], v[104:107], v[16:19], 0
v_mfma_f32_16x16x32_bf16 v[64:67], v[108:111], v[16:19], 0
v_mfma_f32_16x16x32_bf16 v[68:71], v[112:115], v[16:19], 0
s_add_u32 s64, s14, 4096
buffer_load_dwordx4 v[16:19], v3, s[52:55], s64 offen
s_waitcnt vmcnt(10)
v_mfma_f32_16x16x32_bf16 v[52:55], v[116:119], v[20:23], v[52:55]
v_mfma_f32_16x16x32_bf16 v[56:59], v[120:123], v[20:23], v[56:59]
v_mfma_f32_16x16x32_bf16 v[60:63], v[124:127], v[20:23], v[60:63]
v_mfma_f32_16x16x32_bf16 v[64:67], v[128:131], v[20:23], v[64:67]
v_mfma_f32_16x16x32_bf16 v[68:71], v[132:135], v[20:23], v[68:71]
s_add_u32 s64, s14, 5120
buffer_load_dwordx4 v[20:23], v3, s[52:55], s64 offen
s_waitcnt vmcnt(10)
v_mfma_f32_16x16x32_bf16 v[52:55], v[136:139], v[24:27], v[52:55]
v_mfma_f32_16x16x32_bf16 v[56:59], v[140:143], v[24:27], v[56:59]
v_mfma_f32_16x16x32_bf16 v[60:63], v[144:147], v[24:27], v[60:63]
v_mfma_f32_16x16x32_bf16 v[64:67], v[148:151], v[24:27], v[64:67]
v_mfma_f32_16x16x32_bf16 v[68:71], v[152:155], v[24:27], v[68:71]
s_add_u32 s64, s14, 6144
buffer_load_dwordx4 v[24:27], v3, s[52:55], s64 offen
s_waitcnt vmcnt(10)
v_mfma_f32_16x16x32_bf16 v[52:55], v[156:159], v[28:31], v[52:55]
v_mfma_f32_16x16x32_bf16 v[56:59], v[160:163], v[28:31], v[56:59]
v_mfma_f32_16x16x32_bf16 v[60:63], v[164:167], v[28:31], v[60:63]
v_mfma_f32_16x16x32_bf16 v[64:67], v[168:171], v[28:31], v[64:67]
v_mfma_f32_16x16x32_bf16 v[68:71], v[172:175], v[28:31], v[68:71]
s_add_u32 s64, s15, 0
buffer_load_dwordx4 v[28:31], v3, s[52:55], s64 offen
s_waitcnt vmcnt(10)
v_mfma_f32_16x16x32_bf16 v[52:55], v[176:179], v[72:75], v[52:55]
v_mfma_f32_16x16x32_bf16 v[56:59], v[180:183], v[72:75], v[56:59]
v_mfma_f32_16x16x32_bf16 v[60:63], v[184:187], v[72:75], v[60:63]
v_mfma_f32_16x16x32_bf16 v[64:67], v[188:191], v[72:75], v[64:67]
v_mfma_f32_16x16x32_bf16 v[68:71], v[192:195], v[72:75], v[68:71]
s_add_u32 s64, s15, 1024
buffer_load_dwordx4 v[72:75], v3, s[52:55], s64 offen
s_waitcnt vmcnt(10)
v_mfma_f32_16x16x32_bf16 v[52:55], v[196:199], v[76:79], v[52:55]
v_mfma_f32_16x16x32_bf16 v[56:59], v[200:203], v[76:79], v[56:59]
v_mfma_f32_16x16x32_bf16 v[60:63], v[204:207], v[76:79], v[60:63]
v_mfma_f32_16x16x32_bf16 v[64:67], v[208:211], v[76:79], v[64:67]
v_mfma_f32_16x16x32_bf16 v[68:71], v[212:215], v[76:79], v[68:71]
s_add_u32 s64, s15, 2048
buffer_load_dwordx4 v[76:79], v3, s[52:55], s64 offen
s_waitcnt vmcnt(10)
v_mfma_f32_16x16x32_bf16 v[52:55], v[216:219], v[80:83], v[52:55]
v_mfma_f32_16x16x32_bf16 v[56:59], v[220:223], v[80:83], v[56:59]
v_mfma_f32_16x16x32_bf16 v[60:63], v[224:227], v[80:83], v[60:63]
v_mfma_f32_16x16x32_bf16 v[64:67], v[228:231], v[80:83], v[64:67]
v_mfma_f32_16x16x32_bf16 v[68:71], v[232:235], v[80:83], v[68:71]
s_add_u32 s64, s15, 3072
buffer_load_dwordx4 v[80:83], v3, s[52:55], s64 offen
s_nop 1
v_pk_mul_f32 v[52:53], v[52:53], v[8:9] op_sel:[0,1] op_sel_hi:[1,1]
v_pk_mul_f32 v[54:55], v[54:55], v[8:9] op_sel:[0,1] op_sel_hi:[1,1]
v_pk_mul_f32 v[56:57], v[56:57], v[8:9] op_sel:[0,1] op_sel_hi:[1,1]
v_pk_mul_f32 v[58:59], v[58:59], v[8:9] op_sel:[0,1] op_sel_hi:[1,1]
v_pk_mul_f32 v[60:61], v[60:61], v[8:9] op_sel:[0,1] op_sel_hi:[1,1]
v_pk_mul_f32 v[62:63], v[62:63], v[8:9] op_sel:[0,1] op_sel_hi:[1,1]
v_pk_mul_f32 v[64:65], v[64:65], v[8:9] op_sel:[0,1] op_sel_hi:[1,1]
v_pk_mul_f32 v[66:67], v[66:67], v[8:9] op_sel:[0,1] op_sel_hi:[1,1]
v_pk_mul_f32 v[68:69], v[68:69], v[8:9] op_sel:[0,1] op_sel_hi:[1,1]
v_pk_mul_f32 v[70:71], v[70:71], v[8:9] op_sel:[0,1] op_sel_hi:[1,1]
ds_write_b128 v7, v[52:55] offset:5120
ds_write_b128 v7, v[56:59] offset:6144
ds_write_b128 v7, v[60:63] offset:7168
ds_write_b128 v7, v[64:67] offset:8192
ds_write_b128 v7, v[68:71] offset:9216
s_add_u32 s64, s59, 2
s_and_b32 s64, s64, 3
s_lshl_b32 s64, s64, 2
s_add_u32 s64, s64, 153576
v_mov_b32 v5, s64
s_mov_b64 exec, 1
ds_add_u32 v5, v0
s_mov_b64 exec, -1
s_waitcnt vmcnt(10)
v_mfma_f32_16x16x32_bf16 v[32:35], v[96:99], v[84:87], 0
v_mfma_f32_16x16x32_bf16 v[36:39], v[100:103], v[84:87], 0
v_mfma_f32_16x16x32_bf16 v[40:43], v[104:107], v[84:87], 0
v_mfma_f32_16x16x32_bf16 v[44:47], v[108:111], v[84:87], 0
v_mfma_f32_16x16x32_bf16 v[48:51], v[112:115], v[84:87], 0
s_add_u32 s64, s15, 4096
buffer_load_dwordx4 v[84:87], v3, s[52:55], s64 offen
s_waitcnt vmcnt(10)
v_mfma_f32_16x16x32_bf16 v[32:35], v[116:119], v[88:91], v[32:35]
v_mfma_f32_16x16x32_bf16 v[36:39], v[120:123], v[88:91], v[36:39]
v_mfma_f32_16x16x32_bf16 v[40:43], v[124:127], v[88:91], v[40:43]
v_mfma_f32_16x16x32_bf16 v[44:47], v[128:131], v[88:91], v[44:47]
v_mfma_f32_16x16x32_bf16 v[48:51], v[132:135], v[88:91], v[48:51]
s_add_u32 s64, s15, 5120
buffer_load_dwordx4 v[88:91], v3, s[52:55], s64 offen
s_waitcnt vmcnt(10)
v_mfma_f32_16x16x32_bf16 v[32:35], v[136:139], v[92:95], v[32:35]
v_mfma_f32_16x16x32_bf16 v[36:39], v[140:143], v[92:95], v[36:39]
v_mfma_f32_16x16x32_bf16 v[40:43], v[144:147], v[92:95], v[40:43]
v_mfma_f32_16x16x32_bf16 v[44:47], v[148:151], v[92:95], v[44:47]
v_mfma_f32_16x16x32_bf16 v[48:51], v[152:155], v[92:95], v[48:51]
s_add_u32 s64, s15, 6144
buffer_load_dwordx4 v[92:95], v3, s[52:55], s64 offen
s_waitcnt vmcnt(10)
v_mfma_f32_16x16x32_bf16 v[32:35], v[156:159], v[12:15], v[32:35]
v_mfma_f32_16x16x32_bf16 v[36:39], v[160:163], v[12:15], v[36:39]
v_mfma_f32_16x16x32_bf16 v[40:43], v[164:167], v[12:15], v[40:43]
v_mfma_f32_16x16x32_bf16 v[44:47], v[168:171], v[12:15], v[44:47]
v_mfma_f32_16x16x32_bf16 v[48:51], v[172:175], v[12:15], v[48:51]
s_waitcnt vmcnt(9)
v_mfma_f32_16x16x32_bf16 v[32:35], v[176:179], v[16:19], v[32:35]
v_mfma_f32_16x16x32_bf16 v[36:39], v[180:183], v[16:19], v[36:39]
v_mfma_f32_16x16x32_bf16 v[40:43], v[184:187], v[16:19], v[40:43]
v_mfma_f32_16x16x32_bf16 v[44:47], v[188:191], v[16:19], v[44:47]
v_mfma_f32_16x16x32_bf16 v[48:51], v[192:195], v[16:19], v[48:51]
s_waitcnt vmcnt(8)
v_mfma_f32_16x16x32_bf16 v[32:35], v[196:199], v[20:23], v[32:35]
v_mfma_f32_16x16x32_bf16 v[36:39], v[200:203], v[20:23], v[36:39]
v_mfma_f32_16x16x32_bf16 v[40:43], v[204:207], v[20:23], v[40:43]
v_mfma_f32_16x16x32_bf16 v[44:47], v[208:211], v[20:23], v[44:47]
v_mfma_f32_16x16x32_bf16 v[48:51], v[212:215], v[20:23], v[48:51]
s_waitcnt vmcnt(7)
v_mfma_f32_16x16x32_bf16 v[32:35], v[216:219], v[24:27], v[32:35]
v_mfma_f32_16x16x32_bf16 v[36:39], v[220:223], v[24:27], v[36:39]
v_mfma_f32_16x16x32_bf16 v[40:43], v[224:227], v[24:27], v[40:43]
v_mfma_f32_16x16x32_bf16 v[44:47], v[228:231], v[24:27], v[44:47]
v_mfma_f32_16x16x32_bf16 v[48:51], v[232:235], v[24:27], v[48:51]
s_nop 3
v_pk_mul_f32 v[32:33], v[32:33], v[10:11] op_sel_hi:[1,0]
v_pk_mul_f32 v[34:35], v[34:35], v[10:11] op_sel_hi:[1,0]
v_pk_mul_f32 v[36:37], v[36:37], v[10:11] op_sel_hi:[1,0]
v_pk_mul_f32 v[38:39], v[38:39], v[10:11] op_sel_hi:[1,0]
v_pk_mul_f32 v[40:41], v[40:41], v[10:11] op_sel_hi:[1,0]
v_pk_mul_f32 v[42:43], v[42:43], v[10:11] op_sel_hi:[1,0]
v_pk_mul_f32 v[44:45], v[44:45], v[10:11] op_sel_hi:[1,0]
v_pk_mul_f32 v[46:47], v[46:47], v[10:11] op_sel_hi:[1,0]
v_pk_mul_f32 v[48:49], v[48:49], v[10:11] op_sel_hi:[1,0]
v_pk_mul_f32 v[50:51], v[50:51], v[10:11] op_sel_hi:[1,0]
ds_write_b128 v7, v[32:35] offset:10240
ds_write_b128 v7, v[36:39] offset:11264
ds_write_b128 v7, v[40:43] offset:12288
ds_write_b128 v7, v[44:47] offset:13312
ds_write_b128 v7, v[48:51] offset:14336
s_add_u32 s64, s59, 3
s_and_b32 s64, s64, 3
s_lshl_b32 s64, s64, 2
s_add_u32 s64, s64, 153576
v_mov_b32 v5, s64
s_mov_b64 exec, 1
ds_add_u32 v5, v0
s_mov_b64 exec, -1
s_waitcnt vmcnt(6)
v_mfma_f32_16x16x32_bf16 v[52:55], v[96:99], v[28:31], 0
v_mfma_f32_16x16x32_bf16 v[56:59], v[100:103], v[28:31], 0
v_mfma_f32_16x16x32_bf16 v[60:63], v[104:107], v[28:31], 0
v_mfma_f32_16x16x32_bf16 v[64:67], v[108:111], v[28:31], 0
v_mfma_f32_16x16x32_bf16 v[68:71], v[112:115], v[28:31], 0
s_waitcnt vmcnt(5)
v_mfma_f32_16x16x32_bf16 v[52:55], v[116:119], v[72:75], v[52:55]
v_mfma_f32_16x16x32_bf16 v[56:59], v[120:123], v[72:75], v[56:59]
v_mfma_f32_16x16x32_bf16 v[60:63], v[124:127], v[72:75], v[60:63]
v_mfma_f32_16x16x32_bf16 v[64:67], v[128:131], v[72:75], v[64:67]
v_mfma_f32_16x16x32_bf16 v[68:71], v[132:135], v[72:75], v[68:71]
s_waitcnt vmcnt(4)
v_mfma_f32_16x16x32_bf16 v[52:55], v[136:139], v[76:79], v[52:55]
v_mfma_f32_16x16x32_bf16 v[56:59], v[140:143], v[76:79], v[56:59]
v_mfma_f32_16x16x32_bf16 v[60:63], v[144:147], v[76:79], v[60:63]
v_mfma_f32_16x16x32_bf16 v[64:67], v[148:151], v[76:79], v[64:67]
v_mfma_f32_16x16x32_bf16 v[68:71], v[152:155], v[76:79], v[68:71]
s_waitcnt vmcnt(3)
v_mfma_f32_16x16x32_bf16 v[52:55], v[156:159], v[80:83], v[52:55]
v_mfma_f32_16x16x32_bf16 v[56:59], v[160:163], v[80:83], v[56:59]
v_mfma_f32_16x16x32_bf16 v[60:63], v[164:167], v[80:83], v[60:63]
v_mfma_f32_16x16x32_bf16 v[64:67], v[168:171], v[80:83], v[64:67]
v_mfma_f32_16x16x32_bf16 v[68:71], v[172:175], v[80:83], v[68:71]
s_lshl_b32 s65, s59, 2
s_add_u32 s65, s65, 153576
v_mov_b32 v5, s65
s_mov_b32 s22, 0
L_er7:
ds_read_b32 v97, v5
v_mov_b32 v98, 153560
ds_read_b32 v99, v98
s_waitcnt lgkmcnt(0)
v_readfirstlane_b32 s64, v97
v_readfirstlane_b32 s65, v99
s_add_u32 s22, s22, 1
s_cmp_ge_u32 s22, 0x400000
s_cbranch_scc1 L_er7ok
s_cmp_lt_u32 s64, 3
s_cbranch_scc1 L_er7
s_cmp_lt_u32 s65, 4
s_cbranch_scc1 L_er7
L_er7ok:
s_add_u32 s64, s59, 1
s_and_b32 s64, s64, 3
s_mov_b32 s65, 0
s_cmp_eq_u32 s64, 1
s_cselect_b32 s65, 15360, s65
s_cmp_eq_u32 s64, 2
s_cselect_b32 s65, 30720, s65
s_cmp_eq_u32 s64, 3
s_cselect_b32 s65, 87040, s65
s_add_u32 s65, s65, 10240
v_add_u32 v5, s65, v3
ds_read_b128 v[96:99], v5 offset:0
ds_read_b128 v[100:103], v5 offset:1024
ds_read_b128 v[104:107], v5 offset:2048
ds_read_b128 v[108:111], v5 offset:3072
ds_read_b128 v[112:115], v5 offset:4096
s_add_u32 s64, s59, 2
s_and_b32 s64, s64, 3
s_mov_b32 s65, 0
s_cmp_eq_u32 s64, 1
s_cselect_b32 s65, 15360, s65
s_cmp_eq_u32 s64, 2
s_cselect_b32 s65, 30720, s65
s_cmp_eq_u32 s64, 3
s_cselect_b32 s65, 87040, s65
s_add_u32 s65, s65, 5120
v_add_u32 v5, s65, v3
ds_read_b128 v[116:119], v5 offset:0
ds_read_b128 v[120:123], v5 offset:1024
ds_read_b128 v[124:127], v5 offset:2048
ds_read_b128 v[128:131], v5 offset:3072
ds_read_b128 v[132:135], v5 offset:4096
s_add_u32 s64, s59, 3
s_and_b32 s64, s64, 3
s_mov_b32 s65, 0
s_cmp_eq_u32 s64, 1
s_cselect_b32 s65, 15360, s65
s_cmp_eq_u32 s64, 2
s_cselect_b32 s65, 30720, s65
s_cmp_eq_u32 s64, 3
s_cselect_b32 s65, 87040, s65
s_add_u32 s65, s65, 0
v_add_u32 v5, s65, v3
ds_read_b128 v[136:139], v5 offset:0
ds_read_b128 v[140:143], v5 offset:1024
ds_read_b128 v[144:147], v5 offset:2048
ds_read_b128 v[148:151], v5 offset:3072
ds_read_b128 v[152:155], v5 offset:4096
s_mov_b32 s65, 46080
s_cmp_eq_u32 s59, 1
s_cselect_b32 s65, 66560, s65
s_cmp_eq_u32 s59, 2
s_cselect_b32 s65, 102400, s65
s_cmp_eq_u32 s59, 3
s_cselect_b32 s65, 122880, s65
s_add_u32 s65, s65, 15360
v_add_u32 v5, s65, v3
ds_read_b128 v[156:159], v5 offset:0
ds_read_b128 v[160:163], v5 offset:1024
ds_read_b128 v[164:167], v5 offset:2048
ds_read_b128 v[168:171], v5 offset:3072
ds_read_b128 v[172:175], v5 offset:4096
s_waitcnt vmcnt(2)
v_mfma_f32_16x16x32_bf16 v[52:55], v[176:179], v[84:87], v[52:55]
v_mfma_f32_16x16x32_bf16 v[56:59], v[180:183], v[84:87], v[56:59]
v_mfma_f32_16x16x32_bf16 v[60:63], v[184:187], v[84:87], v[60:63]
v_mfma_f32_16x16x32_bf16 v[64:67], v[188:191], v[84:87], v[64:67]
v_mfma_f32_16x16x32_bf16 v[68:71], v[192:195], v[84:87], v[68:71]
s_waitcnt vmcnt(1)
v_mfma_f32_16x16x32_bf16 v[52:55], v[196:199], v[88:91], v[52:55]
v_mfma_f32_16x16x32_bf16 v[56:59], v[200:203], v[88:91], v[56:59]
v_mfma_f32_16x16x32_bf16 v[60:63], v[204:207], v[88:91], v[60:63]
v_mfma_f32_16x16x32_bf16 v[64:67], v[208:211], v[88:91], v[64:67]
v_mfma_f32_16x16x32_bf16 v[68:71], v[212:215], v[88:91], v[68:71]
s_waitcnt vmcnt(0)
v_mfma_f32_16x16x32_bf16 v[52:55], v[216:219], v[92:95], v[52:55]
v_mfma_f32_16x16x32_bf16 v[56:59], v[220:223], v[92:95], v[56:59]
v_mfma_f32_16x16x32_bf16 v[60:63], v[224:227], v[92:95], v[60:63]
v_mfma_f32_16x16x32_bf16 v[64:67], v[228:231], v[92:95], v[64:67]
v_mfma_f32_16x16x32_bf16 v[68:71], v[232:235], v[92:95], v[68:71]
s_nop 3
v_pk_mul_f32 v[52:53], v[52:53], v[10:11] op_sel:[0,1] op_sel_hi:[1,1]
v_pk_mul_f32 v[54:55], v[54:55], v[10:11] op_sel:[0,1] op_sel_hi:[1,1]
v_pk_mul_f32 v[56:57], v[56:57], v[10:11] op_sel:[0,1] op_sel_hi:[1,1]
v_pk_mul_f32 v[58:59], v[58:59], v[10:11] op_sel:[0,1] op_sel_hi:[1,1]
v_pk_mul_f32 v[60:61], v[60:61], v[10:11] op_sel:[0,1] op_sel_hi:[1,1]
v_pk_mul_f32 v[62:63], v[62:63], v[10:11] op_sel:[0,1] op_sel_hi:[1,1]
v_pk_mul_f32 v[64:65], v[64:65], v[10:11] op_sel:[0,1] op_sel_hi:[1,1]
v_pk_mul_f32 v[66:67], v[66:67], v[10:11] op_sel:[0,1] op_sel_hi:[1,1]
v_pk_mul_f32 v[68:69], v[68:69], v[10:11] op_sel:[0,1] op_sel_hi:[1,1]
v_pk_mul_f32 v[70:71], v[70:71], v[10:11] op_sel:[0,1] op_sel_hi:[1,1]
s_branch L_y_fin
L_y_k6:
s_add_u32 s64, s12, 0
buffer_load_dwordx4 v[72:75], v3, s[52:55], s64 offen
s_add_u32 s64, s12, 1024
buffer_load_dwordx4 v[76:79], v3, s[52:55], s64 offen
s_add_u32 s64, s12, 2048
buffer_load_dwordx4 v[80:83], v3, s[52:55], s64 offen
s_add_u32 s64, s12, 3072
buffer_load_dwordx4 v[84:87], v3, s[52:55], s64 offen
s_add_u32 s64, s12, 4096
buffer_load_dwordx4 v[88:91], v3, s[52:55], s64 offen
s_add_u32 s64, s12, 5120
buffer_load_dwordx4 v[92:95], v3, s[52:55], s64 offen
s_add_u32 s64, s13, 0
buffer_load_dwordx4 v[12:15], v3, s[52:55], s64 offen
s_add_u32 s64, s13, 1024
buffer_load_dwordx4 v[16:19], v3, s[52:55], s64 offen
s_add_u32 s64, s13, 2048
buffer_load_dwordx4 v[20:23], v3, s[52:55], s64 offen
s_add_u32 s64, s13, 3072
buffer_load_dwordx4 v[24:27], v3, s[52:55], s64 offen
s_add_u32 s64, s13, 4096
buffer_load_dwordx4 v[28:31], v3, s[52:55], s64 offen
s_mov_b32 s67, 0
s_cmp_eq_u32 s59, 1
s_cselect_b32 s67, 15360, s67
s_cmp_eq_u32 s59, 2
s_cselect_b32 s67, 30720, s67
s_cmp_eq_u32 s59, 3
s_cselect_b32 s67, 87040, s67
v_add_u32 v7, s67, v3
s_waitcnt vmcnt(10)
v_mfma_f32_16x16x32_bf16 v[32:35], v[96:99], v[72:75], 0
v_mfma_f32_16x16x32_bf16 v[36:39], v[100:103], v[72:75], 0
v_mfma_f32_16x16x32_bf16 v[40:43], v[104:107], v[72:75], 0
v_mfma_f32_16x16x32_bf16 v[44:47], v[108:111], v[72:75], 0
v_mfma_f32_16x16x32_bf16 v[48:51], v[112:115], v[72:75], 0
s_add_u32 s64, s13, 5120
buffer_load_dwordx4 v[72:75], v3, s[52:55], s64 offen
s_waitcnt vmcnt(10)
v_mfma_f32_16x16x32_bf16 v[32:35], v[116:119], v[76:79], v[32:35]
v_mfma_f32_16x16x32_bf16 v[36:39], v[120:123], v[76:79], v[36:39]
v_mfma_f32_16x16x32_bf16 v[40:43], v[124:127], v[76:79], v[40:43]
v_mfma_f32_16x16x32_bf16 v[44:47], v[128:131], v[76:79], v[44:47]
v_mfma_f32_16x16x32_bf16 v[48:51], v[132:135], v[76:79], v[48:51]
s_add_u32 s64, s14, 0
buffer_load_dwordx4 v[76:79], v3, s[52:55], s64 offen
s_waitcnt vmcnt(10)
v_mfma_f32_16x16x32_bf16 v[32:35], v[136:139], v[80:83], v[32:35]
v_mfma_f32_16x16x32_bf16 v[36:39], v[140:143], v[80:83], v[36:39]
v_mfma_f32_16x16x32_bf16 v[40:43], v[144:147], v[80:83], v[40:43]
v_mfma_f32_16x16x32_bf16 v[44:47], v[148:151], v[80:83], v[44:47]
v_mfma_f32_16x16x32_bf16 v[48:51], v[152:155], v[80:83], v[48:51]
s_add_u32 s64, s14, 1024
buffer_load_dwordx4 v[80:83], v3, s[52:55], s64 offen
s_waitcnt vmcnt(10)
v_mfma_f32_16x16x32_bf16 v[32:35], v[156:159], v[84:87], v[32:35]
v_mfma_f32_16x16x32_bf16 v[36:39], v[160:163], v[84:87], v[36:39]
v_mfma_f32_16x16x32_bf16 v[40:43], v[164:167], v[84:87], v[40:43]
v_mfma_f32_16x16x32_bf16 v[44:47], v[168:171], v[84:87], v[44:47]
v_mfma_f32_16x16x32_bf16 v[48:51], v[172:175], v[84:87], v[48:51]
s_add_u32 s64, s14, 2048
buffer_load_dwordx4 v[84:87], v3, s[52:55], s64 offen
s_waitcnt vmcnt(10)
v_mfma_f32_16x16x32_bf16 v[32:35], v[176:179], v[88:91], v[32:35]
v_mfma_f32_16x16x32_bf16 v[36:39], v[180:183], v[88:91], v[36:39]
v_mfma_f32_16x16x32_bf16 v[40:43], v[184:187], v[88:91], v[40:43]
v_mfma_f32_16x16x32_bf16 v[44:47], v[188:191], v[88:91], v[44:47]
v_mfma_f32_16x16x32_bf16 v[48:51], v[192:195], v[88:91], v[48:51]
s_add_u32 s64, s14, 3072
buffer_load_dwordx4 v[88:91], v3, s[52:55], s64 offen
s_waitcnt vmcnt(10)
v_mfma_f32_16x16x32_bf16 v[32:35], v[196:199], v[92:95], v[32:35]
v_mfma_f32_16x16x32_bf16 v[36:39], v[200:203], v[92:95], v[36:39]
v_mfma_f32_16x16x32_bf16 v[40:43], v[204:207], v[92:95], v[40:43]
v_mfma_f32_16x16x32_bf16 v[44:47], v[208:211], v[92:95], v[44:47]
v_mfma_f32_16x16x32_bf16 v[48:51], v[212:215], v[92:95], v[48:51]
s_add_u32 s64, s14, 4096
buffer_load_dwordx4 v[92:95], v3, s[52:55], s64 offen
s_nop 1
v_pk_mul_f32 v[32:33], v[32:33], v[8:9] op_sel_hi:[1,0]
v_pk_mul_f32 v[34:35], v[34:35], v[8:9] op_sel_hi:[1,0]
v_pk_mul_f32 v[36:37], v[36:37], v[8:9] op_sel_hi:[1,0]
v_pk_mul_f32 v[38:39], v[38:39], v[8:9] op_sel_hi:[1,0]
v_pk_mul_f32 v[40:41], v[40:41], v[8:9] op_sel_hi:[1,0]
v_pk_mul_f32 v[42:43], v[42:43], v[8:9] op_sel_hi:[1,0]
v_pk_mul_f32 v[44:45], v[44:45], v[8:9] op_sel_hi:[1,0]
v_pk_mul_f32 v[46:47], v[46:47], v[8:9] op_sel_hi:[1,0]
v_pk_mul_f32 v[48:49], v[48:49], v[8:9] op_sel_hi:[1,0]
v_pk_mul_f32 v[50:51], v[50:51], v[8:9] op_sel_hi:[1,0]
ds_write_b128 v7, v[32:35] offset:0
ds_write_b128 v7, v[36:39] offset:1024
ds_write_b128 v7, v[40:43] offset:2048
ds_write_b128 v7, v[44:47] offset:3072
ds_write_b128 v7, v[48:51] offset:4096
s_add_u32 s64, s59, 1
s_and_b32 s64, s64, 3
s_lshl_b32 s64, s64, 2
s_add_u32 s64, s64, 153576
v_mov_b32 v5, s64
s_mov_b64 exec, 1
ds_add_u32 v5, v0
s_mov_b64 exec, -1
s_waitcnt vmcnt(10)
v_mfma_f32_16x16x32_bf16 v[52:55], v[96:99], v[12:15], 0
v_mfma_f32_16x16x32_bf16 v[56:59], v[100:103], v[12:15], 0
v_mfma_f32_16x16x32_bf16 v[60:63], v[104:107], v[12:15], 0
v_mfma_f32_16x16x32_bf16 v[64:67], v[108:111], v[12:15], 0
v_mfma_f32_16x16x32_bf16 v[68:71], v[112:115], v[12:15], 0
s_add_u32 s64, s14, 5120
buffer_load_dwordx4 v[12:15], v3, s[52:55], s64 offen
s_waitcnt vmcnt(10)
v_mfma_f32_16x16x32_bf16 v[52:55], v[116:119], v[16:19], v[52:55]
v_mfma_f32_16x16x32_bf16 v[56:59], v[120:123], v[16:19], v[56:59]
v_mfma_f32_16x16x32_bf16 v[60:63], v[124:127], v[16:19], v[60:63]
v_mfma_f32_16x16x32_bf16 v[64:67], v[128:131], v[16:19], v[64:67]
v_mfma_f32_16x16x32_bf16 v[68:71], v[132:135], v[16:19], v[68:71]
s_add_u32 s64, s15, 0
buffer_load_dwordx4 v[16:19], v3, s[52:55], s64 offen
s_waitcnt vmcnt(10)
v_mfma_f32_16x16x32_bf16 v[52:55], v[136:139], v[20:23], v[52:55]
v_mfma_f32_16x16x32_bf16 v[56:59], v[140:143], v[20:23], v[56:59]
v_mfma_f32_16x16x32_bf16 v[60:63], v[144:147], v[20:23], v[60:63]
v_mfma_f32_16x16x32_bf16 v[64:67], v[148:151], v[20:23], v[64:67]
v_mfma_f32_16x16x32_bf16 v[68:71], v[152:155], v[20:23], v[68:71]
s_add_u32 s64, s15, 1024
buffer_load_dwordx4 v[20:23], v3, s[52:55], s64 offen
s_waitcnt vmcnt(10)
v_mfma_f32_16x16x32_bf16 v[52:55], v[156:159], v[24:27], v[52:55]
v_mfma_f32_16x16x32_bf16 v[56:59], v[160:163], v[24:27], v[56:59]
v_mfma_f32_16x16x32_bf16 v[60:63], v[164:167], v[24:27], v[60:63]
v_mfma_f32_16x16x32_bf16 v[64:67], v[168:171], v[24:27], v[64:67]
v_mfma_f32_16x16x32_bf16 v[68:71], v[172:175], v[24:27], v[68:71]
s_add_u32 s64, s15, 2048
buffer_load_dwordx4 v[24:27], v3, s[52:55], s64 offen
s_waitcnt vmcnt(10)
v_mfma_f32_16x16x32_bf16 v[52:55], v[176:179], v[28:31], v[52:55]
v_mfma_f32_16x16x32_bf16 v[56:59], v[180:183], v[28:31], v[56:59]
v_mfma_f32_16x16x32_bf16 v[60:63], v[184:187], v[28:31], v[60:63]
v_mfma_f32_16x16x32_bf16 v[64:67], v[188:191], v[28:31], v[64:67]
v_mfma_f32_16x16x32_bf16 v[68:71], v[192:195], v[28:31], v[68:71]
s_add_u32 s64, s15, 3072
buffer_load_dwordx4 v[28:31], v3, s[52:55], s64 offen
s_waitcnt vmcnt(10)
v_mfma_f32_16x16x32_bf16 v[52:55], v[196:199], v[72:75], v[52:55]
v_mfma_f32_16x16x32_bf16 v[56:59], v[200:203], v[72:75], v[56:59]
v_mfma_f32_16x16x32_bf16 v[60:63], v[204:207], v[72:75], v[60:63]
v_mfma_f32_16x16x32_bf16 v[64:67], v[208:211], v[72:75], v[64:67]
v_mfma_f32_16x16x32_bf16 v[68:71], v[212:215], v[72:75], v[68:71]
s_add_u32 s64, s15, 4096
buffer_load_dwordx4 v[72:75], v3, s[52:55], s64 offen
s_nop 1
v_pk_mul_f32 v[52:53], v[52:53], v[8:9] op_sel:[0,1] op_sel_hi:[1,1]
v_pk_mul_f32 v[54:55], v[54:55], v[8:9] op_sel:[0,1] op_sel_hi:[1,1]
v_pk_mul_f32 v[56:57], v[56:57], v[8:9] op_sel:[0,1] op_sel_hi:[1,1]
v_pk_mul_f32 v[58:59], v[58:59], v[8:9] op_sel:[0,1] op_sel_hi:[1,1]
v_pk_mul_f32 v[60:61], v[60:61], v[8:9] op_sel:[0,1] op_sel_hi:[1,1]
v_pk_mul_f32 v[62:63], v[62:63], v[8:9] op_sel:[0,1] op_sel_hi:[1,1]
v_pk_mul_f32 v[64:65], v[64:65], v[8:9] op_sel:[0,1] op_sel_hi:[1,1]
v_pk_mul_f32 v[66:67], v[66:67], v[8:9] op_sel:[0,1] op_sel_hi:[1,1]
v_pk_mul_f32 v[68:69], v[68:69], v[8:9] op_sel:[0,1] op_sel_hi:[1,1]
v_pk_mul_f32 v[70:71], v[70:71], v[8:9] op_sel:[0,1] op_sel_hi:[1,1]
ds_write_b128 v7, v[52:55] offset:5120
ds_write_b128 v7, v[56:59] offset:6144
ds_write_b128 v7, v[60:63] offset:7168
ds_write_b128 v7, v[64:67] offset:8192
ds_write_b128 v7, v[68:71] offset:9216
s_add_u32 s64, s59, 2
s_and_b32 s64, s64, 3
s_lshl_b32 s64, s64, 2
s_add_u32 s64, s64, 153576
v_mov_b32 v5, s64
s_mov_b64 exec, 1
ds_add_u32 v5, v0
s_mov_b64 exec, -1
s_waitcnt vmcnt(10)
v_mfma_f32_16x16x32_bf16 v[32:35], v[96:99], v[76:79], 0
v_mfma_f32_16x16x32_bf16 v[36:39], v[100:103], v[76:79], 0
v_mfma_f32_16x16x32_bf16 v[40:43], v[104:107], v[76:79], 0
v_mfma_f32_16x16x32_bf16 v[44:47], v[108:111], v[76:79], 0
v_mfma_f32_16x16x32_bf16 v[48:51], v[112:115], v[76:79], 0
s_add_u32 s64, s15, 5120
buffer_load_dwordx4 v[76:79], v3, s[52:55], s64 offen
s_waitcnt vmcnt(10)
v_mfma_f32_16x16x32_bf16 v[32:35], v[116:119], v[80:83], v[32:35]
v_mfma_f32_16x16x32_bf16 v[36:39], v[120:123], v[80:83], v[36:39]
v_mfma_f32_16x16x32_bf16 v[40:43], v[124:127], v[80:83], v[40:43]
v_mfma_f32_16x16x32_bf16 v[44:47], v[128:131], v[80:83], v[44:47]
v_mfma_f32_16x16x32_bf16 v[48:51], v[132:135], v[80:83], v[48:51]
s_waitcnt vmcnt(9)
v_mfma_f32_16x16x32_bf16 v[32:35], v[136:139], v[84:87], v[32:35]
v_mfma_f32_16x16x32_bf16 v[36:39], v[140:143], v[84:87], v[36:39]
v_mfma_f32_16x16x32_bf16 v[40:43], v[144:147], v[84:87], v[40:43]
v_mfma_f32_16x16x32_bf16 v[44:47], v[148:151], v[84:87], v[44:47]
v_mfma_f32_16x16x32_bf16 v[48:51], v[152:155], v[84:87], v[48:51]
s_waitcnt vmcnt(8)
v_mfma_f32_16x16x32_bf16 v[32:35], v[156:159], v[88:91], v[32:35]
v_mfma_f32_16x16x32_bf16 v[36:39], v[160:163], v[88:91], v[36:39]
v_mfma_f32_16x16x32_bf16 v[40:43], v[164:167], v[88:91], v[40:43]
v_mfma_f32_16x16x32_bf16 v[44:47], v[168:171], v[88:91], v[44:47]
v_mfma_f32_16x16x32_bf16 v[48:51], v[172:175], v[88:91], v[48:51]
s_waitcnt vmcnt(7)
v_mfma_f32_16x16x32_bf16 v[32:35], v[176:179], v[92:95], v[32:35]
v_mfma_f32_16x16x32_bf16 v[36:39], v[180:183], v[92:95], v[36:39]
v_mfma_f32_16x16x32_bf16 v[40:43], v[184:187], v[92:95], v[40:43]
v_mfma_f32_16x16x32_bf16 v[44:47], v[188:191], v[92:95], v[44:47]
v_mfma_f32_16x16x32_bf16 v[48:51], v[192:195], v[92:95], v[48:51]
s_waitcnt vmcnt(6)
v_mfma_f32_16x16x32_bf16 v[32:35], v[196:199], v[12:15], v[32:35]
v_mfma_f32_16x16x32_bf16 v[36:39], v[200:203], v[12:15], v[36:39]
v_mfma_f32_16x16x32_bf16 v[40:43], v[204:207], v[12:15], v[40:43]
v_mfma_f32_16x16x32_bf16 v[44:47], v[208:211], v[12:15], v[44:47]
v_mfma_f32_16x16x32_bf16 v[48:51], v[212:215], v[12:15], v[48:51]
s_nop 3
v_pk_mul_f32 v[32:33], v[32:33], v[10:11] op_sel_hi:[1,0]
v_pk_mul_f32 v[34:35], v[34:35], v[10:11] op_sel_hi:[1,0]
v_pk_mul_f32 v[36:37], v[36:37], v[10:11] op_sel_hi:[1,0]
v_pk_mul_f32 v[38:39], v[38:39], v[10:11] op_sel_hi:[1,0]
v_pk_mul_f32 v[40:41], v[40:41], v[10:11] op_sel_hi:[1,0]
v_pk_mul_f32 v[42:43], v[42:43], v[10:11] op_sel_hi:[1,0]
v_pk_mul_f32 v[44:45], v[44:45], v[10:11] op_sel_hi:[1,0]
v_pk_mul_f32 v[46:47], v[46:47], v[10:11] op_sel_hi:[1,0]
v_pk_mul_f32 v[48:49], v[48:49], v[10:11] op_sel_hi:[1,0]
v_pk_mul_f32 v[50:51], v[50:51], v[10:11] op_sel_hi:[1,0]
ds_write_b128 v7, v[32:35] offset:10240
ds_write_b128 v7, v[36:39] offset:11264
ds_write_b128 v7, v[40:43] offset:12288
ds_write_b128 v7, v[44:47] offset:13312
ds_write_b128 v7, v[48:51] offset:14336
s_add_u32 s64, s59, 3
s_and_b32 s64, s64, 3
s_lshl_b32 s64, s64, 2
s_add_u32 s64, s64, 153576
v_mov_b32 v5, s64
s_mov_b64 exec, 1
ds_add_u32 v5, v0
s_mov_b64 exec, -1
s_waitcnt vmcnt(5)
v_mfma_f32_16x16x32_bf16 v[52:55], v[96:99], v[16:19], 0
v_mfma_f32_16x16x32_bf16 v[56:59], v[100:103], v[16:19], 0
v_mfma_f32_16x16x32_bf16 v[60:63], v[104:107], v[16:19], 0
v_mfma_f32_16x16x32_bf16 v[64:67], v[108:111], v[16:19], 0
v_mfma_f32_16x16x32_bf16 v[68:71], v[112:115], v[16:19], 0
s_waitcnt vmcnt(4)
v_mfma_f32_16x16x32_bf16 v[52:55], v[116:119], v[20:23], v[52:55]
v_mfma_f32_16x16x32_bf16 v[56:59], v[120:123], v[20:23], v[56:59]
v_mfma_f32_16x16x32_bf16 v[60:63], v[124:127], v[20:23], v[60:63]
v_mfma_f32_16x16x32_bf16 v[64:67], v[128:131], v[20:23], v[64:67]
v_mfma_f32_16x16x32_bf16 v[68:71], v[132:135], v[20:23], v[68:71]
s_waitcnt vmcnt(3)
v_mfma_f32_16x16x32_bf16 v[52:55], v[136:139], v[24:27], v[52:55]
v_mfma_f32_16x16x32_bf16 v[56:59], v[140:143], v[24:27], v[56:59]
v_mfma_f32_16x16x32_bf16 v[60:63], v[144:147], v[24:27], v[60:63]
v_mfma_f32_16x16x32_bf16 v[64:67], v[148:151], v[24:27], v[64:67]
v_mfma_f32_16x16x32_bf16 v[68:71], v[152:155], v[24:27], v[68:71]
s_waitcnt vmcnt(2)
v_mfma_f32_16x16x32_bf16 v[52:55], v[156:159], v[28:31], v[52:55]
v_mfma_f32_16x16x32_bf16 v[56:59], v[160:163], v[28:31], v[56:59]
v_mfma_f32_16x16x32_bf16 v[60:63], v[164:167], v[28:31], v[60:63]
v_mfma_f32_16x16x32_bf16 v[64:67], v[168:171], v[28:31], v[64:67]
v_mfma_f32_16x16x32_bf16 v[68:71], v[172:175], v[28:31], v[68:71]
s_lshl_b32 s65, s59, 2
s_add_u32 s65, s65, 153576
v_mov_b32 v5, s65
s_mov_b32 s22, 0
L_er6:
ds_read_b32 v97, v5
v_mov_b32 v98, 153560
ds_read_b32 v99, v98
s_waitcnt lgkmcnt(0)
v_readfirstlane_b32 s64, v97
v_readfirstlane_b32 s65, v99
s_add_u32 s22, s22, 1
s_cmp_ge_u32 s22, 0x400000
s_cbranch_scc1 L_er6ok
s_cmp_lt_u32 s64, 3
s_cbranch_scc1 L_er6
s_cmp_lt_u32 s65, 4
s_cbranch_scc1 L_er6
L_er6ok:
s_add_u32 s64, s59, 1
s_and_b32 s64, s64, 3
s_mov_b32 s65, 0
s_cmp_eq_u32 s64, 1
s_cselect_b32 s65, 15360, s65
s_cmp_eq_u32 s64, 2
s_cselect_b32 s65, 30720, s65
s_cmp_eq_u32 s64, 3
s_cselect_b32 s65, 87040, s65
s_add_u32 s65, s65, 10240
v_add_u32 v5, s65, v3
ds_read_b128 v[96:99], v5 offset:0
ds_read_b128 v[100:103], v5 offset:1024
ds_read_b128 v[104:107], v5 offset:2048
ds_read_b128 v[108:111], v5 offset:3072
ds_read_b128 v[112:115], v5 offset:4096
s_add_u32 s64, s59, 2
s_and_b32 s64, s64, 3
s_mov_b32 s65, 0
s_cmp_eq_u32 s64, 1
s_cselect_b32 s65, 15360, s65
s_cmp_eq_u32 s64, 2
s_cselect_b32 s65, 30720, s65
s_cmp_eq_u32 s64, 3
s_cselect_b32 s65, 87040, s65
s_add_u32 s65, s65, 5120
v_add_u32 v5, s65, v3
ds_read_b128 v[116:119], v5 offset:0
ds_read_b128 v[120:123], v5 offset:1024
ds_read_b128 v[124:127], v5 offset:2048
ds_read_b128 v[128:131], v5 offset:3072
ds_read_b128 v[132:135], v5 offset:4096
s_add_u32 s64, s59, 3
s_and_b32 s64, s64, 3
s_mov_b32 s65, 0
s_cmp_eq_u32 s64, 1
s_cselect_b32 s65, 15360, s65
s_cmp_eq_u32 s64, 2
s_cselect_b32 s65, 30720, s65
s_cmp_eq_u32 s64, 3
s_cselect_b32 s65, 87040, s65
s_add_u32 s65, s65, 0
v_add_u32 v5, s65, v3
ds_read_b128 v[136:139], v5 offset:0
ds_read_b128 v[140:143], v5 offset:1024
ds_read_b128 v[144:147], v5 offset:2048
ds_read_b128 v[148:151], v5 offset:3072
ds_read_b128 v[152:155], v5 offset:4096
s_mov_b32 s65, 46080
s_cmp_eq_u32 s59, 1
s_cselect_b32 s65, 66560, s65
s_cmp_eq_u32 s59, 2
s_cselect_b32 s65, 102400, s65
s_cmp_eq_u32 s59, 3
s_cselect_b32 s65, 122880, s65
s_add_u32 s65, s65, 15360
v_add_u32 v5, s65, v3
ds_read_b128 v[156:159], v5 offset:0
ds_read_b128 v[160:163], v5 offset:1024
ds_read_b128 v[164:167], v5 offset:2048
ds_read_b128 v[168:171], v5 offset:3072
ds_read_b128 v[172:175], v5 offset:4096
s_waitcnt vmcnt(1)
v_mfma_f32_16x16x32_bf16 v[52:55], v[176:179], v[72:75], v[52:55]
v_mfma_f32_16x16x32_bf16 v[56:59], v[180:183], v[72:75], v[56:59]
v_mfma_f32_16x16x32_bf16 v[60:63], v[184:187], v[72:75], v[60:63]
v_mfma_f32_16x16x32_bf16 v[64:67], v[188:191], v[72:75], v[64:67]
v_mfma_f32_16x16x32_bf16 v[68:71], v[192:195], v[72:75], v[68:71]
s_waitcnt vmcnt(0)
v_mfma_f32_16x16x32_bf16 v[52:55], v[196:199], v[76:79], v[52:55]
v_mfma_f32_16x16x32_bf16 v[56:59], v[200:203], v[76:79], v[56:59]
v_mfma_f32_16x16x32_bf16 v[60:63], v[204:207], v[76:79], v[60:63]
v_mfma_f32_16x16x32_bf16 v[64:67], v[208:211], v[76:79], v[64:67]
v_mfma_f32_16x16x32_bf16 v[68:71], v[212:215], v[76:79], v[68:71]
s_nop 3
v_pk_mul_f32 v[52:53], v[52:53], v[10:11] op_sel:[0,1] op_sel_hi:[1,1]
v_pk_mul_f32 v[54:55], v[54:55], v[10:11] op_sel:[0,1] op_sel_hi:[1,1]
v_pk_mul_f32 v[56:57], v[56:57], v[10:11] op_sel:[0,1] op_sel_hi:[1,1]
v_pk_mul_f32 v[58:59], v[58:59], v[10:11] op_sel:[0,1] op_sel_hi:[1,1]
v_pk_mul_f32 v[60:61], v[60:61], v[10:11] op_sel:[0,1] op_sel_hi:[1,1]
v_pk_mul_f32 v[62:63], v[62:63], v[10:11] op_sel:[0,1] op_sel_hi:[1,1]
v_pk_mul_f32 v[64:65], v[64:65], v[10:11] op_sel:[0,1] op_sel_hi:[1,1]
v_pk_mul_f32 v[66:67], v[66:67], v[10:11] op_sel:[0,1] op_sel_hi:[1,1]
v_pk_mul_f32 v[68:69], v[68:69], v[10:11] op_sel:[0,1] op_sel_hi:[1,1]
v_pk_mul_f32 v[70:71], v[70:71], v[10:11] op_sel:[0,1] op_sel_hi:[1,1]
L_y_fin:
s_waitcnt vmcnt(0)
v_lshlrev_b32 v24, 16, v236
v_lshlrev_b32 v25, 16, v246
v_mul_f32 v24, v24, v25
v_fma_f32 v52, v24, v2, v52
v_and_b32 v24, 0xffff0000, v236
v_and_b32 v25, 0xffff0000, v246
v_mul_f32 v24, v24, v25
v_fma_f32 v53, v24, v2, v53
v_lshlrev_b32 v24, 16, v237
v_lshlrev_b32 v25, 16, v247
v_mul_f32 v24, v24, v25
v_fma_f32 v54, v24, v2, v54
v_and_b32 v24, 0xffff0000, v237
v_and_b32 v25, 0xffff0000, v247
v_mul_f32 v24, v24, v25
v_fma_f32 v55, v24, v2, v55
v_lshlrev_b32 v24, 16, v238
v_lshlrev_b32 v25, 16, v248
v_mul_f32 v24, v24, v25
v_fma_f32 v56, v24, v2, v56
v_and_b32 v24, 0xffff0000, v238
v_and_b32 v25, 0xffff0000, v248
v_mul_f32 v24, v24, v25
v_fma_f32 v57, v24, v2, v57
v_lshlrev_b32 v24, 16, v239
v_lshlrev_b32 v25, 16, v249
v_mul_f32 v24, v24, v25
v_fma_f32 v58, v24, v2, v58
v_and_b32 v24, 0xffff0000, v239
v_and_b32 v25, 0xffff0000, v249
v_mul_f32 v24, v24, v25
v_fma_f32 v59, v24, v2, v59
v_lshlrev_b32 v24, 16, v240
v_lshlrev_b32 v25, 16, v250
v_mul_f32 v24, v24, v25
v_fma_f32 v60, v24, v2, v60
v_and_b32 v24, 0xffff0000, v240
v_and_b32 v25, 0xffff0000, v250
v_mul_f32 v24, v24, v25
v_fma_f32 v61, v24, v2, v61
v_lshlrev_b32 v24, 16, v241
v_lshlrev_b32 v25, 16, v251
v_mul_f32 v24, v24, v25
v_fma_f32 v62, v24, v2, v62
v_and_b32 v24, 0xffff0000, v241
v_and_b32 v25, 0xffff0000, v251
v_mul_f32 v24, v24, v25
v_fma_f32 v63, v24, v2, v63
v_lshlrev_b32 v24, 16, v242
v_lshlrev_b32 v25, 16, v252
v_mul_f32 v24, v24, v25
v_fma_f32 v64, v24, v2, v64
v_and_b32 v24, 0xffff0000, v242
v_and_b32 v25, 0xffff0000, v252
v_mul_f32 v24, v24, v25
v_fma_f32 v65, v24, v2, v65
v_lshlrev_b32 v24, 16, v243
v_lshlrev_b32 v25, 16, v253
v_mul_f32 v24, v24, v25
v_fma_f32 v66, v24, v2, v66
v_and_b32 v24, 0xffff0000, v243
v_and_b32 v25, 0xffff0000, v253
v_mul_f32 v24, v24, v25
v_fma_f32 v67, v24, v2, v67
v_lshlrev_b32 v24, 16, v244
v_lshlrev_b32 v25, 16, v254
v_mul_f32 v24, v24, v25
v_fma_f32 v68, v24, v2, v68
v_and_b32 v24, 0xffff0000, v244
v_and_b32 v25, 0xffff0000, v254
v_mul_f32 v24, v24, v25
v_fma_f32 v69, v24, v2, v69
v_lshlrev_b32 v24, 16, v245
v_lshlrev_b32 v25, 16, v255
v_mul_f32 v24, v24, v25
v_fma_f32 v70, v24, v2, v70
v_and_b32 v24, 0xffff0000, v245
v_and_b32 v25, 0xffff0000, v255
v_mul_f32 v24, v24, v25
v_fma_f32 v71, v24, v2, v71
s_waitcnt lgkmcnt(0)
v_lshlrev_b32 v4, 2, v4
v_pk_add_f32 v[52:53], v[52:53], v[96:97]
v_pk_add_f32 v[54:55], v[54:55], v[98:99]
v_pk_add_f32 v[52:53], v[52:53], v[116:117]
v_pk_add_f32 v[54:55], v[54:55], v[118:119]
v_pk_add_f32 v[52:53], v[52:53], v[136:137]
v_pk_add_f32 v[54:55], v[54:55], v[138:139]
v_pk_add_f32 v[52:53], v[52:53], v[156:157]
v_pk_add_f32 v[54:55], v[54:55], v[158:159]
buffer_store_dwordx4 v[52:55], v4, s[48:51], 0 offen offset:0 sc1
v_pk_add_f32 v[56:57], v[56:57], v[100:101]
v_pk_add_f32 v[58:59], v[58:59], v[102:103]
v_pk_add_f32 v[56:57], v[56:57], v[120:121]
v_pk_add_f32 v[58:59], v[58:59], v[122:123]
v_pk_add_f32 v[56:57], v[56:57], v[140:141]
v_pk_add_f32 v[58:59], v[58:59], v[142:143]
v_pk_add_f32 v[56:57], v[56:57], v[160:161]
v_pk_add_f32 v[58:59], v[58:59], v[162:163]
buffer_store_dwordx4 v[56:59], v4, s[48:51], 0 offen offset:64 sc1
v_pk_add_f32 v[60:61], v[60:61], v[104:105]
v_pk_add_f32 v[62:63], v[62:63], v[106:107]
v_pk_add_f32 v[60:61], v[60:61], v[124:125]
v_pk_add_f32 v[62:63], v[62:63], v[126:127]
v_pk_add_f32 v[60:61], v[60:61], v[144:145]
v_pk_add_f32 v[62:63], v[62:63], v[146:147]
v_pk_add_f32 v[60:61], v[60:61], v[164:165]
v_pk_add_f32 v[62:63], v[62:63], v[166:167]
buffer_store_dwordx4 v[60:63], v4, s[48:51], 0 offen offset:128 sc1
v_pk_add_f32 v[64:65], v[64:65], v[108:109]
v_pk_add_f32 v[66:67], v[66:67], v[110:111]
v_pk_add_f32 v[64:65], v[64:65], v[128:129]
v_pk_add_f32 v[66:67], v[66:67], v[130:131]
v_pk_add_f32 v[64:65], v[64:65], v[148:149]
v_pk_add_f32 v[66:67], v[66:67], v[150:151]
v_pk_add_f32 v[64:65], v[64:65], v[168:169]
v_pk_add_f32 v[66:67], v[66:67], v[170:171]
buffer_store_dwordx4 v[64:67], v4, s[48:51], 0 offen offset:192 sc1
v_pk_add_f32 v[68:69], v[68:69], v[112:113]
v_pk_add_f32 v[70:71], v[70:71], v[114:115]
v_pk_add_f32 v[68:69], v[68:69], v[132:133]
v_pk_add_f32 v[70:71], v[70:71], v[134:135]
v_pk_add_f32 v[68:69], v[68:69], v[152:153]
v_pk_add_f32 v[70:71], v[70:71], v[154:155]
v_pk_add_f32 v[68:69], v[68:69], v[172:173]
v_pk_add_f32 v[70:71], v[70:71], v[174:175]
buffer_store_dwordx4 v[68:71], v4, s[48:51], 0 offen offset:256 sc1
L_fin:
L_end:
s_endpgm
.section .rodata,"a"
.p2align 6
.amdhsa_kernel gated_mix__ssm_conv_s5__linear_kernel_hedgehog__prompt_kernel
.amdhsa_next_free_vgpr 256
.amdhsa_next_free_sgpr 102
.amdhsa_accum_offset 256
.amdhsa_group_segment_fixed_size 0
.amdhsa_kernarg_size 136
.amdhsa_user_sgpr_count 2
.amdhsa_user_sgpr_kernarg_segment_ptr 1
.amdhsa_system_sgpr_workgroup_id_x 1
.amdhsa_float_denorm_mode_32 3
.end_amdhsa_kernel
```
